```python
import torch

def _softmax(x, axis=-1):
    return torch.softmax(x, dim=axis)
def _gelu(x):
    return torch.nn.functional.gelu(x, approximate="tanh")
def _silu(x):
    return torch.nn.functional.silu(x)
def _sigmoid(x):
    return torch.sigmoid(x)
def _layernorm(x, axis=-1, eps=1e-5):
    m = x.mean(dim=axis, keepdim=True)
    v = x.var(dim=axis, keepdim=True, unbiased=False)
    return (x - m) / torch.sqrt(v + eps)
def _scatter_add(tgt, idx, src, axis=0):
    return tgt.clone().index_add_(axis, idx, src)
def _segment_sum(src, seg, n):
    out = torch.zeros((n,) + src.shape[1:], dtype=src.dtype)
    return out.index_add_(0, seg, src)
def _pad(x, pw):
    flat = tuple(v for pair in reversed(pw) for v in pair)
    return torch.nn.functional.pad(x, flat)

kernel_name = 'sequential_preLN__compressed_kv_cla__mixer_token_mlp__prompt'

def setup_inputs():

    _w = (lambda a: (lambda t: t.to(torch.bfloat16) if t.is_floating_point() else t)(torch.as_tensor(a)))
    def _A_setup():
        B, H, Sq, Sk, D, M = 1, 32, 2048, 2048, 128, 512
        Dc = 4 * D
        return {
            "x": _w((lambda *s: torch.randn(*s, dtype=torch.bfloat16) * 0.05)(B, Sq, M)),
            "c_kv": _w((lambda *s: torch.randn(*s, dtype=torch.bfloat16) * 0.2)(B, Sk, Dc)),
            "w_q": _w((lambda *s: torch.randn(*s, dtype=torch.bfloat16) * 3.2)(M, H, D) * (M ** -0.5)),
            "w_uk": _w((lambda *s: torch.randn(*s, dtype=torch.bfloat16) * 6.4)(Dc, H, D) * (Dc ** -0.5)),
            "w_uv": _w((lambda *s: torch.randn(*s, dtype=torch.bfloat16) * 0.2)(Dc, H, D) * (Dc ** -0.5)),
            "w_o": _w((lambda *s: torch.randn(*s, dtype=torch.bfloat16) * 0.2)(H, D, M) * ((H * D) ** -0.5)),
        }
    _A_in = _A_setup()

    def _B_setup():
        B, S, D, F = 1, 2048, 512, 1792
        return {
            "x": _w((lambda *s: torch.randn(*s, dtype=torch.bfloat16) * 0.05)(B, S, D)),
            "w1": _w((lambda *s: torch.randn(*s, dtype=torch.bfloat16) * 0.4)(S, F) * (S ** -0.5)),
            "b1": _w((lambda *s: torch.randn(*s, dtype=torch.bfloat16) * 3.2)(F) * 0.02),
            "w2": _w((lambda *s: torch.randn(*s, dtype=torch.bfloat16) * 0.2)(F, S) * (F ** -0.5)),
            "b2": _w((lambda *s: torch.randn(*s, dtype=torch.bfloat16) * 0.4)(S) * 0.02),
        }
    _B_in = _B_setup()

    return {
        "A_x": _A_in["x"],
        "A_c_kv": _A_in["c_kv"],
        "A_w_q": _A_in["w_q"],
        "A_w_uk": _A_in["w_uk"],
        "A_w_uv": _A_in["w_uv"],
        "A_w_o": _A_in["w_o"],
        "B_x": _B_in["x"],
        "B_w1": _B_in["w1"],
        "B_b1": _B_in["b1"],
        "B_w2": _B_in["w2"],
        "B_b2": _B_in["b2"],
    }

def reference(A_x, A_c_kv, A_w_q, A_w_uk, A_w_uv, A_w_o, B_x, B_w1, B_b1, B_w2, B_b2):
    def _A_ref(x, c_kv, w_q, w_uk, w_uv, w_o):
        B, Sq, M = x.shape[0], x.shape[1], x.shape[2]
        Sk = c_kv.shape[1]
        H, D = w_q.shape[1], w_q.shape[2]
        q = torch.einsum("bqm,mhd->bhqd", x, w_q)
        k = torch.einsum("bkc,chd->bhkd", c_kv, w_uk)
        v = torch.einsum("bkc,chd->bhkd", c_kv, w_uv)
        scores = torch.einsum("bhqd,bhkd->bhqk", q, k) * (D ** -0.5)
        off = Sk - Sq
        qi = torch.arange(Sq)[:, None]
        kj = torch.arange(Sk)[None, :]
        cmask = kj <= (qi + off)
        scores = torch.where(cmask[None, None], scores, -1e9)
        p = _softmax(scores, axis=-1)
        ctx = torch.einsum("bhqk,bhkd->bhqd", p, v)
        return torch.einsum("bhqd,hdm->bqm", ctx, w_o)

    def _B_ref(x, w1, b1, w2, b2):
        B, S, D = x.shape
        h = _layernorm(x, axis=-1)
        u = torch.einsum("bsd,sf->bdf", h, w1) + b1
        u = _gelu(u)
        y = torch.einsum("bdf,fs->bds", u, w2) + b2
        return (lambda x, *d: x.permute(*d))(y, 0, 2, 1)

    x = A_x
    h = x + _A_ref(_layernorm(x, axis=-1), A_c_kv, A_w_q, A_w_uk, A_w_uv, A_w_o)
    h2 = h + _B_ref(_layernorm(h, axis=-1), B_w1, B_b1, B_w2, B_b2)
    return h2
```

```asm
; @launch kernel=k1_kernel grid=(256,1,1) block=(512,1,1) lds=163840
; @launch kernel=k2_kernel grid=(256,1,1) block=(512,1,1) lds=163840
; @launch kernel=k3_kernel grid=(256,1,1) block=(256,1,1) lds=163840
; @launch kernel=k4_kernel grid=(256,1,1) block=(256,1,1) lds=9216
; @launch kernel=k5_kernel grid=(256,1,1) block=(512,1,1) lds=131072
; @launch kernel=k6_kernel grid=(256,1,1) block=(512,1,1) lds=131072
.amdgcn_target "amdgcn-amd-amdhsa--gfx950"
.text
.globl k1_kernel
.p2align 8
.type k1_kernel,@function
k1_kernel:
  s_cmp_ge_u32 s2, 256
  s_cbranch_scc1 k1_kernel_end
  s_load_dwordx2 s[4:5], s[0:1], 0
  s_load_dwordx2 s[6:7], s[0:1], 8
  s_load_dwordx2 s[8:9], s[0:1], 24
  s_load_dwordx2 s[10:11], s[0:1], 32
  s_load_dwordx2 s[12:13], s[0:1], 104
  s_load_dwordx2 s[52:53], s[0:1], 16
  v_and_b32 v1, 63, v0
  v_lshrrev_b32 v2, 6, v0
  s_nop 0
  v_readfirstlane_b32 s3, v2
  s_waitcnt lgkmcnt(0)
  s_and_b32 s17, s2, 7
  s_lshr_b32 s18, s2, 3
  s_and_b32 s14, s18, 7
  s_lshr_b32 s18, s18, 3
  s_lshr_b32 s15, s18, 1
  s_and_b32 s18, s18, 1
  s_lshl_b32 s16, s17, 1
  s_add_u32 s16, s16, s18
  s_cmp_eq_u32 s15, 0
  s_cselect_b32 s8, s8, s10
  s_cselect_b32 s9, s9, s11
  s_mov_b32 s20, s8
  s_and_b32 s21, s9, 0xffff
  s_mov_b32 s22, 4194304
  s_mov_b32 s23, 0x20000
  s_mov_b32 s24, s6
  s_and_b32 s25, s7, 0xffff
  s_mov_b32 s26, 2097152
  s_mov_b32 s27, 0x20000
  s_mov_b32 s28, s4
  s_and_b32 s29, s5, 0xffff
  s_mov_b32 s30, 2097152
  s_mov_b32 s31, 0x20000
  s_add_u32 s32, s12, 0
  s_addc_u32 s33, s13, 0
  s_and_b32 s33, s33, 0xffff
  s_mov_b32 s34, 2097152
  s_mov_b32 s35, 0x20000
  s_add_u32 s36, s12, 2097152
  s_addc_u32 s37, s13, 0
  s_and_b32 s37, s37, 0xffff
  s_mov_b32 s38, 33554432
  s_mov_b32 s39, 0x20000
  s_and_b32 s40, s3, 1
  s_lshl_b32 s41, s40, 1
  v_lshrrev_b32 v3, 5, v1
  v_add_u32 v4, s41, v3
  v_bfe_u32 v5, v1, 2, 3
  v_xor_b32 v5, v5, v4
  v_lshlrev_b32 v5, 6, v5
  v_lshl_add_u32 v5, v3, 13, v5
  v_and_b32 v6, 3, v1
  v_lshl_add_u32 v18, v6, 4, v5
  s_lshl_b32 s41, s40, 2
  v_lshrrev_b32 v3, 4, v1
  v_add_u32 v4, s41, v3
  v_and_b32 v5, 7, v1
  v_xor_b32 v5, v5, v4
  v_lshlrev_b32 v5, 4, v5
  v_lshrrev_b32 v3, 3, v1
  v_lshl_add_u32 v19, v3, 10, v5
  s_lshl_b32 s42, s3, 14
  s_lshl_b32 s45, s16, 9
  s_add_u32 s42, s42, s45
  s_lshl_b32 s43, s14, 18
  s_lshl_b32 s45, s3, 13
  s_add_u32 s43, s43, s45
  s_lshl_b32 s44, s3, 10
  s_lshl_b32 s47, s2, 3
  s_add_u32 s47, s47, s3
  s_lshl_b32 s48, s47, 10
  v_lshlrev_b32 v20, 4, v1
  buffer_load_dwordx4 v[24:27], v20, s[28:31], s48 offen
  s_add_u32 m0, s44, 0
  s_add_u32 s46, s43, 0
  buffer_load_dwordx4 v19, s[24:27], s46 offen lds
  s_add_u32 m0, s44, 8192
  s_add_u32 s46, s43, 65536
  buffer_load_dwordx4 v19, s[24:27], s46 offen lds
  s_add_u32 m0, s44, 98304
  s_add_u32 s46, s42, 0
  buffer_load_dwordx4 v18, s[20:23], s46 offen lds
  s_add_u32 m0, s44, 106496
  s_add_u32 s46, s42, 131072
  buffer_load_dwordx4 v18, s[20:23], s46 offen lds
  s_add_u32 m0, s44, 16384
  s_add_u32 s46, s43, 131072
  buffer_load_dwordx4 v19, s[24:27], s46 offen lds
  s_add_u32 m0, s44, 24576
  s_add_u32 s46, s43, 196608
  buffer_load_dwordx4 v19, s[24:27], s46 offen lds
  s_add_u32 m0, s44, 114688
  s_add_u32 s46, s42, 262144
  buffer_load_dwordx4 v18, s[20:23], s46 offen lds
  s_add_u32 m0, s44, 122880
  s_add_u32 s46, s42, 393216
  buffer_load_dwordx4 v18, s[20:23], s46 offen lds
  s_add_u32 m0, s44, 32768
  s_add_u32 s46, s43, 128
  buffer_load_dwordx4 v19, s[24:27], s46 offen lds
  s_add_u32 m0, s44, 40960
  s_add_u32 s46, s43, 65664
  buffer_load_dwordx4 v19, s[24:27], s46 offen lds
  s_add_u32 m0, s44, 131072
  s_add_u32 s46, s42, 524288
  buffer_load_dwordx4 v18, s[20:23], s46 offen lds
  s_add_u32 m0, s44, 139264
  s_add_u32 s46, s42, 655360
  buffer_load_dwordx4 v18, s[20:23], s46 offen lds
  s_add_u32 m0, s44, 49152
  s_add_u32 s46, s43, 131200
  buffer_load_dwordx4 v19, s[24:27], s46 offen lds
  s_add_u32 m0, s44, 57344
  s_add_u32 s46, s43, 196736
  buffer_load_dwordx4 v19, s[24:27], s46 offen lds
  v_bfe_u32 v3, v1, 2, 2
  v_lshrrev_b32 v4, 5, v1
  v_lshl_add_u32 v4, v4, 3, v3
  v_lshlrev_b32 v4, 9, v4
  v_and_b32 v5, 16, v1
  v_lshl_add_u32 v4, v5, 1, v4
  v_and_b32 v5, 3, v1
  v_lshl_add_u32 v4, v5, 3, v4
  s_lshl_b32 s45, s40, 8
  s_add_u32 s45, s45, 98304
  v_add_u32 v4, s45, v4
  v_xor_b32 v5, 0, v3
  v_lshl_add_u32 v10, v5, 6, v4
  v_xor_b32 v5, 1, v3
  v_lshl_add_u32 v11, v5, 6, v4
  v_xor_b32 v5, 2, v3
  v_lshl_add_u32 v12, v5, 6, v4
  v_xor_b32 v5, 3, v3
  v_lshl_add_u32 v13, v5, 6, v4
  s_lshr_b32 s45, s3, 1
  s_lshl_b32 s45, s45, 13
  v_and_b32 v4, 31, v1
  v_lshlrev_b32 v4, 7, v4
  v_add_u32 v4, s45, v4
  v_bfe_u32 v5, v1, 1, 3
  v_lshrrev_b32 v3, 5, v1
  v_xor_b32 v5, v5, v3
  v_lshl_add_u32 v14, v5, 4, v4
  v_xor_b32 v15, 32, v14
  v_xor_b32 v16, 64, v14
  v_xor_b32 v17, 96, v14
  v_add_u32 v4, 0x10000, v14
  v_add_u32 v5, 0x10000, v15
  v_add_u32 v6, 0x10000, v16
  v_add_u32 v7, 0x10000, v17
  s_waitcnt vmcnt(14)
  v_lshlrev_b32 v28, 16, v24
  v_and_b32 v29, 0xffff0000, v24
  v_lshlrev_b32 v30, 16, v25
  v_and_b32 v31, 0xffff0000, v25
  v_lshlrev_b32 v32, 16, v26
  v_and_b32 v33, 0xffff0000, v26
  v_lshlrev_b32 v34, 16, v27
  v_and_b32 v35, 0xffff0000, v27
  v_add_f32 v36, v28, v29
  v_add_f32 v36, v36, v30
  v_add_f32 v36, v36, v31
  v_add_f32 v36, v36, v32
  v_add_f32 v36, v36, v33
  v_add_f32 v36, v36, v34
  v_add_f32 v36, v36, v35
  s_nop 1
  v_add_f32_dpp v36, v36, v36 row_ror:8 row_mask:0xf bank_mask:0xf
  s_nop 1
  v_add_f32_dpp v36, v36, v36 row_ror:4 row_mask:0xf bank_mask:0xf
  s_nop 1
  v_add_f32_dpp v36, v36, v36 row_ror:2 row_mask:0xf bank_mask:0xf
  s_nop 1
  v_add_f32_dpp v36, v36, v36 row_ror:1 row_mask:0xf bank_mask:0xf
  v_mov_b32 v37, v36
  s_nop 1
  v_permlane16_swap_b32 v37, v36
  v_add_f32 v36, v36, v37
  v_mov_b32 v37, v36
  s_nop 1
  v_permlane32_swap_b32 v37, v36
  v_add_f32 v36, v36, v37
  v_mul_f32 v36, 0x3b000000, v36
  v_sub_f32 v28, v28, v36
  v_sub_f32 v29, v29, v36
  v_sub_f32 v30, v30, v36
  v_sub_f32 v31, v31, v36
  v_sub_f32 v32, v32, v36
  v_sub_f32 v33, v33, v36
  v_sub_f32 v34, v34, v36
  v_sub_f32 v35, v35, v36
  v_mul_f32 v36, v28, v28
  v_fmac_f32 v36, v29, v29
  v_fmac_f32 v36, v30, v30
  v_fmac_f32 v36, v31, v31
  v_fmac_f32 v36, v32, v32
  v_fmac_f32 v36, v33, v33
  v_fmac_f32 v36, v34, v34
  v_fmac_f32 v36, v35, v35
  s_nop 1
  v_add_f32_dpp v36, v36, v36 row_ror:8 row_mask:0xf bank_mask:0xf
  s_nop 1
  v_add_f32_dpp v36, v36, v36 row_ror:4 row_mask:0xf bank_mask:0xf
  s_nop 1
  v_add_f32_dpp v36, v36, v36 row_ror:2 row_mask:0xf bank_mask:0xf
  s_nop 1
  v_add_f32_dpp v36, v36, v36 row_ror:1 row_mask:0xf bank_mask:0xf
  v_mov_b32 v37, v36
  s_nop 1
  v_permlane16_swap_b32 v37, v36
  v_add_f32 v36, v36, v37
  v_mov_b32 v37, v36
  s_nop 1
  v_permlane32_swap_b32 v37, v36
  v_add_f32 v36, v36, v37
  v_mov_b32 v37, 0x3727c5ac
  v_fmac_f32 v37, 0x3b000000, v36
  v_rsq_f32 v37, v37
  s_nop 0
  v_mul_f32 v28, v28, v37
  v_mul_f32 v29, v29, v37
  v_mul_f32 v30, v30, v37
  v_mul_f32 v31, v31, v37
  v_mul_f32 v32, v32, v37
  v_mul_f32 v33, v33, v37
  v_mul_f32 v34, v34, v37
  v_mul_f32 v35, v35, v37
  v_cvt_pk_bf16_f32 v24, v28, v29
  v_cvt_pk_bf16_f32 v25, v30, v31
  v_cvt_pk_bf16_f32 v26, v32, v33
  v_cvt_pk_bf16_f32 v27, v34, v35
  s_lshr_b32 s48, s47, 5
  s_lshl_b32 s48, s48, 15
  s_and_b32 s49, s47, 31
  s_lshl_b32 s49, s49, 4
  s_add_u32 s48, s48, s49
  v_lshrrev_b32 v20, 1, v1
  v_lshlrev_b32 v20, 10, v20
  v_and_b32 v21, 1, v1
  v_lshl_add_u32 v20, v21, 9, v20
  buffer_store_dwordx4 v[24:27], v20, s[32:35], s48 offen
  s_cmp_eq_u32 s15, 1
  s_cbranch_scc1 k1_kernel_v1
  s_waitcnt vmcnt(5)
  s_barrier
  ds_read_b64_tr_b16 v[64:65], v10 offset:0
  ds_read_b64_tr_b16 v[66:67], v10 offset:2048
  ds_read_b64_tr_b16 v[68:69], v11 offset:0
  ds_read_b64_tr_b16 v[70:71], v11 offset:2048
  ds_read_b64_tr_b16 v[72:73], v12 offset:0
  ds_read_b64_tr_b16 v[74:75], v12 offset:2048
  ds_read_b64_tr_b16 v[76:77], v13 offset:0
  ds_read_b64_tr_b16 v[78:79], v13 offset:2048
  ds_read_b128 v[80:83], v14 offset:0
  ds_read_b128 v[84:87], v14 offset:4096
  ds_read_b64_tr_b16 v[88:89], v10 offset:8192
  ds_read_b64_tr_b16 v[90:91], v10 offset:10240
  ds_read_b64_tr_b16 v[92:93], v11 offset:8192
  ds_read_b64_tr_b16 v[94:95], v11 offset:10240
  ds_read_b64_tr_b16 v[96:97], v12 offset:8192
  ds_read_b64_tr_b16 v[98:99], v12 offset:10240
  ds_read_b64_tr_b16 v[100:101], v13 offset:8192
  ds_read_b64_tr_b16 v[102:103], v13 offset:10240
  ds_read_b128 v[104:107], v15 offset:0
  ds_read_b128 v[108:111], v15 offset:4096
  s_waitcnt lgkmcnt(10)
  v_mfma_f32_32x32x16_bf16 v[128:143], v[64:67], v[80:83], 0
  v_mfma_f32_32x32x16_bf16 v[144:159], v[68:71], v[80:83], 0
  s_add_u32 m0, s44, 147456
  v_mfma_f32_32x32x16_bf16 v[160:175], v[72:75], v[80:83], 0
  s_add_u32 s46, s42, 786432
  v_mfma_f32_32x32x16_bf16 v[176:191], v[76:79], v[80:83], 0
  buffer_load_dwordx4 v18, s[20:23], s46 offen lds
  v_mfma_f32_32x32x16_bf16 v[192:207], v[64:67], v[84:87], 0
  v_mfma_f32_32x32x16_bf16 v[208:223], v[68:71], v[84:87], 0
  s_add_u32 m0, s44, 155648
  v_mfma_f32_32x32x16_bf16 v[224:239], v[72:75], v[84:87], 0
  s_add_u32 s46, s42, 917504
  v_mfma_f32_32x32x16_bf16 v[240:255], v[76:79], v[84:87], 0
  buffer_load_dwordx4 v18, s[20:23], s46 offen lds
  ds_read_b64_tr_b16 v[64:65], v10 offset:16384
  ds_read_b64_tr_b16 v[66:67], v10 offset:18432
  ds_read_b64_tr_b16 v[68:69], v11 offset:16384
  ds_read_b64_tr_b16 v[70:71], v11 offset:18432
  ds_read_b64_tr_b16 v[72:73], v12 offset:16384
  ds_read_b64_tr_b16 v[74:75], v12 offset:18432
  ds_read_b64_tr_b16 v[76:77], v13 offset:16384
  ds_read_b64_tr_b16 v[78:79], v13 offset:18432
  ds_read_b128 v[80:83], v16 offset:0
  ds_read_b128 v[84:87], v16 offset:4096
  s_waitcnt lgkmcnt(10)
  v_mfma_f32_32x32x16_bf16 v[128:143], v[88:91], v[104:107], v[128:143]
  v_mfma_f32_32x32x16_bf16 v[144:159], v[92:95], v[104:107], v[144:159]
  s_add_u32 m0, s44, 65536
  v_mfma_f32_32x32x16_bf16 v[160:175], v[96:99], v[104:107], v[160:175]
  s_add_u32 s46, s43, 256
  v_mfma_f32_32x32x16_bf16 v[176:191], v[100:103], v[104:107], v[176:191]
  buffer_load_dwordx4 v19, s[24:27], s46 offen lds
  v_mfma_f32_32x32x16_bf16 v[192:207], v[88:91], v[108:111], v[192:207]
  v_mfma_f32_32x32x16_bf16 v[208:223], v[92:95], v[108:111], v[208:223]
  s_add_u32 m0, s44, 73728
  v_mfma_f32_32x32x16_bf16 v[224:239], v[96:99], v[108:111], v[224:239]
  s_add_u32 s46, s43, 65792
  v_mfma_f32_32x32x16_bf16 v[240:255], v[100:103], v[108:111], v[240:255]
  buffer_load_dwordx4 v19, s[24:27], s46 offen lds
  s_waitcnt vmcnt(4)
  s_barrier
  ds_read_b64_tr_b16 v[88:89], v10 offset:24576
  ds_read_b64_tr_b16 v[90:91], v10 offset:26624
  ds_read_b64_tr_b16 v[92:93], v11 offset:24576
  ds_read_b64_tr_b16 v[94:95], v11 offset:26624
  ds_read_b64_tr_b16 v[96:97], v12 offset:24576
  ds_read_b64_tr_b16 v[98:99], v12 offset:26624
  ds_read_b64_tr_b16 v[100:101], v13 offset:24576
  ds_read_b64_tr_b16 v[102:103], v13 offset:26624
  ds_read_b128 v[104:107], v17 offset:0
  ds_read_b128 v[108:111], v17 offset:4096
  s_waitcnt lgkmcnt(10)
  v_mfma_f32_32x32x16_bf16 v[128:143], v[64:67], v[80:83], v[128:143]
  v_mfma_f32_32x32x16_bf16 v[144:159], v[68:71], v[80:83], v[144:159]
  s_add_u32 m0, s44, 98304
  v_mfma_f32_32x32x16_bf16 v[160:175], v[72:75], v[80:83], v[160:175]
  s_add_u32 s46, s42, 1048576
  v_mfma_f32_32x32x16_bf16 v[176:191], v[76:79], v[80:83], v[176:191]
  buffer_load_dwordx4 v18, s[20:23], s46 offen lds
  v_mfma_f32_32x32x16_bf16 v[192:207], v[64:67], v[84:87], v[192:207]
  v_mfma_f32_32x32x16_bf16 v[208:223], v[68:71], v[84:87], v[208:223]
  s_add_u32 m0, s44, 106496
  v_mfma_f32_32x32x16_bf16 v[224:239], v[72:75], v[84:87], v[224:239]
  s_add_u32 s46, s42, 1179648
  v_mfma_f32_32x32x16_bf16 v[240:255], v[76:79], v[84:87], v[240:255]
  buffer_load_dwordx4 v18, s[20:23], s46 offen lds
  ds_read_b64_tr_b16 v[64:65], v10 offset:32768
  ds_read_b64_tr_b16 v[66:67], v10 offset:34816
  ds_read_b64_tr_b16 v[68:69], v11 offset:32768
  ds_read_b64_tr_b16 v[70:71], v11 offset:34816
  ds_read_b64_tr_b16 v[72:73], v12 offset:32768
  ds_read_b64_tr_b16 v[74:75], v12 offset:34816
  ds_read_b64_tr_b16 v[76:77], v13 offset:32768
  ds_read_b64_tr_b16 v[78:79], v13 offset:34816
  ds_read_b128 v[80:83], v14 offset:32768
  ds_read_b128 v[84:87], v14 offset:36864
  s_waitcnt lgkmcnt(10)
  v_mfma_f32_32x32x16_bf16 v[128:143], v[88:91], v[104:107], v[128:143]
  v_mfma_f32_32x32x16_bf16 v[144:159], v[92:95], v[104:107], v[144:159]
  s_add_u32 m0, s44, 81920
  v_mfma_f32_32x32x16_bf16 v[160:175], v[96:99], v[104:107], v[160:175]
  s_add_u32 s46, s43, 131328
  v_mfma_f32_32x32x16_bf16 v[176:191], v[100:103], v[104:107], v[176:191]
  buffer_load_dwordx4 v19, s[24:27], s46 offen lds
  v_mfma_f32_32x32x16_bf16 v[192:207], v[88:91], v[108:111], v[192:207]
  v_mfma_f32_32x32x16_bf16 v[208:223], v[92:95], v[108:111], v[208:223]
  s_add_u32 m0, s44, 90112
  v_mfma_f32_32x32x16_bf16 v[224:239], v[96:99], v[108:111], v[224:239]
  s_add_u32 s46, s43, 196864
  v_mfma_f32_32x32x16_bf16 v[240:255], v[100:103], v[108:111], v[240:255]
  buffer_load_dwordx4 v19, s[24:27], s46 offen lds
  s_waitcnt vmcnt(4)
  s_barrier
  ds_read_b64_tr_b16 v[88:89], v10 offset:40960
  ds_read_b64_tr_b16 v[90:91], v10 offset:43008
  ds_read_b64_tr_b16 v[92:93], v11 offset:40960
  ds_read_b64_tr_b16 v[94:95], v11 offset:43008
  ds_read_b64_tr_b16 v[96:97], v12 offset:40960
  ds_read_b64_tr_b16 v[98:99], v12 offset:43008
  ds_read_b64_tr_b16 v[100:101], v13 offset:40960
  ds_read_b64_tr_b16 v[102:103], v13 offset:43008
  ds_read_b128 v[104:107], v15 offset:32768
  ds_read_b128 v[108:111], v15 offset:36864
  s_waitcnt lgkmcnt(10)
  v_mfma_f32_32x32x16_bf16 v[128:143], v[64:67], v[80:83], v[128:143]
  v_mfma_f32_32x32x16_bf16 v[144:159], v[68:71], v[80:83], v[144:159]
  s_add_u32 m0, s44, 114688
  v_mfma_f32_32x32x16_bf16 v[160:175], v[72:75], v[80:83], v[160:175]
  s_add_u32 s46, s42, 1310720
  v_mfma_f32_32x32x16_bf16 v[176:191], v[76:79], v[80:83], v[176:191]
  buffer_load_dwordx4 v18, s[20:23], s46 offen lds
  v_mfma_f32_32x32x16_bf16 v[192:207], v[64:67], v[84:87], v[192:207]
  v_mfma_f32_32x32x16_bf16 v[208:223], v[68:71], v[84:87], v[208:223]
  s_add_u32 m0, s44, 122880
  v_mfma_f32_32x32x16_bf16 v[224:239], v[72:75], v[84:87], v[224:239]
  s_add_u32 s46, s42, 1441792
  v_mfma_f32_32x32x16_bf16 v[240:255], v[76:79], v[84:87], v[240:255]
  buffer_load_dwordx4 v18, s[20:23], s46 offen lds
  ds_read_b64_tr_b16 v[64:65], v10 offset:49152
  ds_read_b64_tr_b16 v[66:67], v10 offset:51200
  ds_read_b64_tr_b16 v[68:69], v11 offset:49152
  ds_read_b64_tr_b16 v[70:71], v11 offset:51200
  ds_read_b64_tr_b16 v[72:73], v12 offset:49152
  ds_read_b64_tr_b16 v[74:75], v12 offset:51200
  ds_read_b64_tr_b16 v[76:77], v13 offset:49152
  ds_read_b64_tr_b16 v[78:79], v13 offset:51200
  ds_read_b128 v[80:83], v16 offset:32768
  ds_read_b128 v[84:87], v16 offset:36864
  s_waitcnt lgkmcnt(10)
  v_mfma_f32_32x32x16_bf16 v[128:143], v[88:91], v[104:107], v[128:143]
  v_mfma_f32_32x32x16_bf16 v[144:159], v[92:95], v[104:107], v[144:159]
  s_add_u32 m0, s44, 0
  v_mfma_f32_32x32x16_bf16 v[160:175], v[96:99], v[104:107], v[160:175]
  s_add_u32 s46, s43, 384
  v_mfma_f32_32x32x16_bf16 v[176:191], v[100:103], v[104:107], v[176:191]
  buffer_load_dwordx4 v19, s[24:27], s46 offen lds
  v_mfma_f32_32x32x16_bf16 v[192:207], v[88:91], v[108:111], v[192:207]
  v_mfma_f32_32x32x16_bf16 v[208:223], v[92:95], v[108:111], v[208:223]
  s_add_u32 m0, s44, 8192
  v_mfma_f32_32x32x16_bf16 v[224:239], v[96:99], v[108:111], v[224:239]
  s_add_u32 s46, s43, 65920
  v_mfma_f32_32x32x16_bf16 v[240:255], v[100:103], v[108:111], v[240:255]
  buffer_load_dwordx4 v19, s[24:27], s46 offen lds
  s_waitcnt vmcnt(4)
  s_barrier
  ds_read_b64_tr_b16 v[88:89], v10 offset:57344
  ds_read_b64_tr_b16 v[90:91], v10 offset:59392
  ds_read_b64_tr_b16 v[92:93], v11 offset:57344
  ds_read_b64_tr_b16 v[94:95], v11 offset:59392
  ds_read_b64_tr_b16 v[96:97], v12 offset:57344
  ds_read_b64_tr_b16 v[98:99], v12 offset:59392
  ds_read_b64_tr_b16 v[100:101], v13 offset:57344
  ds_read_b64_tr_b16 v[102:103], v13 offset:59392
  ds_read_b128 v[104:107], v17 offset:32768
  ds_read_b128 v[108:111], v17 offset:36864
  s_waitcnt lgkmcnt(10)
  v_mfma_f32_32x32x16_bf16 v[128:143], v[64:67], v[80:83], v[128:143]
  v_mfma_f32_32x32x16_bf16 v[144:159], v[68:71], v[80:83], v[144:159]
  s_add_u32 m0, s44, 131072
  v_mfma_f32_32x32x16_bf16 v[160:175], v[72:75], v[80:83], v[160:175]
  s_add_u32 s46, s42, 1572864
  v_mfma_f32_32x32x16_bf16 v[176:191], v[76:79], v[80:83], v[176:191]
  buffer_load_dwordx4 v18, s[20:23], s46 offen lds
  v_mfma_f32_32x32x16_bf16 v[192:207], v[64:67], v[84:87], v[192:207]
  v_mfma_f32_32x32x16_bf16 v[208:223], v[68:71], v[84:87], v[208:223]
  s_add_u32 m0, s44, 139264
  v_mfma_f32_32x32x16_bf16 v[224:239], v[72:75], v[84:87], v[224:239]
  s_add_u32 s46, s42, 1703936
  v_mfma_f32_32x32x16_bf16 v[240:255], v[76:79], v[84:87], v[240:255]
  buffer_load_dwordx4 v18, s[20:23], s46 offen lds
  ds_read_b64_tr_b16 v[64:65], v10 offset:0
  ds_read_b64_tr_b16 v[66:67], v10 offset:2048
  ds_read_b64_tr_b16 v[68:69], v11 offset:0
  ds_read_b64_tr_b16 v[70:71], v11 offset:2048
  ds_read_b64_tr_b16 v[72:73], v12 offset:0
  ds_read_b64_tr_b16 v[74:75], v12 offset:2048
  ds_read_b64_tr_b16 v[76:77], v13 offset:0
  ds_read_b64_tr_b16 v[78:79], v13 offset:2048
  ds_read_b128 v[80:83], v4 offset:0
  ds_read_b128 v[84:87], v4 offset:4096
  s_waitcnt lgkmcnt(10)
  v_mfma_f32_32x32x16_bf16 v[128:143], v[88:91], v[104:107], v[128:143]
  v_mfma_f32_32x32x16_bf16 v[144:159], v[92:95], v[104:107], v[144:159]
  s_add_u32 m0, s44, 16384
  v_mfma_f32_32x32x16_bf16 v[160:175], v[96:99], v[104:107], v[160:175]
  s_add_u32 s46, s43, 131456
  v_mfma_f32_32x32x16_bf16 v[176:191], v[100:103], v[104:107], v[176:191]
  buffer_load_dwordx4 v19, s[24:27], s46 offen lds
  v_mfma_f32_32x32x16_bf16 v[192:207], v[88:91], v[108:111], v[192:207]
  v_mfma_f32_32x32x16_bf16 v[208:223], v[92:95], v[108:111], v[208:223]
  s_add_u32 m0, s44, 24576
  v_mfma_f32_32x32x16_bf16 v[224:239], v[96:99], v[108:111], v[224:239]
  s_add_u32 s46, s43, 196992
  v_mfma_f32_32x32x16_bf16 v[240:255], v[100:103], v[108:111], v[240:255]
  buffer_load_dwordx4 v19, s[24:27], s46 offen lds
  s_waitcnt vmcnt(4)
  s_barrier
  ds_read_b64_tr_b16 v[88:89], v10 offset:8192
  ds_read_b64_tr_b16 v[90:91], v10 offset:10240
  ds_read_b64_tr_b16 v[92:93], v11 offset:8192
  ds_read_b64_tr_b16 v[94:95], v11 offset:10240
  ds_read_b64_tr_b16 v[96:97], v12 offset:8192
  ds_read_b64_tr_b16 v[98:99], v12 offset:10240
  ds_read_b64_tr_b16 v[100:101], v13 offset:8192
  ds_read_b64_tr_b16 v[102:103], v13 offset:10240
  ds_read_b128 v[104:107], v5 offset:0
  ds_read_b128 v[108:111], v5 offset:4096
  s_waitcnt lgkmcnt(10)
  v_mfma_f32_32x32x16_bf16 v[128:143], v[64:67], v[80:83], v[128:143]
  v_mfma_f32_32x32x16_bf16 v[144:159], v[68:71], v[80:83], v[144:159]
  s_add_u32 m0, s44, 147456
  v_mfma_f32_32x32x16_bf16 v[160:175], v[72:75], v[80:83], v[160:175]
  s_add_u32 s46, s42, 1835008
  v_mfma_f32_32x32x16_bf16 v[176:191], v[76:79], v[80:83], v[176:191]
  buffer_load_dwordx4 v18, s[20:23], s46 offen lds
  v_mfma_f32_32x32x16_bf16 v[192:207], v[64:67], v[84:87], v[192:207]
  v_mfma_f32_32x32x16_bf16 v[208:223], v[68:71], v[84:87], v[208:223]
  s_add_u32 m0, s44, 155648
  v_mfma_f32_32x32x16_bf16 v[224:239], v[72:75], v[84:87], v[224:239]
  s_add_u32 s46, s42, 1966080
  v_mfma_f32_32x32x16_bf16 v[240:255], v[76:79], v[84:87], v[240:255]
  buffer_load_dwordx4 v18, s[20:23], s46 offen lds
  ds_read_b64_tr_b16 v[64:65], v10 offset:16384
  ds_read_b64_tr_b16 v[66:67], v10 offset:18432
  ds_read_b64_tr_b16 v[68:69], v11 offset:16384
  ds_read_b64_tr_b16 v[70:71], v11 offset:18432
  ds_read_b64_tr_b16 v[72:73], v12 offset:16384
  ds_read_b64_tr_b16 v[74:75], v12 offset:18432
  ds_read_b64_tr_b16 v[76:77], v13 offset:16384
  ds_read_b64_tr_b16 v[78:79], v13 offset:18432
  ds_read_b128 v[80:83], v6 offset:0
  ds_read_b128 v[84:87], v6 offset:4096
  s_waitcnt lgkmcnt(10)
  v_mfma_f32_32x32x16_bf16 v[128:143], v[88:91], v[104:107], v[128:143]
  v_mfma_f32_32x32x16_bf16 v[144:159], v[92:95], v[104:107], v[144:159]
  s_add_u32 m0, s44, 32768
  v_mfma_f32_32x32x16_bf16 v[160:175], v[96:99], v[104:107], v[160:175]
  s_add_u32 s46, s43, 512
  v_mfma_f32_32x32x16_bf16 v[176:191], v[100:103], v[104:107], v[176:191]
  buffer_load_dwordx4 v19, s[24:27], s46 offen lds
  v_mfma_f32_32x32x16_bf16 v[192:207], v[88:91], v[108:111], v[192:207]
  v_mfma_f32_32x32x16_bf16 v[208:223], v[92:95], v[108:111], v[208:223]
  s_add_u32 m0, s44, 40960
  v_mfma_f32_32x32x16_bf16 v[224:239], v[96:99], v[108:111], v[224:239]
  s_add_u32 s46, s43, 66048
  v_mfma_f32_32x32x16_bf16 v[240:255], v[100:103], v[108:111], v[240:255]
  buffer_load_dwordx4 v19, s[24:27], s46 offen lds
  s_waitcnt vmcnt(4)
  s_barrier
  ds_read_b64_tr_b16 v[88:89], v10 offset:24576
  ds_read_b64_tr_b16 v[90:91], v10 offset:26624
  ds_read_b64_tr_b16 v[92:93], v11 offset:24576
  ds_read_b64_tr_b16 v[94:95], v11 offset:26624
  ds_read_b64_tr_b16 v[96:97], v12 offset:24576
  ds_read_b64_tr_b16 v[98:99], v12 offset:26624
  ds_read_b64_tr_b16 v[100:101], v13 offset:24576
  ds_read_b64_tr_b16 v[102:103], v13 offset:26624
  ds_read_b128 v[104:107], v7 offset:0
  ds_read_b128 v[108:111], v7 offset:4096
  s_waitcnt lgkmcnt(10)
  v_mfma_f32_32x32x16_bf16 v[128:143], v[64:67], v[80:83], v[128:143]
  v_mfma_f32_32x32x16_bf16 v[144:159], v[68:71], v[80:83], v[144:159]
  s_add_u32 m0, s44, 98304
  v_mfma_f32_32x32x16_bf16 v[160:175], v[72:75], v[80:83], v[160:175]
  s_add_u32 s46, s42, 2097152
  v_mfma_f32_32x32x16_bf16 v[176:191], v[76:79], v[80:83], v[176:191]
  buffer_load_dwordx4 v18, s[20:23], s46 offen lds
  v_mfma_f32_32x32x16_bf16 v[192:207], v[64:67], v[84:87], v[192:207]
  v_mfma_f32_32x32x16_bf16 v[208:223], v[68:71], v[84:87], v[208:223]
  s_add_u32 m0, s44, 106496
  v_mfma_f32_32x32x16_bf16 v[224:239], v[72:75], v[84:87], v[224:239]
  s_add_u32 s46, s42, 2228224
  v_mfma_f32_32x32x16_bf16 v[240:255], v[76:79], v[84:87], v[240:255]
  buffer_load_dwordx4 v18, s[20:23], s46 offen lds
  ds_read_b64_tr_b16 v[64:65], v10 offset:32768
  ds_read_b64_tr_b16 v[66:67], v10 offset:34816
  ds_read_b64_tr_b16 v[68:69], v11 offset:32768
  ds_read_b64_tr_b16 v[70:71], v11 offset:34816
  ds_read_b64_tr_b16 v[72:73], v12 offset:32768
  ds_read_b64_tr_b16 v[74:75], v12 offset:34816
  ds_read_b64_tr_b16 v[76:77], v13 offset:32768
  ds_read_b64_tr_b16 v[78:79], v13 offset:34816
  ds_read_b128 v[80:83], v14 offset:0
  ds_read_b128 v[84:87], v14 offset:4096
  s_waitcnt lgkmcnt(10)
  v_mfma_f32_32x32x16_bf16 v[128:143], v[88:91], v[104:107], v[128:143]
  v_mfma_f32_32x32x16_bf16 v[144:159], v[92:95], v[104:107], v[144:159]
  s_add_u32 m0, s44, 49152
  v_mfma_f32_32x32x16_bf16 v[160:175], v[96:99], v[104:107], v[160:175]
  s_add_u32 s46, s43, 131584
  v_mfma_f32_32x32x16_bf16 v[176:191], v[100:103], v[104:107], v[176:191]
  buffer_load_dwordx4 v19, s[24:27], s46 offen lds
  v_mfma_f32_32x32x16_bf16 v[192:207], v[88:91], v[108:111], v[192:207]
  v_mfma_f32_32x32x16_bf16 v[208:223], v[92:95], v[108:111], v[208:223]
  s_add_u32 m0, s44, 57344
  v_mfma_f32_32x32x16_bf16 v[224:239], v[96:99], v[108:111], v[224:239]
  s_add_u32 s46, s43, 197120
  v_mfma_f32_32x32x16_bf16 v[240:255], v[100:103], v[108:111], v[240:255]
  buffer_load_dwordx4 v19, s[24:27], s46 offen lds
  s_waitcnt vmcnt(4)
  s_barrier
  ds_read_b64_tr_b16 v[88:89], v10 offset:40960
  ds_read_b64_tr_b16 v[90:91], v10 offset:43008
  ds_read_b64_tr_b16 v[92:93], v11 offset:40960
  ds_read_b64_tr_b16 v[94:95], v11 offset:43008
  ds_read_b64_tr_b16 v[96:97], v12 offset:40960
  ds_read_b64_tr_b16 v[98:99], v12 offset:43008
  ds_read_b64_tr_b16 v[100:101], v13 offset:40960
  ds_read_b64_tr_b16 v[102:103], v13 offset:43008
  ds_read_b128 v[104:107], v15 offset:0
  ds_read_b128 v[108:111], v15 offset:4096
  s_waitcnt lgkmcnt(10)
  v_mfma_f32_32x32x16_bf16 v[128:143], v[64:67], v[80:83], v[128:143]
  v_mfma_f32_32x32x16_bf16 v[144:159], v[68:71], v[80:83], v[144:159]
  s_add_u32 m0, s44, 114688
  v_mfma_f32_32x32x16_bf16 v[160:175], v[72:75], v[80:83], v[160:175]
  s_add_u32 s46, s42, 2359296
  v_mfma_f32_32x32x16_bf16 v[176:191], v[76:79], v[80:83], v[176:191]
  buffer_load_dwordx4 v18, s[20:23], s46 offen lds
  v_mfma_f32_32x32x16_bf16 v[192:207], v[64:67], v[84:87], v[192:207]
  v_mfma_f32_32x32x16_bf16 v[208:223], v[68:71], v[84:87], v[208:223]
  s_add_u32 m0, s44, 122880
  v_mfma_f32_32x32x16_bf16 v[224:239], v[72:75], v[84:87], v[224:239]
  s_add_u32 s46, s42, 2490368
  v_mfma_f32_32x32x16_bf16 v[240:255], v[76:79], v[84:87], v[240:255]
  buffer_load_dwordx4 v18, s[20:23], s46 offen lds
  ds_read_b64_tr_b16 v[64:65], v10 offset:49152
  ds_read_b64_tr_b16 v[66:67], v10 offset:51200
  ds_read_b64_tr_b16 v[68:69], v11 offset:49152
  ds_read_b64_tr_b16 v[70:71], v11 offset:51200
  ds_read_b64_tr_b16 v[72:73], v12 offset:49152
  ds_read_b64_tr_b16 v[74:75], v12 offset:51200
  ds_read_b64_tr_b16 v[76:77], v13 offset:49152
  ds_read_b64_tr_b16 v[78:79], v13 offset:51200
  ds_read_b128 v[80:83], v16 offset:0
  ds_read_b128 v[84:87], v16 offset:4096
  s_waitcnt lgkmcnt(10)
  v_mfma_f32_32x32x16_bf16 v[128:143], v[88:91], v[104:107], v[128:143]
  v_mfma_f32_32x32x16_bf16 v[144:159], v[92:95], v[104:107], v[144:159]
  s_add_u32 m0, s44, 65536
  v_mfma_f32_32x32x16_bf16 v[160:175], v[96:99], v[104:107], v[160:175]
  s_add_u32 s46, s43, 640
  v_mfma_f32_32x32x16_bf16 v[176:191], v[100:103], v[104:107], v[176:191]
  buffer_load_dwordx4 v19, s[24:27], s46 offen lds
  v_mfma_f32_32x32x16_bf16 v[192:207], v[88:91], v[108:111], v[192:207]
  v_mfma_f32_32x32x16_bf16 v[208:223], v[92:95], v[108:111], v[208:223]
  s_add_u32 m0, s44, 73728
  v_mfma_f32_32x32x16_bf16 v[224:239], v[96:99], v[108:111], v[224:239]
  s_add_u32 s46, s43, 66176
  v_mfma_f32_32x32x16_bf16 v[240:255], v[100:103], v[108:111], v[240:255]
  buffer_load_dwordx4 v19, s[24:27], s46 offen lds
  s_waitcnt vmcnt(4)
  s_barrier
  ds_read_b64_tr_b16 v[88:89], v10 offset:57344
  ds_read_b64_tr_b16 v[90:91], v10 offset:59392
  ds_read_b64_tr_b16 v[92:93], v11 offset:57344
  ds_read_b64_tr_b16 v[94:95], v11 offset:59392
  ds_read_b64_tr_b16 v[96:97], v12 offset:57344
  ds_read_b64_tr_b16 v[98:99], v12 offset:59392
  ds_read_b64_tr_b16 v[100:101], v13 offset:57344
  ds_read_b64_tr_b16 v[102:103], v13 offset:59392
  ds_read_b128 v[104:107], v17 offset:0
  ds_read_b128 v[108:111], v17 offset:4096
  s_waitcnt lgkmcnt(10)
  v_mfma_f32_32x32x16_bf16 v[128:143], v[64:67], v[80:83], v[128:143]
  v_mfma_f32_32x32x16_bf16 v[144:159], v[68:71], v[80:83], v[144:159]
  s_add_u32 m0, s44, 131072
  v_mfma_f32_32x32x16_bf16 v[160:175], v[72:75], v[80:83], v[160:175]
  s_add_u32 s46, s42, 2621440
  v_mfma_f32_32x32x16_bf16 v[176:191], v[76:79], v[80:83], v[176:191]
  buffer_load_dwordx4 v18, s[20:23], s46 offen lds
  v_mfma_f32_32x32x16_bf16 v[192:207], v[64:67], v[84:87], v[192:207]
  v_mfma_f32_32x32x16_bf16 v[208:223], v[68:71], v[84:87], v[208:223]
  s_add_u32 m0, s44, 139264
  v_mfma_f32_32x32x16_bf16 v[224:239], v[72:75], v[84:87], v[224:239]
  s_add_u32 s46, s42, 2752512
  v_mfma_f32_32x32x16_bf16 v[240:255], v[76:79], v[84:87], v[240:255]
  buffer_load_dwordx4 v18, s[20:23], s46 offen lds
  ds_read_b64_tr_b16 v[64:65], v10 offset:0
  ds_read_b64_tr_b16 v[66:67], v10 offset:2048
  ds_read_b64_tr_b16 v[68:69], v11 offset:0
  ds_read_b64_tr_b16 v[70:71], v11 offset:2048
  ds_read_b64_tr_b16 v[72:73], v12 offset:0
  ds_read_b64_tr_b16 v[74:75], v12 offset:2048
  ds_read_b64_tr_b16 v[76:77], v13 offset:0
  ds_read_b64_tr_b16 v[78:79], v13 offset:2048
  ds_read_b128 v[80:83], v14 offset:32768
  ds_read_b128 v[84:87], v14 offset:36864
  s_waitcnt lgkmcnt(10)
  v_mfma_f32_32x32x16_bf16 v[128:143], v[88:91], v[104:107], v[128:143]
  v_mfma_f32_32x32x16_bf16 v[144:159], v[92:95], v[104:107], v[144:159]
  s_add_u32 m0, s44, 81920
  v_mfma_f32_32x32x16_bf16 v[160:175], v[96:99], v[104:107], v[160:175]
  s_add_u32 s46, s43, 131712
  v_mfma_f32_32x32x16_bf16 v[176:191], v[100:103], v[104:107], v[176:191]
  buffer_load_dwordx4 v19, s[24:27], s46 offen lds
  v_mfma_f32_32x32x16_bf16 v[192:207], v[88:91], v[108:111], v[192:207]
  v_mfma_f32_32x32x16_bf16 v[208:223], v[92:95], v[108:111], v[208:223]
  s_add_u32 m0, s44, 90112
  v_mfma_f32_32x32x16_bf16 v[224:239], v[96:99], v[108:111], v[224:239]
  s_add_u32 s46, s43, 197248
  v_mfma_f32_32x32x16_bf16 v[240:255], v[100:103], v[108:111], v[240:255]
  buffer_load_dwordx4 v19, s[24:27], s46 offen lds
  s_waitcnt vmcnt(4)
  s_barrier
  ds_read_b64_tr_b16 v[88:89], v10 offset:8192
  ds_read_b64_tr_b16 v[90:91], v10 offset:10240
  ds_read_b64_tr_b16 v[92:93], v11 offset:8192
  ds_read_b64_tr_b16 v[94:95], v11 offset:10240
  ds_read_b64_tr_b16 v[96:97], v12 offset:8192
  ds_read_b64_tr_b16 v[98:99], v12 offset:10240
  ds_read_b64_tr_b16 v[100:101], v13 offset:8192
  ds_read_b64_tr_b16 v[102:103], v13 offset:10240
  ds_read_b128 v[104:107], v15 offset:32768
  ds_read_b128 v[108:111], v15 offset:36864
  s_waitcnt lgkmcnt(10)
  v_mfma_f32_32x32x16_bf16 v[128:143], v[64:67], v[80:83], v[128:143]
  v_mfma_f32_32x32x16_bf16 v[144:159], v[68:71], v[80:83], v[144:159]
  s_add_u32 m0, s44, 147456
  v_mfma_f32_32x32x16_bf16 v[160:175], v[72:75], v[80:83], v[160:175]
  s_add_u32 s46, s42, 2883584
  v_mfma_f32_32x32x16_bf16 v[176:191], v[76:79], v[80:83], v[176:191]
  buffer_load_dwordx4 v18, s[20:23], s46 offen lds
  v_mfma_f32_32x32x16_bf16 v[192:207], v[64:67], v[84:87], v[192:207]
  v_mfma_f32_32x32x16_bf16 v[208:223], v[68:71], v[84:87], v[208:223]
  s_add_u32 m0, s44, 155648
  v_mfma_f32_32x32x16_bf16 v[224:239], v[72:75], v[84:87], v[224:239]
  s_add_u32 s46, s42, 3014656
  v_mfma_f32_32x32x16_bf16 v[240:255], v[76:79], v[84:87], v[240:255]
  buffer_load_dwordx4 v18, s[20:23], s46 offen lds
  ds_read_b64_tr_b16 v[64:65], v10 offset:16384
  ds_read_b64_tr_b16 v[66:67], v10 offset:18432
  ds_read_b64_tr_b16 v[68:69], v11 offset:16384
  ds_read_b64_tr_b16 v[70:71], v11 offset:18432
  ds_read_b64_tr_b16 v[72:73], v12 offset:16384
  ds_read_b64_tr_b16 v[74:75], v12 offset:18432
  ds_read_b64_tr_b16 v[76:77], v13 offset:16384
  ds_read_b64_tr_b16 v[78:79], v13 offset:18432
  ds_read_b128 v[80:83], v16 offset:32768
  ds_read_b128 v[84:87], v16 offset:36864
  s_waitcnt lgkmcnt(10)
  v_mfma_f32_32x32x16_bf16 v[128:143], v[88:91], v[104:107], v[128:143]
  v_mfma_f32_32x32x16_bf16 v[144:159], v[92:95], v[104:107], v[144:159]
  s_add_u32 m0, s44, 0
  v_mfma_f32_32x32x16_bf16 v[160:175], v[96:99], v[104:107], v[160:175]
  s_add_u32 s46, s43, 768
  v_mfma_f32_32x32x16_bf16 v[176:191], v[100:103], v[104:107], v[176:191]
  buffer_load_dwordx4 v19, s[24:27], s46 offen lds
  v_mfma_f32_32x32x16_bf16 v[192:207], v[88:91], v[108:111], v[192:207]
  v_mfma_f32_32x32x16_bf16 v[208:223], v[92:95], v[108:111], v[208:223]
  s_add_u32 m0, s44, 8192
  v_mfma_f32_32x32x16_bf16 v[224:239], v[96:99], v[108:111], v[224:239]
  s_add_u32 s46, s43, 66304
  v_mfma_f32_32x32x16_bf16 v[240:255], v[100:103], v[108:111], v[240:255]
  buffer_load_dwordx4 v19, s[24:27], s46 offen lds
  s_waitcnt vmcnt(4)
  s_barrier
  ds_read_b64_tr_b16 v[88:89], v10 offset:24576
  ds_read_b64_tr_b16 v[90:91], v10 offset:26624
  ds_read_b64_tr_b16 v[92:93], v11 offset:24576
  ds_read_b64_tr_b16 v[94:95], v11 offset:26624
  ds_read_b64_tr_b16 v[96:97], v12 offset:24576
  ds_read_b64_tr_b16 v[98:99], v12 offset:26624
  ds_read_b64_tr_b16 v[100:101], v13 offset:24576
  ds_read_b64_tr_b16 v[102:103], v13 offset:26624
  ds_read_b128 v[104:107], v17 offset:32768
  ds_read_b128 v[108:111], v17 offset:36864
  s_waitcnt lgkmcnt(10)
  v_mfma_f32_32x32x16_bf16 v[128:143], v[64:67], v[80:83], v[128:143]
  v_mfma_f32_32x32x16_bf16 v[144:159], v[68:71], v[80:83], v[144:159]
  s_add_u32 m0, s44, 98304
  v_mfma_f32_32x32x16_bf16 v[160:175], v[72:75], v[80:83], v[160:175]
  s_add_u32 s46, s42, 3145728
  v_mfma_f32_32x32x16_bf16 v[176:191], v[76:79], v[80:83], v[176:191]
  buffer_load_dwordx4 v18, s[20:23], s46 offen lds
  v_mfma_f32_32x32x16_bf16 v[192:207], v[64:67], v[84:87], v[192:207]
  v_mfma_f32_32x32x16_bf16 v[208:223], v[68:71], v[84:87], v[208:223]
  s_add_u32 m0, s44, 106496
  v_mfma_f32_32x32x16_bf16 v[224:239], v[72:75], v[84:87], v[224:239]
  s_add_u32 s46, s42, 3276800
  v_mfma_f32_32x32x16_bf16 v[240:255], v[76:79], v[84:87], v[240:255]
  buffer_load_dwordx4 v18, s[20:23], s46 offen lds
  ds_read_b64_tr_b16 v[64:65], v10 offset:32768
  ds_read_b64_tr_b16 v[66:67], v10 offset:34816
  ds_read_b64_tr_b16 v[68:69], v11 offset:32768
  ds_read_b64_tr_b16 v[70:71], v11 offset:34816
  ds_read_b64_tr_b16 v[72:73], v12 offset:32768
  ds_read_b64_tr_b16 v[74:75], v12 offset:34816
  ds_read_b64_tr_b16 v[76:77], v13 offset:32768
  ds_read_b64_tr_b16 v[78:79], v13 offset:34816
  ds_read_b128 v[80:83], v4 offset:0
  ds_read_b128 v[84:87], v4 offset:4096
  s_waitcnt lgkmcnt(10)
  v_mfma_f32_32x32x16_bf16 v[128:143], v[88:91], v[104:107], v[128:143]
  v_mfma_f32_32x32x16_bf16 v[144:159], v[92:95], v[104:107], v[144:159]
  s_add_u32 m0, s44, 16384
  v_mfma_f32_32x32x16_bf16 v[160:175], v[96:99], v[104:107], v[160:175]
  s_add_u32 s46, s43, 131840
  v_mfma_f32_32x32x16_bf16 v[176:191], v[100:103], v[104:107], v[176:191]
  buffer_load_dwordx4 v19, s[24:27], s46 offen lds
  v_mfma_f32_32x32x16_bf16 v[192:207], v[88:91], v[108:111], v[192:207]
  v_mfma_f32_32x32x16_bf16 v[208:223], v[92:95], v[108:111], v[208:223]
  s_add_u32 m0, s44, 24576
  v_mfma_f32_32x32x16_bf16 v[224:239], v[96:99], v[108:111], v[224:239]
  s_add_u32 s46, s43, 197376
  v_mfma_f32_32x32x16_bf16 v[240:255], v[100:103], v[108:111], v[240:255]
  buffer_load_dwordx4 v19, s[24:27], s46 offen lds
  s_waitcnt vmcnt(4)
  s_barrier
  ds_read_b64_tr_b16 v[88:89], v10 offset:40960
  ds_read_b64_tr_b16 v[90:91], v10 offset:43008
  ds_read_b64_tr_b16 v[92:93], v11 offset:40960
  ds_read_b64_tr_b16 v[94:95], v11 offset:43008
  ds_read_b64_tr_b16 v[96:97], v12 offset:40960
  ds_read_b64_tr_b16 v[98:99], v12 offset:43008
  ds_read_b64_tr_b16 v[100:101], v13 offset:40960
  ds_read_b64_tr_b16 v[102:103], v13 offset:43008
  ds_read_b128 v[104:107], v5 offset:0
  ds_read_b128 v[108:111], v5 offset:4096
  s_waitcnt lgkmcnt(10)
  v_mfma_f32_32x32x16_bf16 v[128:143], v[64:67], v[80:83], v[128:143]
  v_mfma_f32_32x32x16_bf16 v[144:159], v[68:71], v[80:83], v[144:159]
  s_add_u32 m0, s44, 114688
  v_mfma_f32_32x32x16_bf16 v[160:175], v[72:75], v[80:83], v[160:175]
  s_add_u32 s46, s42, 3407872
  v_mfma_f32_32x32x16_bf16 v[176:191], v[76:79], v[80:83], v[176:191]
  buffer_load_dwordx4 v18, s[20:23], s46 offen lds
  v_mfma_f32_32x32x16_bf16 v[192:207], v[64:67], v[84:87], v[192:207]
  v_mfma_f32_32x32x16_bf16 v[208:223], v[68:71], v[84:87], v[208:223]
  s_add_u32 m0, s44, 122880
  v_mfma_f32_32x32x16_bf16 v[224:239], v[72:75], v[84:87], v[224:239]
  s_add_u32 s46, s42, 3538944
  v_mfma_f32_32x32x16_bf16 v[240:255], v[76:79], v[84:87], v[240:255]
  buffer_load_dwordx4 v18, s[20:23], s46 offen lds
  ds_read_b64_tr_b16 v[64:65], v10 offset:49152
  ds_read_b64_tr_b16 v[66:67], v10 offset:51200
  ds_read_b64_tr_b16 v[68:69], v11 offset:49152
  ds_read_b64_tr_b16 v[70:71], v11 offset:51200
  ds_read_b64_tr_b16 v[72:73], v12 offset:49152
  ds_read_b64_tr_b16 v[74:75], v12 offset:51200
  ds_read_b64_tr_b16 v[76:77], v13 offset:49152
  ds_read_b64_tr_b16 v[78:79], v13 offset:51200
  ds_read_b128 v[80:83], v6 offset:0
  ds_read_b128 v[84:87], v6 offset:4096
  s_waitcnt lgkmcnt(10)
  v_mfma_f32_32x32x16_bf16 v[128:143], v[88:91], v[104:107], v[128:143]
  v_mfma_f32_32x32x16_bf16 v[144:159], v[92:95], v[104:107], v[144:159]
  s_add_u32 m0, s44, 32768
  v_mfma_f32_32x32x16_bf16 v[160:175], v[96:99], v[104:107], v[160:175]
  s_add_u32 s46, s43, 896
  v_mfma_f32_32x32x16_bf16 v[176:191], v[100:103], v[104:107], v[176:191]
  buffer_load_dwordx4 v19, s[24:27], s46 offen lds
  v_mfma_f32_32x32x16_bf16 v[192:207], v[88:91], v[108:111], v[192:207]
  v_mfma_f32_32x32x16_bf16 v[208:223], v[92:95], v[108:111], v[208:223]
  s_add_u32 m0, s44, 40960
  v_mfma_f32_32x32x16_bf16 v[224:239], v[96:99], v[108:111], v[224:239]
  s_add_u32 s46, s43, 66432
  v_mfma_f32_32x32x16_bf16 v[240:255], v[100:103], v[108:111], v[240:255]
  buffer_load_dwordx4 v19, s[24:27], s46 offen lds
  s_waitcnt vmcnt(4)
  s_barrier
  ds_read_b64_tr_b16 v[88:89], v10 offset:57344
  ds_read_b64_tr_b16 v[90:91], v10 offset:59392
  ds_read_b64_tr_b16 v[92:93], v11 offset:57344
  ds_read_b64_tr_b16 v[94:95], v11 offset:59392
  ds_read_b64_tr_b16 v[96:97], v12 offset:57344
  ds_read_b64_tr_b16 v[98:99], v12 offset:59392
  ds_read_b64_tr_b16 v[100:101], v13 offset:57344
  ds_read_b64_tr_b16 v[102:103], v13 offset:59392
  ds_read_b128 v[104:107], v7 offset:0
  ds_read_b128 v[108:111], v7 offset:4096
  s_waitcnt lgkmcnt(10)
  v_mfma_f32_32x32x16_bf16 v[128:143], v[64:67], v[80:83], v[128:143]
  v_mfma_f32_32x32x16_bf16 v[144:159], v[68:71], v[80:83], v[144:159]
  s_add_u32 m0, s44, 131072
  v_mfma_f32_32x32x16_bf16 v[160:175], v[72:75], v[80:83], v[160:175]
  s_add_u32 s46, s42, 3670016
  v_mfma_f32_32x32x16_bf16 v[176:191], v[76:79], v[80:83], v[176:191]
  buffer_load_dwordx4 v18, s[20:23], s46 offen lds
  v_mfma_f32_32x32x16_bf16 v[192:207], v[64:67], v[84:87], v[192:207]
  v_mfma_f32_32x32x16_bf16 v[208:223], v[68:71], v[84:87], v[208:223]
  s_add_u32 m0, s44, 139264
  v_mfma_f32_32x32x16_bf16 v[224:239], v[72:75], v[84:87], v[224:239]
  s_add_u32 s46, s42, 3801088
  v_mfma_f32_32x32x16_bf16 v[240:255], v[76:79], v[84:87], v[240:255]
  buffer_load_dwordx4 v18, s[20:23], s46 offen lds
  ds_read_b64_tr_b16 v[64:65], v10 offset:0
  ds_read_b64_tr_b16 v[66:67], v10 offset:2048
  ds_read_b64_tr_b16 v[68:69], v11 offset:0
  ds_read_b64_tr_b16 v[70:71], v11 offset:2048
  ds_read_b64_tr_b16 v[72:73], v12 offset:0
  ds_read_b64_tr_b16 v[74:75], v12 offset:2048
  ds_read_b64_tr_b16 v[76:77], v13 offset:0
  ds_read_b64_tr_b16 v[78:79], v13 offset:2048
  ds_read_b128 v[80:83], v14 offset:0
  ds_read_b128 v[84:87], v14 offset:4096
  s_waitcnt lgkmcnt(10)
  v_mfma_f32_32x32x16_bf16 v[128:143], v[88:91], v[104:107], v[128:143]
  v_mfma_f32_32x32x16_bf16 v[144:159], v[92:95], v[104:107], v[144:159]
  s_add_u32 m0, s44, 49152
  v_mfma_f32_32x32x16_bf16 v[160:175], v[96:99], v[104:107], v[160:175]
  s_add_u32 s46, s43, 131968
  v_mfma_f32_32x32x16_bf16 v[176:191], v[100:103], v[104:107], v[176:191]
  buffer_load_dwordx4 v19, s[24:27], s46 offen lds
  v_mfma_f32_32x32x16_bf16 v[192:207], v[88:91], v[108:111], v[192:207]
  v_mfma_f32_32x32x16_bf16 v[208:223], v[92:95], v[108:111], v[208:223]
  s_add_u32 m0, s44, 57344
  v_mfma_f32_32x32x16_bf16 v[224:239], v[96:99], v[108:111], v[224:239]
  s_add_u32 s46, s43, 197504
  v_mfma_f32_32x32x16_bf16 v[240:255], v[100:103], v[108:111], v[240:255]
  buffer_load_dwordx4 v19, s[24:27], s46 offen lds
  s_waitcnt vmcnt(4)
  s_barrier
  ds_read_b64_tr_b16 v[88:89], v10 offset:8192
  ds_read_b64_tr_b16 v[90:91], v10 offset:10240
  ds_read_b64_tr_b16 v[92:93], v11 offset:8192
  ds_read_b64_tr_b16 v[94:95], v11 offset:10240
  ds_read_b64_tr_b16 v[96:97], v12 offset:8192
  ds_read_b64_tr_b16 v[98:99], v12 offset:10240
  ds_read_b64_tr_b16 v[100:101], v13 offset:8192
  ds_read_b64_tr_b16 v[102:103], v13 offset:10240
  ds_read_b128 v[104:107], v15 offset:0
  ds_read_b128 v[108:111], v15 offset:4096
  s_waitcnt lgkmcnt(10)
  v_mfma_f32_32x32x16_bf16 v[128:143], v[64:67], v[80:83], v[128:143]
  v_mfma_f32_32x32x16_bf16 v[144:159], v[68:71], v[80:83], v[144:159]
  s_add_u32 m0, s44, 147456
  v_mfma_f32_32x32x16_bf16 v[160:175], v[72:75], v[80:83], v[160:175]
  s_add_u32 s46, s42, 3932160
  v_mfma_f32_32x32x16_bf16 v[176:191], v[76:79], v[80:83], v[176:191]
  buffer_load_dwordx4 v18, s[20:23], s46 offen lds
  v_mfma_f32_32x32x16_bf16 v[192:207], v[64:67], v[84:87], v[192:207]
  v_mfma_f32_32x32x16_bf16 v[208:223], v[68:71], v[84:87], v[208:223]
  s_add_u32 m0, s44, 155648
  v_mfma_f32_32x32x16_bf16 v[224:239], v[72:75], v[84:87], v[224:239]
  s_add_u32 s46, s42, 4063232
  v_mfma_f32_32x32x16_bf16 v[240:255], v[76:79], v[84:87], v[240:255]
  buffer_load_dwordx4 v18, s[20:23], s46 offen lds
  ds_read_b64_tr_b16 v[64:65], v10 offset:16384
  ds_read_b64_tr_b16 v[66:67], v10 offset:18432
  ds_read_b64_tr_b16 v[68:69], v11 offset:16384
  ds_read_b64_tr_b16 v[70:71], v11 offset:18432
  ds_read_b64_tr_b16 v[72:73], v12 offset:16384
  ds_read_b64_tr_b16 v[74:75], v12 offset:18432
  ds_read_b64_tr_b16 v[76:77], v13 offset:16384
  ds_read_b64_tr_b16 v[78:79], v13 offset:18432
  ds_read_b128 v[80:83], v16 offset:0
  ds_read_b128 v[84:87], v16 offset:4096
  s_waitcnt lgkmcnt(10)
  v_mfma_f32_32x32x16_bf16 v[128:143], v[88:91], v[104:107], v[128:143]
  v_mfma_f32_32x32x16_bf16 v[144:159], v[92:95], v[104:107], v[144:159]
  v_mfma_f32_32x32x16_bf16 v[160:175], v[96:99], v[104:107], v[160:175]
  v_mfma_f32_32x32x16_bf16 v[176:191], v[100:103], v[104:107], v[176:191]
  v_mfma_f32_32x32x16_bf16 v[192:207], v[88:91], v[108:111], v[192:207]
  v_mfma_f32_32x32x16_bf16 v[208:223], v[92:95], v[108:111], v[208:223]
  v_mfma_f32_32x32x16_bf16 v[224:239], v[96:99], v[108:111], v[224:239]
  v_mfma_f32_32x32x16_bf16 v[240:255], v[100:103], v[108:111], v[240:255]
  s_waitcnt vmcnt(2)
  s_barrier
  ds_read_b64_tr_b16 v[88:89], v10 offset:24576
  ds_read_b64_tr_b16 v[90:91], v10 offset:26624
  ds_read_b64_tr_b16 v[92:93], v11 offset:24576
  ds_read_b64_tr_b16 v[94:95], v11 offset:26624
  ds_read_b64_tr_b16 v[96:97], v12 offset:24576
  ds_read_b64_tr_b16 v[98:99], v12 offset:26624
  ds_read_b64_tr_b16 v[100:101], v13 offset:24576
  ds_read_b64_tr_b16 v[102:103], v13 offset:26624
  ds_read_b128 v[104:107], v17 offset:0
  ds_read_b128 v[108:111], v17 offset:4096
  s_waitcnt lgkmcnt(10)
  v_mfma_f32_32x32x16_bf16 v[128:143], v[64:67], v[80:83], v[128:143]
  v_mfma_f32_32x32x16_bf16 v[144:159], v[68:71], v[80:83], v[144:159]
  v_mfma_f32_32x32x16_bf16 v[160:175], v[72:75], v[80:83], v[160:175]
  v_mfma_f32_32x32x16_bf16 v[176:191], v[76:79], v[80:83], v[176:191]
  v_mfma_f32_32x32x16_bf16 v[192:207], v[64:67], v[84:87], v[192:207]
  v_mfma_f32_32x32x16_bf16 v[208:223], v[68:71], v[84:87], v[208:223]
  v_mfma_f32_32x32x16_bf16 v[224:239], v[72:75], v[84:87], v[224:239]
  v_mfma_f32_32x32x16_bf16 v[240:255], v[76:79], v[84:87], v[240:255]
  ds_read_b64_tr_b16 v[64:65], v10 offset:32768
  ds_read_b64_tr_b16 v[66:67], v10 offset:34816
  ds_read_b64_tr_b16 v[68:69], v11 offset:32768
  ds_read_b64_tr_b16 v[70:71], v11 offset:34816
  ds_read_b64_tr_b16 v[72:73], v12 offset:32768
  ds_read_b64_tr_b16 v[74:75], v12 offset:34816
  ds_read_b64_tr_b16 v[76:77], v13 offset:32768
  ds_read_b64_tr_b16 v[78:79], v13 offset:34816
  ds_read_b128 v[80:83], v14 offset:32768
  ds_read_b128 v[84:87], v14 offset:36864
  s_waitcnt lgkmcnt(10)
  v_mfma_f32_32x32x16_bf16 v[128:143], v[88:91], v[104:107], v[128:143]
  v_mfma_f32_32x32x16_bf16 v[144:159], v[92:95], v[104:107], v[144:159]
  v_mfma_f32_32x32x16_bf16 v[160:175], v[96:99], v[104:107], v[160:175]
  v_mfma_f32_32x32x16_bf16 v[176:191], v[100:103], v[104:107], v[176:191]
  v_mfma_f32_32x32x16_bf16 v[192:207], v[88:91], v[108:111], v[192:207]
  v_mfma_f32_32x32x16_bf16 v[208:223], v[92:95], v[108:111], v[208:223]
  v_mfma_f32_32x32x16_bf16 v[224:239], v[96:99], v[108:111], v[224:239]
  v_mfma_f32_32x32x16_bf16 v[240:255], v[100:103], v[108:111], v[240:255]
  s_waitcnt vmcnt(0)
  s_barrier
  ds_read_b64_tr_b16 v[88:89], v10 offset:40960
  ds_read_b64_tr_b16 v[90:91], v10 offset:43008
  ds_read_b64_tr_b16 v[92:93], v11 offset:40960
  ds_read_b64_tr_b16 v[94:95], v11 offset:43008
  ds_read_b64_tr_b16 v[96:97], v12 offset:40960
  ds_read_b64_tr_b16 v[98:99], v12 offset:43008
  ds_read_b64_tr_b16 v[100:101], v13 offset:40960
  ds_read_b64_tr_b16 v[102:103], v13 offset:43008
  ds_read_b128 v[104:107], v15 offset:32768
  ds_read_b128 v[108:111], v15 offset:36864
  s_waitcnt lgkmcnt(10)
  v_mfma_f32_32x32x16_bf16 v[128:143], v[64:67], v[80:83], v[128:143]
  v_mfma_f32_32x32x16_bf16 v[144:159], v[68:71], v[80:83], v[144:159]
  v_mfma_f32_32x32x16_bf16 v[160:175], v[72:75], v[80:83], v[160:175]
  v_mfma_f32_32x32x16_bf16 v[176:191], v[76:79], v[80:83], v[176:191]
  v_mfma_f32_32x32x16_bf16 v[192:207], v[64:67], v[84:87], v[192:207]
  v_mfma_f32_32x32x16_bf16 v[208:223], v[68:71], v[84:87], v[208:223]
  v_mfma_f32_32x32x16_bf16 v[224:239], v[72:75], v[84:87], v[224:239]
  v_mfma_f32_32x32x16_bf16 v[240:255], v[76:79], v[84:87], v[240:255]
  ds_read_b64_tr_b16 v[64:65], v10 offset:49152
  ds_read_b64_tr_b16 v[66:67], v10 offset:51200
  ds_read_b64_tr_b16 v[68:69], v11 offset:49152
  ds_read_b64_tr_b16 v[70:71], v11 offset:51200
  ds_read_b64_tr_b16 v[72:73], v12 offset:49152
  ds_read_b64_tr_b16 v[74:75], v12 offset:51200
  ds_read_b64_tr_b16 v[76:77], v13 offset:49152
  ds_read_b64_tr_b16 v[78:79], v13 offset:51200
  ds_read_b128 v[80:83], v16 offset:32768
  ds_read_b128 v[84:87], v16 offset:36864
  s_waitcnt lgkmcnt(10)
  v_mfma_f32_32x32x16_bf16 v[128:143], v[88:91], v[104:107], v[128:143]
  v_mfma_f32_32x32x16_bf16 v[144:159], v[92:95], v[104:107], v[144:159]
  v_mfma_f32_32x32x16_bf16 v[160:175], v[96:99], v[104:107], v[160:175]
  v_mfma_f32_32x32x16_bf16 v[176:191], v[100:103], v[104:107], v[176:191]
  v_mfma_f32_32x32x16_bf16 v[192:207], v[88:91], v[108:111], v[192:207]
  v_mfma_f32_32x32x16_bf16 v[208:223], v[92:95], v[108:111], v[208:223]
  v_mfma_f32_32x32x16_bf16 v[224:239], v[96:99], v[108:111], v[224:239]
  v_mfma_f32_32x32x16_bf16 v[240:255], v[100:103], v[108:111], v[240:255]
  s_waitcnt vmcnt(0)
  s_barrier
  ds_read_b64_tr_b16 v[88:89], v10 offset:57344
  ds_read_b64_tr_b16 v[90:91], v10 offset:59392
  ds_read_b64_tr_b16 v[92:93], v11 offset:57344
  ds_read_b64_tr_b16 v[94:95], v11 offset:59392
  ds_read_b64_tr_b16 v[96:97], v12 offset:57344
  ds_read_b64_tr_b16 v[98:99], v12 offset:59392
  ds_read_b64_tr_b16 v[100:101], v13 offset:57344
  ds_read_b64_tr_b16 v[102:103], v13 offset:59392
  ds_read_b128 v[104:107], v17 offset:32768
  ds_read_b128 v[108:111], v17 offset:36864
  s_waitcnt lgkmcnt(10)
  v_mfma_f32_32x32x16_bf16 v[128:143], v[64:67], v[80:83], v[128:143]
  v_mfma_f32_32x32x16_bf16 v[144:159], v[68:71], v[80:83], v[144:159]
  v_mfma_f32_32x32x16_bf16 v[160:175], v[72:75], v[80:83], v[160:175]
  v_mfma_f32_32x32x16_bf16 v[176:191], v[76:79], v[80:83], v[176:191]
  v_mfma_f32_32x32x16_bf16 v[192:207], v[64:67], v[84:87], v[192:207]
  v_mfma_f32_32x32x16_bf16 v[208:223], v[68:71], v[84:87], v[208:223]
  v_mfma_f32_32x32x16_bf16 v[224:239], v[72:75], v[84:87], v[224:239]
  v_mfma_f32_32x32x16_bf16 v[240:255], v[76:79], v[84:87], v[240:255]
  s_waitcnt lgkmcnt(0)
  v_mfma_f32_32x32x16_bf16 v[128:143], v[88:91], v[104:107], v[128:143]
  v_mfma_f32_32x32x16_bf16 v[144:159], v[92:95], v[104:107], v[144:159]
  v_mfma_f32_32x32x16_bf16 v[160:175], v[96:99], v[104:107], v[160:175]
  v_mfma_f32_32x32x16_bf16 v[176:191], v[100:103], v[104:107], v[176:191]
  v_mfma_f32_32x32x16_bf16 v[192:207], v[88:91], v[108:111], v[192:207]
  v_mfma_f32_32x32x16_bf16 v[208:223], v[92:95], v[108:111], v[208:223]
  v_mfma_f32_32x32x16_bf16 v[224:239], v[96:99], v[108:111], v[224:239]
  v_mfma_f32_32x32x16_bf16 v[240:255], v[100:103], v[108:111], v[240:255]
  s_mov_b32 s56, s52
  s_and_b32 s57, s53, 0xffff
  s_mov_b32 s58, 4194304
  s_mov_b32 s59, 0x20000
  s_cmp_ge_u32 s3, 2
  s_cbranch_scc1 k1_kernel_pf2
  s_lshr_b32 s50, s2, 3
  s_lshl_b32 s50, s50, 1
  s_add_u32 s50, s50, s3
  s_lshl_b32 s50, s50, 16
  s_lshl_b32 s51, s17, 10
  s_add_u32 s50, s50, s51
  v_lshrrev_b32 v20, 3, v1
  v_lshlrev_b32 v20, 13, v20
  v_and_b32 v21, 7, v1
  v_lshl_add_u32 v20, v21, 7, v20
  buffer_load_dword v21, v20, s[56:59], s50 offen
k1_kernel_pf2:
  s_lshl_b32 s50, s16, 1
  s_add_u32 s50, s50, s40
  s_lshl_b32 s50, s50, 5
  s_lshl_b32 s51, s14, 2
  s_add_u32 s50, s50, s51
  s_lshr_b32 s51, s3, 1
  s_add_u32 s50, s50, s51
  s_lshl_b32 s50, s50, 15
  v_lshlrev_b32 v20, 4, v1
  v_cvt_pk_bf16_f32 v64, v128, v129
  v_cvt_pk_bf16_f32 v65, v130, v131
  v_cvt_pk_bf16_f32 v66, v132, v133
  v_cvt_pk_bf16_f32 v67, v134, v135
  s_add_u32 s51, s50, 0
  buffer_store_dwordx4 v[64:67], v20, s[36:39], s51 offen
  v_cvt_pk_bf16_f32 v68, v136, v137
  v_cvt_pk_bf16_f32 v69, v138, v139
  v_cvt_pk_bf16_f32 v70, v140, v141
  v_cvt_pk_bf16_f32 v71, v142, v143
  s_add_u32 s51, s50, 1024
  buffer_store_dwordx4 v[68:71], v20, s[36:39], s51 offen
  v_cvt_pk_bf16_f32 v72, v144, v145
  v_cvt_pk_bf16_f32 v73, v146, v147
  v_cvt_pk_bf16_f32 v74, v148, v149
  v_cvt_pk_bf16_f32 v75, v150, v151
  s_add_u32 s51, s50, 2048
  buffer_store_dwordx4 v[72:75], v20, s[36:39], s51 offen
  v_cvt_pk_bf16_f32 v76, v152, v153
  v_cvt_pk_bf16_f32 v77, v154, v155
  v_cvt_pk_bf16_f32 v78, v156, v157
  v_cvt_pk_bf16_f32 v79, v158, v159
  s_add_u32 s51, s50, 3072
  buffer_store_dwordx4 v[76:79], v20, s[36:39], s51 offen
  v_cvt_pk_bf16_f32 v80, v160, v161
  v_cvt_pk_bf16_f32 v81, v162, v163
  v_cvt_pk_bf16_f32 v82, v164, v165
  v_cvt_pk_bf16_f32 v83, v166, v167
  s_add_u32 s51, s50, 4096
  buffer_store_dwordx4 v[80:83], v20, s[36:39], s51 offen
  v_cvt_pk_bf16_f32 v84, v168, v169
  v_cvt_pk_bf16_f32 v85, v170, v171
  v_cvt_pk_bf16_f32 v86, v172, v173
  v_cvt_pk_bf16_f32 v87, v174, v175
  s_add_u32 s51, s50, 5120
  buffer_store_dwordx4 v[84:87], v20, s[36:39], s51 offen
  v_cvt_pk_bf16_f32 v88, v176, v177
  v_cvt_pk_bf16_f32 v89, v178, v179
  v_cvt_pk_bf16_f32 v90, v180, v181
  v_cvt_pk_bf16_f32 v91, v182, v183
  s_add_u32 s51, s50, 6144
  buffer_store_dwordx4 v[88:91], v20, s[36:39], s51 offen
  v_cvt_pk_bf16_f32 v92, v184, v185
  v_cvt_pk_bf16_f32 v93, v186, v187
  v_cvt_pk_bf16_f32 v94, v188, v189
  v_cvt_pk_bf16_f32 v95, v190, v191
  s_add_u32 s51, s50, 7168
  buffer_store_dwordx4 v[92:95], v20, s[36:39], s51 offen
  v_cvt_pk_bf16_f32 v64, v192, v193
  v_cvt_pk_bf16_f32 v65, v194, v195
  v_cvt_pk_bf16_f32 v66, v196, v197
  v_cvt_pk_bf16_f32 v67, v198, v199
  s_add_u32 s51, s50, 8192
  buffer_store_dwordx4 v[64:67], v20, s[36:39], s51 offen
  v_cvt_pk_bf16_f32 v68, v200, v201
  v_cvt_pk_bf16_f32 v69, v202, v203
  v_cvt_pk_bf16_f32 v70, v204, v205
  v_cvt_pk_bf16_f32 v71, v206, v207
  s_add_u32 s51, s50, 9216
  buffer_store_dwordx4 v[68:71], v20, s[36:39], s51 offen
  v_cvt_pk_bf16_f32 v72, v208, v209
  v_cvt_pk_bf16_f32 v73, v210, v211
  v_cvt_pk_bf16_f32 v74, v212, v213
  v_cvt_pk_bf16_f32 v75, v214, v215
  s_add_u32 s51, s50, 10240
  buffer_store_dwordx4 v[72:75], v20, s[36:39], s51 offen
  v_cvt_pk_bf16_f32 v76, v216, v217
  v_cvt_pk_bf16_f32 v77, v218, v219
  v_cvt_pk_bf16_f32 v78, v220, v221
  v_cvt_pk_bf16_f32 v79, v222, v223
  s_add_u32 s51, s50, 11264
  buffer_store_dwordx4 v[76:79], v20, s[36:39], s51 offen
  v_cvt_pk_bf16_f32 v80, v224, v225
  v_cvt_pk_bf16_f32 v81, v226, v227
  v_cvt_pk_bf16_f32 v82, v228, v229
  v_cvt_pk_bf16_f32 v83, v230, v231
  s_add_u32 s51, s50, 12288
  buffer_store_dwordx4 v[80:83], v20, s[36:39], s51 offen
  v_cvt_pk_bf16_f32 v84, v232, v233
  v_cvt_pk_bf16_f32 v85, v234, v235
  v_cvt_pk_bf16_f32 v86, v236, v237
  v_cvt_pk_bf16_f32 v87, v238, v239
  s_add_u32 s51, s50, 13312
  buffer_store_dwordx4 v[84:87], v20, s[36:39], s51 offen
  v_cvt_pk_bf16_f32 v88, v240, v241
  v_cvt_pk_bf16_f32 v89, v242, v243
  v_cvt_pk_bf16_f32 v90, v244, v245
  v_cvt_pk_bf16_f32 v91, v246, v247
  s_add_u32 s51, s50, 14336
  buffer_store_dwordx4 v[88:91], v20, s[36:39], s51 offen
  v_cvt_pk_bf16_f32 v92, v248, v249
  v_cvt_pk_bf16_f32 v93, v250, v251
  v_cvt_pk_bf16_f32 v94, v252, v253
  v_cvt_pk_bf16_f32 v95, v254, v255
  s_add_u32 s51, s50, 15360
  buffer_store_dwordx4 v[92:95], v20, s[36:39], s51 offen
  s_waitcnt vmcnt(0)
  s_branch k1_kernel_end
k1_kernel_v1:
  s_waitcnt vmcnt(5)
  s_barrier
  ds_read_b64_tr_b16 v[64:65], v10 offset:0
  ds_read_b64_tr_b16 v[66:67], v10 offset:2048
  ds_read_b64_tr_b16 v[68:69], v11 offset:0
  ds_read_b64_tr_b16 v[70:71], v11 offset:2048
  ds_read_b64_tr_b16 v[72:73], v12 offset:0
  ds_read_b64_tr_b16 v[74:75], v12 offset:2048
  ds_read_b64_tr_b16 v[76:77], v13 offset:0
  ds_read_b64_tr_b16 v[78:79], v13 offset:2048
  ds_read_b128 v[80:83], v14 offset:0
  ds_read_b128 v[84:87], v14 offset:4096
  ds_read_b64_tr_b16 v[88:89], v10 offset:8192
  ds_read_b64_tr_b16 v[90:91], v10 offset:10240
  ds_read_b64_tr_b16 v[92:93], v11 offset:8192
  ds_read_b64_tr_b16 v[94:95], v11 offset:10240
  ds_read_b64_tr_b16 v[96:97], v12 offset:8192
  ds_read_b64_tr_b16 v[98:99], v12 offset:10240
  ds_read_b64_tr_b16 v[100:101], v13 offset:8192
  ds_read_b64_tr_b16 v[102:103], v13 offset:10240
  ds_read_b128 v[104:107], v15 offset:0
  ds_read_b128 v[108:111], v15 offset:4096
  s_waitcnt lgkmcnt(10)
  v_mfma_f32_32x32x16_bf16 v[128:143], v[80:83], v[64:67], 0
  v_mfma_f32_32x32x16_bf16 v[144:159], v[80:83], v[68:71], 0
  s_add_u32 m0, s44, 147456
  v_mfma_f32_32x32x16_bf16 v[160:175], v[80:83], v[72:75], 0
  s_add_u32 s46, s42, 786432
  v_mfma_f32_32x32x16_bf16 v[176:191], v[80:83], v[76:79], 0
  buffer_load_dwordx4 v18, s[20:23], s46 offen lds
  v_mfma_f32_32x32x16_bf16 v[192:207], v[84:87], v[64:67], 0
  v_mfma_f32_32x32x16_bf16 v[208:223], v[84:87], v[68:71], 0
  s_add_u32 m0, s44, 155648
  v_mfma_f32_32x32x16_bf16 v[224:239], v[84:87], v[72:75], 0
  s_add_u32 s46, s42, 917504
  v_mfma_f32_32x32x16_bf16 v[240:255], v[84:87], v[76:79], 0
  buffer_load_dwordx4 v18, s[20:23], s46 offen lds
  ds_read_b64_tr_b16 v[64:65], v10 offset:16384
  ds_read_b64_tr_b16 v[66:67], v10 offset:18432
  ds_read_b64_tr_b16 v[68:69], v11 offset:16384
  ds_read_b64_tr_b16 v[70:71], v11 offset:18432
  ds_read_b64_tr_b16 v[72:73], v12 offset:16384
  ds_read_b64_tr_b16 v[74:75], v12 offset:18432
  ds_read_b64_tr_b16 v[76:77], v13 offset:16384
  ds_read_b64_tr_b16 v[78:79], v13 offset:18432
  ds_read_b128 v[80:83], v16 offset:0
  ds_read_b128 v[84:87], v16 offset:4096
  s_waitcnt lgkmcnt(10)
  v_mfma_f32_32x32x16_bf16 v[128:143], v[104:107], v[88:91], v[128:143]
  v_mfma_f32_32x32x16_bf16 v[144:159], v[104:107], v[92:95], v[144:159]
  s_add_u32 m0, s44, 65536
  v_mfma_f32_32x32x16_bf16 v[160:175], v[104:107], v[96:99], v[160:175]
  s_add_u32 s46, s43, 256
  v_mfma_f32_32x32x16_bf16 v[176:191], v[104:107], v[100:103], v[176:191]
  buffer_load_dwordx4 v19, s[24:27], s46 offen lds
  v_mfma_f32_32x32x16_bf16 v[192:207], v[108:111], v[88:91], v[192:207]
  v_mfma_f32_32x32x16_bf16 v[208:223], v[108:111], v[92:95], v[208:223]
  s_add_u32 m0, s44, 73728
  v_mfma_f32_32x32x16_bf16 v[224:239], v[108:111], v[96:99], v[224:239]
  s_add_u32 s46, s43, 65792
  v_mfma_f32_32x32x16_bf16 v[240:255], v[108:111], v[100:103], v[240:255]
  buffer_load_dwordx4 v19, s[24:27], s46 offen lds
  s_waitcnt vmcnt(4)
  s_barrier
  ds_read_b64_tr_b16 v[88:89], v10 offset:24576
  ds_read_b64_tr_b16 v[90:91], v10 offset:26624
  ds_read_b64_tr_b16 v[92:93], v11 offset:24576
  ds_read_b64_tr_b16 v[94:95], v11 offset:26624
  ds_read_b64_tr_b16 v[96:97], v12 offset:24576
  ds_read_b64_tr_b16 v[98:99], v12 offset:26624
  ds_read_b64_tr_b16 v[100:101], v13 offset:24576
  ds_read_b64_tr_b16 v[102:103], v13 offset:26624
  ds_read_b128 v[104:107], v17 offset:0
  ds_read_b128 v[108:111], v17 offset:4096
  s_waitcnt lgkmcnt(10)
  v_mfma_f32_32x32x16_bf16 v[128:143], v[80:83], v[64:67], v[128:143]
  v_mfma_f32_32x32x16_bf16 v[144:159], v[80:83], v[68:71], v[144:159]
  s_add_u32 m0, s44, 98304
  v_mfma_f32_32x32x16_bf16 v[160:175], v[80:83], v[72:75], v[160:175]
  s_add_u32 s46, s42, 1048576
  v_mfma_f32_32x32x16_bf16 v[176:191], v[80:83], v[76:79], v[176:191]
  buffer_load_dwordx4 v18, s[20:23], s46 offen lds
  v_mfma_f32_32x32x16_bf16 v[192:207], v[84:87], v[64:67], v[192:207]
  v_mfma_f32_32x32x16_bf16 v[208:223], v[84:87], v[68:71], v[208:223]
  s_add_u32 m0, s44, 106496
  v_mfma_f32_32x32x16_bf16 v[224:239], v[84:87], v[72:75], v[224:239]
  s_add_u32 s46, s42, 1179648
  v_mfma_f32_32x32x16_bf16 v[240:255], v[84:87], v[76:79], v[240:255]
  buffer_load_dwordx4 v18, s[20:23], s46 offen lds
  ds_read_b64_tr_b16 v[64:65], v10 offset:32768
  ds_read_b64_tr_b16 v[66:67], v10 offset:34816
  ds_read_b64_tr_b16 v[68:69], v11 offset:32768
  ds_read_b64_tr_b16 v[70:71], v11 offset:34816
  ds_read_b64_tr_b16 v[72:73], v12 offset:32768
  ds_read_b64_tr_b16 v[74:75], v12 offset:34816
  ds_read_b64_tr_b16 v[76:77], v13 offset:32768
  ds_read_b64_tr_b16 v[78:79], v13 offset:34816
  ds_read_b128 v[80:83], v14 offset:32768
  ds_read_b128 v[84:87], v14 offset:36864
  s_waitcnt lgkmcnt(10)
  v_mfma_f32_32x32x16_bf16 v[128:143], v[104:107], v[88:91], v[128:143]
  v_mfma_f32_32x32x16_bf16 v[144:159], v[104:107], v[92:95], v[144:159]
  s_add_u32 m0, s44, 81920
  v_mfma_f32_32x32x16_bf16 v[160:175], v[104:107], v[96:99], v[160:175]
  s_add_u32 s46, s43, 131328
  v_mfma_f32_32x32x16_bf16 v[176:191], v[104:107], v[100:103], v[176:191]
  buffer_load_dwordx4 v19, s[24:27], s46 offen lds
  v_mfma_f32_32x32x16_bf16 v[192:207], v[108:111], v[88:91], v[192:207]
  v_mfma_f32_32x32x16_bf16 v[208:223], v[108:111], v[92:95], v[208:223]
  s_add_u32 m0, s44, 90112
  v_mfma_f32_32x32x16_bf16 v[224:239], v[108:111], v[96:99], v[224:239]
  s_add_u32 s46, s43, 196864
  v_mfma_f32_32x32x16_bf16 v[240:255], v[108:111], v[100:103], v[240:255]
  buffer_load_dwordx4 v19, s[24:27], s46 offen lds
  s_waitcnt vmcnt(4)
  s_barrier
  ds_read_b64_tr_b16 v[88:89], v10 offset:40960
  ds_read_b64_tr_b16 v[90:91], v10 offset:43008
  ds_read_b64_tr_b16 v[92:93], v11 offset:40960
  ds_read_b64_tr_b16 v[94:95], v11 offset:43008
  ds_read_b64_tr_b16 v[96:97], v12 offset:40960
  ds_read_b64_tr_b16 v[98:99], v12 offset:43008
  ds_read_b64_tr_b16 v[100:101], v13 offset:40960
  ds_read_b64_tr_b16 v[102:103], v13 offset:43008
  ds_read_b128 v[104:107], v15 offset:32768
  ds_read_b128 v[108:111], v15 offset:36864
  s_waitcnt lgkmcnt(10)
  v_mfma_f32_32x32x16_bf16 v[128:143], v[80:83], v[64:67], v[128:143]
  v_mfma_f32_32x32x16_bf16 v[144:159], v[80:83], v[68:71], v[144:159]
  s_add_u32 m0, s44, 114688
  v_mfma_f32_32x32x16_bf16 v[160:175], v[80:83], v[72:75], v[160:175]
  s_add_u32 s46, s42, 1310720
  v_mfma_f32_32x32x16_bf16 v[176:191], v[80:83], v[76:79], v[176:191]
  buffer_load_dwordx4 v18, s[20:23], s46 offen lds
  v_mfma_f32_32x32x16_bf16 v[192:207], v[84:87], v[64:67], v[192:207]
  v_mfma_f32_32x32x16_bf16 v[208:223], v[84:87], v[68:71], v[208:223]
  s_add_u32 m0, s44, 122880
  v_mfma_f32_32x32x16_bf16 v[224:239], v[84:87], v[72:75], v[224:239]
  s_add_u32 s46, s42, 1441792
  v_mfma_f32_32x32x16_bf16 v[240:255], v[84:87], v[76:79], v[240:255]
  buffer_load_dwordx4 v18, s[20:23], s46 offen lds
  ds_read_b64_tr_b16 v[64:65], v10 offset:49152
  ds_read_b64_tr_b16 v[66:67], v10 offset:51200
  ds_read_b64_tr_b16 v[68:69], v11 offset:49152
  ds_read_b64_tr_b16 v[70:71], v11 offset:51200
  ds_read_b64_tr_b16 v[72:73], v12 offset:49152
  ds_read_b64_tr_b16 v[74:75], v12 offset:51200
  ds_read_b64_tr_b16 v[76:77], v13 offset:49152
  ds_read_b64_tr_b16 v[78:79], v13 offset:51200
  ds_read_b128 v[80:83], v16 offset:32768
  ds_read_b128 v[84:87], v16 offset:36864
  s_waitcnt lgkmcnt(10)
  v_mfma_f32_32x32x16_bf16 v[128:143], v[104:107], v[88:91], v[128:143]
  v_mfma_f32_32x32x16_bf16 v[144:159], v[104:107], v[92:95], v[144:159]
  s_add_u32 m0, s44, 0
  v_mfma_f32_32x32x16_bf16 v[160:175], v[104:107], v[96:99], v[160:175]
  s_add_u32 s46, s43, 384
  v_mfma_f32_32x32x16_bf16 v[176:191], v[104:107], v[100:103], v[176:191]
  buffer_load_dwordx4 v19, s[24:27], s46 offen lds
  v_mfma_f32_32x32x16_bf16 v[192:207], v[108:111], v[88:91], v[192:207]
  v_mfma_f32_32x32x16_bf16 v[208:223], v[108:111], v[92:95], v[208:223]
  s_add_u32 m0, s44, 8192
  v_mfma_f32_32x32x16_bf16 v[224:239], v[108:111], v[96:99], v[224:239]
  s_add_u32 s46, s43, 65920
  v_mfma_f32_32x32x16_bf16 v[240:255], v[108:111], v[100:103], v[240:255]
  buffer_load_dwordx4 v19, s[24:27], s46 offen lds
  s_waitcnt vmcnt(4)
  s_barrier
  ds_read_b64_tr_b16 v[88:89], v10 offset:57344
  ds_read_b64_tr_b16 v[90:91], v10 offset:59392
  ds_read_b64_tr_b16 v[92:93], v11 offset:57344
  ds_read_b64_tr_b16 v[94:95], v11 offset:59392
  ds_read_b64_tr_b16 v[96:97], v12 offset:57344
  ds_read_b64_tr_b16 v[98:99], v12 offset:59392
  ds_read_b64_tr_b16 v[100:101], v13 offset:57344
  ds_read_b64_tr_b16 v[102:103], v13 offset:59392
  ds_read_b128 v[104:107], v17 offset:32768
  ds_read_b128 v[108:111], v17 offset:36864
  s_waitcnt lgkmcnt(10)
  v_mfma_f32_32x32x16_bf16 v[128:143], v[80:83], v[64:67], v[128:143]
  v_mfma_f32_32x32x16_bf16 v[144:159], v[80:83], v[68:71], v[144:159]
  s_add_u32 m0, s44, 131072
  v_mfma_f32_32x32x16_bf16 v[160:175], v[80:83], v[72:75], v[160:175]
  s_add_u32 s46, s42, 1572864
  v_mfma_f32_32x32x16_bf16 v[176:191], v[80:83], v[76:79], v[176:191]
  buffer_load_dwordx4 v18, s[20:23], s46 offen lds
  v_mfma_f32_32x32x16_bf16 v[192:207], v[84:87], v[64:67], v[192:207]
  v_mfma_f32_32x32x16_bf16 v[208:223], v[84:87], v[68:71], v[208:223]
  s_add_u32 m0, s44, 139264
  v_mfma_f32_32x32x16_bf16 v[224:239], v[84:87], v[72:75], v[224:239]
  s_add_u32 s46, s42, 1703936
  v_mfma_f32_32x32x16_bf16 v[240:255], v[84:87], v[76:79], v[240:255]
  buffer_load_dwordx4 v18, s[20:23], s46 offen lds
  ds_read_b64_tr_b16 v[64:65], v10 offset:0
  ds_read_b64_tr_b16 v[66:67], v10 offset:2048
  ds_read_b64_tr_b16 v[68:69], v11 offset:0
  ds_read_b64_tr_b16 v[70:71], v11 offset:2048
  ds_read_b64_tr_b16 v[72:73], v12 offset:0
  ds_read_b64_tr_b16 v[74:75], v12 offset:2048
  ds_read_b64_tr_b16 v[76:77], v13 offset:0
  ds_read_b64_tr_b16 v[78:79], v13 offset:2048
  ds_read_b128 v[80:83], v4 offset:0
  ds_read_b128 v[84:87], v4 offset:4096
  s_waitcnt lgkmcnt(10)
  v_mfma_f32_32x32x16_bf16 v[128:143], v[104:107], v[88:91], v[128:143]
  v_mfma_f32_32x32x16_bf16 v[144:159], v[104:107], v[92:95], v[144:159]
  s_add_u32 m0, s44, 16384
  v_mfma_f32_32x32x16_bf16 v[160:175], v[104:107], v[96:99], v[160:175]
  s_add_u32 s46, s43, 131456
  v_mfma_f32_32x32x16_bf16 v[176:191], v[104:107], v[100:103], v[176:191]
  buffer_load_dwordx4 v19, s[24:27], s46 offen lds
  v_mfma_f32_32x32x16_bf16 v[192:207], v[108:111], v[88:91], v[192:207]
  v_mfma_f32_32x32x16_bf16 v[208:223], v[108:111], v[92:95], v[208:223]
  s_add_u32 m0, s44, 24576
  v_mfma_f32_32x32x16_bf16 v[224:239], v[108:111], v[96:99], v[224:239]
  s_add_u32 s46, s43, 196992
  v_mfma_f32_32x32x16_bf16 v[240:255], v[108:111], v[100:103], v[240:255]
  buffer_load_dwordx4 v19, s[24:27], s46 offen lds
  s_waitcnt vmcnt(4)
  s_barrier
  ds_read_b64_tr_b16 v[88:89], v10 offset:8192
  ds_read_b64_tr_b16 v[90:91], v10 offset:10240
  ds_read_b64_tr_b16 v[92:93], v11 offset:8192
  ds_read_b64_tr_b16 v[94:95], v11 offset:10240
  ds_read_b64_tr_b16 v[96:97], v12 offset:8192
  ds_read_b64_tr_b16 v[98:99], v12 offset:10240
  ds_read_b64_tr_b16 v[100:101], v13 offset:8192
  ds_read_b64_tr_b16 v[102:103], v13 offset:10240
  ds_read_b128 v[104:107], v5 offset:0
  ds_read_b128 v[108:111], v5 offset:4096
  s_waitcnt lgkmcnt(10)
  v_mfma_f32_32x32x16_bf16 v[128:143], v[80:83], v[64:67], v[128:143]
  v_mfma_f32_32x32x16_bf16 v[144:159], v[80:83], v[68:71], v[144:159]
  s_add_u32 m0, s44, 147456
  v_mfma_f32_32x32x16_bf16 v[160:175], v[80:83], v[72:75], v[160:175]
  s_add_u32 s46, s42, 1835008
  v_mfma_f32_32x32x16_bf16 v[176:191], v[80:83], v[76:79], v[176:191]
  buffer_load_dwordx4 v18, s[20:23], s46 offen lds
  v_mfma_f32_32x32x16_bf16 v[192:207], v[84:87], v[64:67], v[192:207]
  v_mfma_f32_32x32x16_bf16 v[208:223], v[84:87], v[68:71], v[208:223]
  s_add_u32 m0, s44, 155648
  v_mfma_f32_32x32x16_bf16 v[224:239], v[84:87], v[72:75], v[224:239]
  s_add_u32 s46, s42, 1966080
  v_mfma_f32_32x32x16_bf16 v[240:255], v[84:87], v[76:79], v[240:255]
  buffer_load_dwordx4 v18, s[20:23], s46 offen lds
  ds_read_b64_tr_b16 v[64:65], v10 offset:16384
  ds_read_b64_tr_b16 v[66:67], v10 offset:18432
  ds_read_b64_tr_b16 v[68:69], v11 offset:16384
  ds_read_b64_tr_b16 v[70:71], v11 offset:18432
  ds_read_b64_tr_b16 v[72:73], v12 offset:16384
  ds_read_b64_tr_b16 v[74:75], v12 offset:18432
  ds_read_b64_tr_b16 v[76:77], v13 offset:16384
  ds_read_b64_tr_b16 v[78:79], v13 offset:18432
  ds_read_b128 v[80:83], v6 offset:0
  ds_read_b128 v[84:87], v6 offset:4096
  s_waitcnt lgkmcnt(10)
  v_mfma_f32_32x32x16_bf16 v[128:143], v[104:107], v[88:91], v[128:143]
  v_mfma_f32_32x32x16_bf16 v[144:159], v[104:107], v[92:95], v[144:159]
  s_add_u32 m0, s44, 32768
  v_mfma_f32_32x32x16_bf16 v[160:175], v[104:107], v[96:99], v[160:175]
  s_add_u32 s46, s43, 512
  v_mfma_f32_32x32x16_bf16 v[176:191], v[104:107], v[100:103], v[176:191]
  buffer_load_dwordx4 v19, s[24:27], s46 offen lds
  v_mfma_f32_32x32x16_bf16 v[192:207], v[108:111], v[88:91], v[192:207]
  v_mfma_f32_32x32x16_bf16 v[208:223], v[108:111], v[92:95], v[208:223]
  s_add_u32 m0, s44, 40960
  v_mfma_f32_32x32x16_bf16 v[224:239], v[108:111], v[96:99], v[224:239]
  s_add_u32 s46, s43, 66048
  v_mfma_f32_32x32x16_bf16 v[240:255], v[108:111], v[100:103], v[240:255]
  buffer_load_dwordx4 v19, s[24:27], s46 offen lds
  s_waitcnt vmcnt(4)
  s_barrier
  ds_read_b64_tr_b16 v[88:89], v10 offset:24576
  ds_read_b64_tr_b16 v[90:91], v10 offset:26624
  ds_read_b64_tr_b16 v[92:93], v11 offset:24576
  ds_read_b64_tr_b16 v[94:95], v11 offset:26624
  ds_read_b64_tr_b16 v[96:97], v12 offset:24576
  ds_read_b64_tr_b16 v[98:99], v12 offset:26624
  ds_read_b64_tr_b16 v[100:101], v13 offset:24576
  ds_read_b64_tr_b16 v[102:103], v13 offset:26624
  ds_read_b128 v[104:107], v7 offset:0
  ds_read_b128 v[108:111], v7 offset:4096
  s_waitcnt lgkmcnt(10)
  v_mfma_f32_32x32x16_bf16 v[128:143], v[80:83], v[64:67], v[128:143]
  v_mfma_f32_32x32x16_bf16 v[144:159], v[80:83], v[68:71], v[144:159]
  s_add_u32 m0, s44, 98304
  v_mfma_f32_32x32x16_bf16 v[160:175], v[80:83], v[72:75], v[160:175]
  s_add_u32 s46, s42, 2097152
  v_mfma_f32_32x32x16_bf16 v[176:191], v[80:83], v[76:79], v[176:191]
  buffer_load_dwordx4 v18, s[20:23], s46 offen lds
  v_mfma_f32_32x32x16_bf16 v[192:207], v[84:87], v[64:67], v[192:207]
  v_mfma_f32_32x32x16_bf16 v[208:223], v[84:87], v[68:71], v[208:223]
  s_add_u32 m0, s44, 106496
  v_mfma_f32_32x32x16_bf16 v[224:239], v[84:87], v[72:75], v[224:239]
  s_add_u32 s46, s42, 2228224
  v_mfma_f32_32x32x16_bf16 v[240:255], v[84:87], v[76:79], v[240:255]
  buffer_load_dwordx4 v18, s[20:23], s46 offen lds
  ds_read_b64_tr_b16 v[64:65], v10 offset:32768
  ds_read_b64_tr_b16 v[66:67], v10 offset:34816
  ds_read_b64_tr_b16 v[68:69], v11 offset:32768
  ds_read_b64_tr_b16 v[70:71], v11 offset:34816
  ds_read_b64_tr_b16 v[72:73], v12 offset:32768
  ds_read_b64_tr_b16 v[74:75], v12 offset:34816
  ds_read_b64_tr_b16 v[76:77], v13 offset:32768
  ds_read_b64_tr_b16 v[78:79], v13 offset:34816
  ds_read_b128 v[80:83], v14 offset:0
  ds_read_b128 v[84:87], v14 offset:4096
  s_waitcnt lgkmcnt(10)
  v_mfma_f32_32x32x16_bf16 v[128:143], v[104:107], v[88:91], v[128:143]
  v_mfma_f32_32x32x16_bf16 v[144:159], v[104:107], v[92:95], v[144:159]
  s_add_u32 m0, s44, 49152
  v_mfma_f32_32x32x16_bf16 v[160:175], v[104:107], v[96:99], v[160:175]
  s_add_u32 s46, s43, 131584
  v_mfma_f32_32x32x16_bf16 v[176:191], v[104:107], v[100:103], v[176:191]
  buffer_load_dwordx4 v19, s[24:27], s46 offen lds
  v_mfma_f32_32x32x16_bf16 v[192:207], v[108:111], v[88:91], v[192:207]
  v_mfma_f32_32x32x16_bf16 v[208:223], v[108:111], v[92:95], v[208:223]
  s_add_u32 m0, s44, 57344
  v_mfma_f32_32x32x16_bf16 v[224:239], v[108:111], v[96:99], v[224:239]
  s_add_u32 s46, s43, 197120
  v_mfma_f32_32x32x16_bf16 v[240:255], v[108:111], v[100:103], v[240:255]
  buffer_load_dwordx4 v19, s[24:27], s46 offen lds
  s_waitcnt vmcnt(4)
  s_barrier
  ds_read_b64_tr_b16 v[88:89], v10 offset:40960
  ds_read_b64_tr_b16 v[90:91], v10 offset:43008
  ds_read_b64_tr_b16 v[92:93], v11 offset:40960
  ds_read_b64_tr_b16 v[94:95], v11 offset:43008
  ds_read_b64_tr_b16 v[96:97], v12 offset:40960
  ds_read_b64_tr_b16 v[98:99], v12 offset:43008
  ds_read_b64_tr_b16 v[100:101], v13 offset:40960
  ds_read_b64_tr_b16 v[102:103], v13 offset:43008
  ds_read_b128 v[104:107], v15 offset:0
  ds_read_b128 v[108:111], v15 offset:4096
  s_waitcnt lgkmcnt(10)
  v_mfma_f32_32x32x16_bf16 v[128:143], v[80:83], v[64:67], v[128:143]
  v_mfma_f32_32x32x16_bf16 v[144:159], v[80:83], v[68:71], v[144:159]
  s_add_u32 m0, s44, 114688
  v_mfma_f32_32x32x16_bf16 v[160:175], v[80:83], v[72:75], v[160:175]
  s_add_u32 s46, s42, 2359296
  v_mfma_f32_32x32x16_bf16 v[176:191], v[80:83], v[76:79], v[176:191]
  buffer_load_dwordx4 v18, s[20:23], s46 offen lds
  v_mfma_f32_32x32x16_bf16 v[192:207], v[84:87], v[64:67], v[192:207]
  v_mfma_f32_32x32x16_bf16 v[208:223], v[84:87], v[68:71], v[208:223]
  s_add_u32 m0, s44, 122880
  v_mfma_f32_32x32x16_bf16 v[224:239], v[84:87], v[72:75], v[224:239]
  s_add_u32 s46, s42, 2490368
  v_mfma_f32_32x32x16_bf16 v[240:255], v[84:87], v[76:79], v[240:255]
  buffer_load_dwordx4 v18, s[20:23], s46 offen lds
  ds_read_b64_tr_b16 v[64:65], v10 offset:49152
  ds_read_b64_tr_b16 v[66:67], v10 offset:51200
  ds_read_b64_tr_b16 v[68:69], v11 offset:49152
  ds_read_b64_tr_b16 v[70:71], v11 offset:51200
  ds_read_b64_tr_b16 v[72:73], v12 offset:49152
  ds_read_b64_tr_b16 v[74:75], v12 offset:51200
  ds_read_b64_tr_b16 v[76:77], v13 offset:49152
  ds_read_b64_tr_b16 v[78:79], v13 offset:51200
  ds_read_b128 v[80:83], v16 offset:0
  ds_read_b128 v[84:87], v16 offset:4096
  s_waitcnt lgkmcnt(10)
  v_mfma_f32_32x32x16_bf16 v[128:143], v[104:107], v[88:91], v[128:143]
  v_mfma_f32_32x32x16_bf16 v[144:159], v[104:107], v[92:95], v[144:159]
  s_add_u32 m0, s44, 65536
  v_mfma_f32_32x32x16_bf16 v[160:175], v[104:107], v[96:99], v[160:175]
  s_add_u32 s46, s43, 640
  v_mfma_f32_32x32x16_bf16 v[176:191], v[104:107], v[100:103], v[176:191]
  buffer_load_dwordx4 v19, s[24:27], s46 offen lds
  v_mfma_f32_32x32x16_bf16 v[192:207], v[108:111], v[88:91], v[192:207]
  v_mfma_f32_32x32x16_bf16 v[208:223], v[108:111], v[92:95], v[208:223]
  s_add_u32 m0, s44, 73728
  v_mfma_f32_32x32x16_bf16 v[224:239], v[108:111], v[96:99], v[224:239]
  s_add_u32 s46, s43, 66176
  v_mfma_f32_32x32x16_bf16 v[240:255], v[108:111], v[100:103], v[240:255]
  buffer_load_dwordx4 v19, s[24:27], s46 offen lds
  s_waitcnt vmcnt(4)
  s_barrier
  ds_read_b64_tr_b16 v[88:89], v10 offset:57344
  ds_read_b64_tr_b16 v[90:91], v10 offset:59392
  ds_read_b64_tr_b16 v[92:93], v11 offset:57344
  ds_read_b64_tr_b16 v[94:95], v11 offset:59392
  ds_read_b64_tr_b16 v[96:97], v12 offset:57344
  ds_read_b64_tr_b16 v[98:99], v12 offset:59392
  ds_read_b64_tr_b16 v[100:101], v13 offset:57344
  ds_read_b64_tr_b16 v[102:103], v13 offset:59392
  ds_read_b128 v[104:107], v17 offset:0
  ds_read_b128 v[108:111], v17 offset:4096
  s_waitcnt lgkmcnt(10)
  v_mfma_f32_32x32x16_bf16 v[128:143], v[80:83], v[64:67], v[128:143]
  v_mfma_f32_32x32x16_bf16 v[144:159], v[80:83], v[68:71], v[144:159]
  s_add_u32 m0, s44, 131072
  v_mfma_f32_32x32x16_bf16 v[160:175], v[80:83], v[72:75], v[160:175]
  s_add_u32 s46, s42, 2621440
  v_mfma_f32_32x32x16_bf16 v[176:191], v[80:83], v[76:79], v[176:191]
  buffer_load_dwordx4 v18, s[20:23], s46 offen lds
  v_mfma_f32_32x32x16_bf16 v[192:207], v[84:87], v[64:67], v[192:207]
  v_mfma_f32_32x32x16_bf16 v[208:223], v[84:87], v[68:71], v[208:223]
  s_add_u32 m0, s44, 139264
  v_mfma_f32_32x32x16_bf16 v[224:239], v[84:87], v[72:75], v[224:239]
  s_add_u32 s46, s42, 2752512
  v_mfma_f32_32x32x16_bf16 v[240:255], v[84:87], v[76:79], v[240:255]
  buffer_load_dwordx4 v18, s[20:23], s46 offen lds
  ds_read_b64_tr_b16 v[64:65], v10 offset:0
  ds_read_b64_tr_b16 v[66:67], v10 offset:2048
  ds_read_b64_tr_b16 v[68:69], v11 offset:0
  ds_read_b64_tr_b16 v[70:71], v11 offset:2048
  ds_read_b64_tr_b16 v[72:73], v12 offset:0
  ds_read_b64_tr_b16 v[74:75], v12 offset:2048
  ds_read_b64_tr_b16 v[76:77], v13 offset:0
  ds_read_b64_tr_b16 v[78:79], v13 offset:2048
  ds_read_b128 v[80:83], v14 offset:32768
  ds_read_b128 v[84:87], v14 offset:36864
  s_waitcnt lgkmcnt(10)
  v_mfma_f32_32x32x16_bf16 v[128:143], v[104:107], v[88:91], v[128:143]
  v_mfma_f32_32x32x16_bf16 v[144:159], v[104:107], v[92:95], v[144:159]
  s_add_u32 m0, s44, 81920
  v_mfma_f32_32x32x16_bf16 v[160:175], v[104:107], v[96:99], v[160:175]
  s_add_u32 s46, s43, 131712
  v_mfma_f32_32x32x16_bf16 v[176:191], v[104:107], v[100:103], v[176:191]
  buffer_load_dwordx4 v19, s[24:27], s46 offen lds
  v_mfma_f32_32x32x16_bf16 v[192:207], v[108:111], v[88:91], v[192:207]
  v_mfma_f32_32x32x16_bf16 v[208:223], v[108:111], v[92:95], v[208:223]
  s_add_u32 m0, s44, 90112
  v_mfma_f32_32x32x16_bf16 v[224:239], v[108:111], v[96:99], v[224:239]
  s_add_u32 s46, s43, 197248
  v_mfma_f32_32x32x16_bf16 v[240:255], v[108:111], v[100:103], v[240:255]
  buffer_load_dwordx4 v19, s[24:27], s46 offen lds
  s_waitcnt vmcnt(4)
  s_barrier
  ds_read_b64_tr_b16 v[88:89], v10 offset:8192
  ds_read_b64_tr_b16 v[90:91], v10 offset:10240
  ds_read_b64_tr_b16 v[92:93], v11 offset:8192
  ds_read_b64_tr_b16 v[94:95], v11 offset:10240
  ds_read_b64_tr_b16 v[96:97], v12 offset:8192
  ds_read_b64_tr_b16 v[98:99], v12 offset:10240
  ds_read_b64_tr_b16 v[100:101], v13 offset:8192
  ds_read_b64_tr_b16 v[102:103], v13 offset:10240
  ds_read_b128 v[104:107], v15 offset:32768
  ds_read_b128 v[108:111], v15 offset:36864
  s_waitcnt lgkmcnt(10)
  v_mfma_f32_32x32x16_bf16 v[128:143], v[80:83], v[64:67], v[128:143]
  v_mfma_f32_32x32x16_bf16 v[144:159], v[80:83], v[68:71], v[144:159]
  s_add_u32 m0, s44, 147456
  v_mfma_f32_32x32x16_bf16 v[160:175], v[80:83], v[72:75], v[160:175]
  s_add_u32 s46, s42, 2883584
  v_mfma_f32_32x32x16_bf16 v[176:191], v[80:83], v[76:79], v[176:191]
  buffer_load_dwordx4 v18, s[20:23], s46 offen lds
  v_mfma_f32_32x32x16_bf16 v[192:207], v[84:87], v[64:67], v[192:207]
  v_mfma_f32_32x32x16_bf16 v[208:223], v[84:87], v[68:71], v[208:223]
  s_add_u32 m0, s44, 155648
  v_mfma_f32_32x32x16_bf16 v[224:239], v[84:87], v[72:75], v[224:239]
  s_add_u32 s46, s42, 3014656
  v_mfma_f32_32x32x16_bf16 v[240:255], v[84:87], v[76:79], v[240:255]
  buffer_load_dwordx4 v18, s[20:23], s46 offen lds
  ds_read_b64_tr_b16 v[64:65], v10 offset:16384
  ds_read_b64_tr_b16 v[66:67], v10 offset:18432
  ds_read_b64_tr_b16 v[68:69], v11 offset:16384
  ds_read_b64_tr_b16 v[70:71], v11 offset:18432
  ds_read_b64_tr_b16 v[72:73], v12 offset:16384
  ds_read_b64_tr_b16 v[74:75], v12 offset:18432
  ds_read_b64_tr_b16 v[76:77], v13 offset:16384
  ds_read_b64_tr_b16 v[78:79], v13 offset:18432
  ds_read_b128 v[80:83], v16 offset:32768
  ds_read_b128 v[84:87], v16 offset:36864
  s_waitcnt lgkmcnt(10)
  v_mfma_f32_32x32x16_bf16 v[128:143], v[104:107], v[88:91], v[128:143]
  v_mfma_f32_32x32x16_bf16 v[144:159], v[104:107], v[92:95], v[144:159]
  s_add_u32 m0, s44, 0
  v_mfma_f32_32x32x16_bf16 v[160:175], v[104:107], v[96:99], v[160:175]
  s_add_u32 s46, s43, 768
  v_mfma_f32_32x32x16_bf16 v[176:191], v[104:107], v[100:103], v[176:191]
  buffer_load_dwordx4 v19, s[24:27], s46 offen lds
  v_mfma_f32_32x32x16_bf16 v[192:207], v[108:111], v[88:91], v[192:207]
  v_mfma_f32_32x32x16_bf16 v[208:223], v[108:111], v[92:95], v[208:223]
  s_add_u32 m0, s44, 8192
  v_mfma_f32_32x32x16_bf16 v[224:239], v[108:111], v[96:99], v[224:239]
  s_add_u32 s46, s43, 66304
  v_mfma_f32_32x32x16_bf16 v[240:255], v[108:111], v[100:103], v[240:255]
  buffer_load_dwordx4 v19, s[24:27], s46 offen lds
  s_waitcnt vmcnt(4)
  s_barrier
  ds_read_b64_tr_b16 v[88:89], v10 offset:24576
  ds_read_b64_tr_b16 v[90:91], v10 offset:26624
  ds_read_b64_tr_b16 v[92:93], v11 offset:24576
  ds_read_b64_tr_b16 v[94:95], v11 offset:26624
  ds_read_b64_tr_b16 v[96:97], v12 offset:24576
  ds_read_b64_tr_b16 v[98:99], v12 offset:26624
  ds_read_b64_tr_b16 v[100:101], v13 offset:24576
  ds_read_b64_tr_b16 v[102:103], v13 offset:26624
  ds_read_b128 v[104:107], v17 offset:32768
  ds_read_b128 v[108:111], v17 offset:36864
  s_waitcnt lgkmcnt(10)
  v_mfma_f32_32x32x16_bf16 v[128:143], v[80:83], v[64:67], v[128:143]
  v_mfma_f32_32x32x16_bf16 v[144:159], v[80:83], v[68:71], v[144:159]
  s_add_u32 m0, s44, 98304
  v_mfma_f32_32x32x16_bf16 v[160:175], v[80:83], v[72:75], v[160:175]
  s_add_u32 s46, s42, 3145728
  v_mfma_f32_32x32x16_bf16 v[176:191], v[80:83], v[76:79], v[176:191]
  buffer_load_dwordx4 v18, s[20:23], s46 offen lds
  v_mfma_f32_32x32x16_bf16 v[192:207], v[84:87], v[64:67], v[192:207]
  v_mfma_f32_32x32x16_bf16 v[208:223], v[84:87], v[68:71], v[208:223]
  s_add_u32 m0, s44, 106496
  v_mfma_f32_32x32x16_bf16 v[224:239], v[84:87], v[72:75], v[224:239]
  s_add_u32 s46, s42, 3276800
  v_mfma_f32_32x32x16_bf16 v[240:255], v[84:87], v[76:79], v[240:255]
  buffer_load_dwordx4 v18, s[20:23], s46 offen lds
  ds_read_b64_tr_b16 v[64:65], v10 offset:32768
  ds_read_b64_tr_b16 v[66:67], v10 offset:34816
  ds_read_b64_tr_b16 v[68:69], v11 offset:32768
  ds_read_b64_tr_b16 v[70:71], v11 offset:34816
  ds_read_b64_tr_b16 v[72:73], v12 offset:32768
  ds_read_b64_tr_b16 v[74:75], v12 offset:34816
  ds_read_b64_tr_b16 v[76:77], v13 offset:32768
  ds_read_b64_tr_b16 v[78:79], v13 offset:34816
  ds_read_b128 v[80:83], v4 offset:0
  ds_read_b128 v[84:87], v4 offset:4096
  s_waitcnt lgkmcnt(10)
  v_mfma_f32_32x32x16_bf16 v[128:143], v[104:107], v[88:91], v[128:143]
  v_mfma_f32_32x32x16_bf16 v[144:159], v[104:107], v[92:95], v[144:159]
  s_add_u32 m0, s44, 16384
  v_mfma_f32_32x32x16_bf16 v[160:175], v[104:107], v[96:99], v[160:175]
  s_add_u32 s46, s43, 131840
  v_mfma_f32_32x32x16_bf16 v[176:191], v[104:107], v[100:103], v[176:191]
  buffer_load_dwordx4 v19, s[24:27], s46 offen lds
  v_mfma_f32_32x32x16_bf16 v[192:207], v[108:111], v[88:91], v[192:207]
  v_mfma_f32_32x32x16_bf16 v[208:223], v[108:111], v[92:95], v[208:223]
  s_add_u32 m0, s44, 24576
  v_mfma_f32_32x32x16_bf16 v[224:239], v[108:111], v[96:99], v[224:239]
  s_add_u32 s46, s43, 197376
  v_mfma_f32_32x32x16_bf16 v[240:255], v[108:111], v[100:103], v[240:255]
  buffer_load_dwordx4 v19, s[24:27], s46 offen lds
  s_waitcnt vmcnt(4)
  s_barrier
  ds_read_b64_tr_b16 v[88:89], v10 offset:40960
  ds_read_b64_tr_b16 v[90:91], v10 offset:43008
  ds_read_b64_tr_b16 v[92:93], v11 offset:40960
  ds_read_b64_tr_b16 v[94:95], v11 offset:43008
  ds_read_b64_tr_b16 v[96:97], v12 offset:40960
  ds_read_b64_tr_b16 v[98:99], v12 offset:43008
  ds_read_b64_tr_b16 v[100:101], v13 offset:40960
  ds_read_b64_tr_b16 v[102:103], v13 offset:43008
  ds_read_b128 v[104:107], v5 offset:0
  ds_read_b128 v[108:111], v5 offset:4096
  s_waitcnt lgkmcnt(10)
  v_mfma_f32_32x32x16_bf16 v[128:143], v[80:83], v[64:67], v[128:143]
  v_mfma_f32_32x32x16_bf16 v[144:159], v[80:83], v[68:71], v[144:159]
  s_add_u32 m0, s44, 114688
  v_mfma_f32_32x32x16_bf16 v[160:175], v[80:83], v[72:75], v[160:175]
  s_add_u32 s46, s42, 3407872
  v_mfma_f32_32x32x16_bf16 v[176:191], v[80:83], v[76:79], v[176:191]
  buffer_load_dwordx4 v18, s[20:23], s46 offen lds
  v_mfma_f32_32x32x16_bf16 v[192:207], v[84:87], v[64:67], v[192:207]
  v_mfma_f32_32x32x16_bf16 v[208:223], v[84:87], v[68:71], v[208:223]
  s_add_u32 m0, s44, 122880
  v_mfma_f32_32x32x16_bf16 v[224:239], v[84:87], v[72:75], v[224:239]
  s_add_u32 s46, s42, 3538944
  v_mfma_f32_32x32x16_bf16 v[240:255], v[84:87], v[76:79], v[240:255]
  buffer_load_dwordx4 v18, s[20:23], s46 offen lds
  ds_read_b64_tr_b16 v[64:65], v10 offset:49152
  ds_read_b64_tr_b16 v[66:67], v10 offset:51200
  ds_read_b64_tr_b16 v[68:69], v11 offset:49152
  ds_read_b64_tr_b16 v[70:71], v11 offset:51200
  ds_read_b64_tr_b16 v[72:73], v12 offset:49152
  ds_read_b64_tr_b16 v[74:75], v12 offset:51200
  ds_read_b64_tr_b16 v[76:77], v13 offset:49152
  ds_read_b64_tr_b16 v[78:79], v13 offset:51200
  ds_read_b128 v[80:83], v6 offset:0
  ds_read_b128 v[84:87], v6 offset:4096
  s_waitcnt lgkmcnt(10)
  v_mfma_f32_32x32x16_bf16 v[128:143], v[104:107], v[88:91], v[128:143]
  v_mfma_f32_32x32x16_bf16 v[144:159], v[104:107], v[92:95], v[144:159]
  s_add_u32 m0, s44, 32768
  v_mfma_f32_32x32x16_bf16 v[160:175], v[104:107], v[96:99], v[160:175]
  s_add_u32 s46, s43, 896
  v_mfma_f32_32x32x16_bf16 v[176:191], v[104:107], v[100:103], v[176:191]
  buffer_load_dwordx4 v19, s[24:27], s46 offen lds
  v_mfma_f32_32x32x16_bf16 v[192:207], v[108:111], v[88:91], v[192:207]
  v_mfma_f32_32x32x16_bf16 v[208:223], v[108:111], v[92:95], v[208:223]
  s_add_u32 m0, s44, 40960
  v_mfma_f32_32x32x16_bf16 v[224:239], v[108:111], v[96:99], v[224:239]
  s_add_u32 s46, s43, 66432
  v_mfma_f32_32x32x16_bf16 v[240:255], v[108:111], v[100:103], v[240:255]
  buffer_load_dwordx4 v19, s[24:27], s46 offen lds
  s_waitcnt vmcnt(4)
  s_barrier
  ds_read_b64_tr_b16 v[88:89], v10 offset:57344
  ds_read_b64_tr_b16 v[90:91], v10 offset:59392
  ds_read_b64_tr_b16 v[92:93], v11 offset:57344
  ds_read_b64_tr_b16 v[94:95], v11 offset:59392
  ds_read_b64_tr_b16 v[96:97], v12 offset:57344
  ds_read_b64_tr_b16 v[98:99], v12 offset:59392
  ds_read_b64_tr_b16 v[100:101], v13 offset:57344
  ds_read_b64_tr_b16 v[102:103], v13 offset:59392
  ds_read_b128 v[104:107], v7 offset:0
  ds_read_b128 v[108:111], v7 offset:4096
  s_waitcnt lgkmcnt(10)
  v_mfma_f32_32x32x16_bf16 v[128:143], v[80:83], v[64:67], v[128:143]
  v_mfma_f32_32x32x16_bf16 v[144:159], v[80:83], v[68:71], v[144:159]
  s_add_u32 m0, s44, 131072
  v_mfma_f32_32x32x16_bf16 v[160:175], v[80:83], v[72:75], v[160:175]
  s_add_u32 s46, s42, 3670016
  v_mfma_f32_32x32x16_bf16 v[176:191], v[80:83], v[76:79], v[176:191]
  buffer_load_dwordx4 v18, s[20:23], s46 offen lds
  v_mfma_f32_32x32x16_bf16 v[192:207], v[84:87], v[64:67], v[192:207]
  v_mfma_f32_32x32x16_bf16 v[208:223], v[84:87], v[68:71], v[208:223]
  s_add_u32 m0, s44, 139264
  v_mfma_f32_32x32x16_bf16 v[224:239], v[84:87], v[72:75], v[224:239]
  s_add_u32 s46, s42, 3801088
  v_mfma_f32_32x32x16_bf16 v[240:255], v[84:87], v[76:79], v[240:255]
  buffer_load_dwordx4 v18, s[20:23], s46 offen lds
  ds_read_b64_tr_b16 v[64:65], v10 offset:0
  ds_read_b64_tr_b16 v[66:67], v10 offset:2048
  ds_read_b64_tr_b16 v[68:69], v11 offset:0
  ds_read_b64_tr_b16 v[70:71], v11 offset:2048
  ds_read_b64_tr_b16 v[72:73], v12 offset:0
  ds_read_b64_tr_b16 v[74:75], v12 offset:2048
  ds_read_b64_tr_b16 v[76:77], v13 offset:0
  ds_read_b64_tr_b16 v[78:79], v13 offset:2048
  ds_read_b128 v[80:83], v14 offset:0
  ds_read_b128 v[84:87], v14 offset:4096
  s_waitcnt lgkmcnt(10)
  v_mfma_f32_32x32x16_bf16 v[128:143], v[104:107], v[88:91], v[128:143]
  v_mfma_f32_32x32x16_bf16 v[144:159], v[104:107], v[92:95], v[144:159]
  s_add_u32 m0, s44, 49152
  v_mfma_f32_32x32x16_bf16 v[160:175], v[104:107], v[96:99], v[160:175]
  s_add_u32 s46, s43, 131968
  v_mfma_f32_32x32x16_bf16 v[176:191], v[104:107], v[100:103], v[176:191]
  buffer_load_dwordx4 v19, s[24:27], s46 offen lds
  v_mfma_f32_32x32x16_bf16 v[192:207], v[108:111], v[88:91], v[192:207]
  v_mfma_f32_32x32x16_bf16 v[208:223], v[108:111], v[92:95], v[208:223]
  s_add_u32 m0, s44, 57344
  v_mfma_f32_32x32x16_bf16 v[224:239], v[108:111], v[96:99], v[224:239]
  s_add_u32 s46, s43, 197504
  v_mfma_f32_32x32x16_bf16 v[240:255], v[108:111], v[100:103], v[240:255]
  buffer_load_dwordx4 v19, s[24:27], s46 offen lds
  s_waitcnt vmcnt(4)
  s_barrier
  ds_read_b64_tr_b16 v[88:89], v10 offset:8192
  ds_read_b64_tr_b16 v[90:91], v10 offset:10240
  ds_read_b64_tr_b16 v[92:93], v11 offset:8192
  ds_read_b64_tr_b16 v[94:95], v11 offset:10240
  ds_read_b64_tr_b16 v[96:97], v12 offset:8192
  ds_read_b64_tr_b16 v[98:99], v12 offset:10240
  ds_read_b64_tr_b16 v[100:101], v13 offset:8192
  ds_read_b64_tr_b16 v[102:103], v13 offset:10240
  ds_read_b128 v[104:107], v15 offset:0
  ds_read_b128 v[108:111], v15 offset:4096
  s_waitcnt lgkmcnt(10)
  v_mfma_f32_32x32x16_bf16 v[128:143], v[80:83], v[64:67], v[128:143]
  v_mfma_f32_32x32x16_bf16 v[144:159], v[80:83], v[68:71], v[144:159]
  s_add_u32 m0, s44, 147456
  v_mfma_f32_32x32x16_bf16 v[160:175], v[80:83], v[72:75], v[160:175]
  s_add_u32 s46, s42, 3932160
  v_mfma_f32_32x32x16_bf16 v[176:191], v[80:83], v[76:79], v[176:191]
  buffer_load_dwordx4 v18, s[20:23], s46 offen lds
  v_mfma_f32_32x32x16_bf16 v[192:207], v[84:87], v[64:67], v[192:207]
  v_mfma_f32_32x32x16_bf16 v[208:223], v[84:87], v[68:71], v[208:223]
  s_add_u32 m0, s44, 155648
  v_mfma_f32_32x32x16_bf16 v[224:239], v[84:87], v[72:75], v[224:239]
  s_add_u32 s46, s42, 4063232
  v_mfma_f32_32x32x16_bf16 v[240:255], v[84:87], v[76:79], v[240:255]
  buffer_load_dwordx4 v18, s[20:23], s46 offen lds
  ds_read_b64_tr_b16 v[64:65], v10 offset:16384
  ds_read_b64_tr_b16 v[66:67], v10 offset:18432
  ds_read_b64_tr_b16 v[68:69], v11 offset:16384
  ds_read_b64_tr_b16 v[70:71], v11 offset:18432
  ds_read_b64_tr_b16 v[72:73], v12 offset:16384
  ds_read_b64_tr_b16 v[74:75], v12 offset:18432
  ds_read_b64_tr_b16 v[76:77], v13 offset:16384
  ds_read_b64_tr_b16 v[78:79], v13 offset:18432
  ds_read_b128 v[80:83], v16 offset:0
  ds_read_b128 v[84:87], v16 offset:4096
  s_waitcnt lgkmcnt(10)
  v_mfma_f32_32x32x16_bf16 v[128:143], v[104:107], v[88:91], v[128:143]
  v_mfma_f32_32x32x16_bf16 v[144:159], v[104:107], v[92:95], v[144:159]
  v_mfma_f32_32x32x16_bf16 v[160:175], v[104:107], v[96:99], v[160:175]
  v_mfma_f32_32x32x16_bf16 v[176:191], v[104:107], v[100:103], v[176:191]
  v_mfma_f32_32x32x16_bf16 v[192:207], v[108:111], v[88:91], v[192:207]
  v_mfma_f32_32x32x16_bf16 v[208:223], v[108:111], v[92:95], v[208:223]
  v_mfma_f32_32x32x16_bf16 v[224:239], v[108:111], v[96:99], v[224:239]
  v_mfma_f32_32x32x16_bf16 v[240:255], v[108:111], v[100:103], v[240:255]
  s_waitcnt vmcnt(2)
  s_barrier
  ds_read_b64_tr_b16 v[88:89], v10 offset:24576
  ds_read_b64_tr_b16 v[90:91], v10 offset:26624
  ds_read_b64_tr_b16 v[92:93], v11 offset:24576
  ds_read_b64_tr_b16 v[94:95], v11 offset:26624
  ds_read_b64_tr_b16 v[96:97], v12 offset:24576
  ds_read_b64_tr_b16 v[98:99], v12 offset:26624
  ds_read_b64_tr_b16 v[100:101], v13 offset:24576
  ds_read_b64_tr_b16 v[102:103], v13 offset:26624
  ds_read_b128 v[104:107], v17 offset:0
  ds_read_b128 v[108:111], v17 offset:4096
  s_waitcnt lgkmcnt(10)
  v_mfma_f32_32x32x16_bf16 v[128:143], v[80:83], v[64:67], v[128:143]
  v_mfma_f32_32x32x16_bf16 v[144:159], v[80:83], v[68:71], v[144:159]
  v_mfma_f32_32x32x16_bf16 v[160:175], v[80:83], v[72:75], v[160:175]
  v_mfma_f32_32x32x16_bf16 v[176:191], v[80:83], v[76:79], v[176:191]
  v_mfma_f32_32x32x16_bf16 v[192:207], v[84:87], v[64:67], v[192:207]
  v_mfma_f32_32x32x16_bf16 v[208:223], v[84:87], v[68:71], v[208:223]
  v_mfma_f32_32x32x16_bf16 v[224:239], v[84:87], v[72:75], v[224:239]
  v_mfma_f32_32x32x16_bf16 v[240:255], v[84:87], v[76:79], v[240:255]
  ds_read_b64_tr_b16 v[64:65], v10 offset:32768
  ds_read_b64_tr_b16 v[66:67], v10 offset:34816
  ds_read_b64_tr_b16 v[68:69], v11 offset:32768
  ds_read_b64_tr_b16 v[70:71], v11 offset:34816
  ds_read_b64_tr_b16 v[72:73], v12 offset:32768
  ds_read_b64_tr_b16 v[74:75], v12 offset:34816
  ds_read_b64_tr_b16 v[76:77], v13 offset:32768
  ds_read_b64_tr_b16 v[78:79], v13 offset:34816
  ds_read_b128 v[80:83], v14 offset:32768
  ds_read_b128 v[84:87], v14 offset:36864
  s_waitcnt lgkmcnt(10)
  v_mfma_f32_32x32x16_bf16 v[128:143], v[104:107], v[88:91], v[128:143]
  v_mfma_f32_32x32x16_bf16 v[144:159], v[104:107], v[92:95], v[144:159]
  v_mfma_f32_32x32x16_bf16 v[160:175], v[104:107], v[96:99], v[160:175]
  v_mfma_f32_32x32x16_bf16 v[176:191], v[104:107], v[100:103], v[176:191]
  v_mfma_f32_32x32x16_bf16 v[192:207], v[108:111], v[88:91], v[192:207]
  v_mfma_f32_32x32x16_bf16 v[208:223], v[108:111], v[92:95], v[208:223]
  v_mfma_f32_32x32x16_bf16 v[224:239], v[108:111], v[96:99], v[224:239]
  v_mfma_f32_32x32x16_bf16 v[240:255], v[108:111], v[100:103], v[240:255]
  s_waitcnt vmcnt(0)
  s_barrier
  ds_read_b64_tr_b16 v[88:89], v10 offset:40960
  ds_read_b64_tr_b16 v[90:91], v10 offset:43008
  ds_read_b64_tr_b16 v[92:93], v11 offset:40960
  ds_read_b64_tr_b16 v[94:95], v11 offset:43008
  ds_read_b64_tr_b16 v[96:97], v12 offset:40960
  ds_read_b64_tr_b16 v[98:99], v12 offset:43008
  ds_read_b64_tr_b16 v[100:101], v13 offset:40960
  ds_read_b64_tr_b16 v[102:103], v13 offset:43008
  ds_read_b128 v[104:107], v15 offset:32768
  ds_read_b128 v[108:111], v15 offset:36864
  s_waitcnt lgkmcnt(10)
  v_mfma_f32_32x32x16_bf16 v[128:143], v[80:83], v[64:67], v[128:143]
  v_mfma_f32_32x32x16_bf16 v[144:159], v[80:83], v[68:71], v[144:159]
  v_mfma_f32_32x32x16_bf16 v[160:175], v[80:83], v[72:75], v[160:175]
  v_mfma_f32_32x32x16_bf16 v[176:191], v[80:83], v[76:79], v[176:191]
  v_mfma_f32_32x32x16_bf16 v[192:207], v[84:87], v[64:67], v[192:207]
  v_mfma_f32_32x32x16_bf16 v[208:223], v[84:87], v[68:71], v[208:223]
  v_mfma_f32_32x32x16_bf16 v[224:239], v[84:87], v[72:75], v[224:239]
  v_mfma_f32_32x32x16_bf16 v[240:255], v[84:87], v[76:79], v[240:255]
  ds_read_b64_tr_b16 v[64:65], v10 offset:49152
  ds_read_b64_tr_b16 v[66:67], v10 offset:51200
  ds_read_b64_tr_b16 v[68:69], v11 offset:49152
  ds_read_b64_tr_b16 v[70:71], v11 offset:51200
  ds_read_b64_tr_b16 v[72:73], v12 offset:49152
  ds_read_b64_tr_b16 v[74:75], v12 offset:51200
  ds_read_b64_tr_b16 v[76:77], v13 offset:49152
  ds_read_b64_tr_b16 v[78:79], v13 offset:51200
  ds_read_b128 v[80:83], v16 offset:32768
  ds_read_b128 v[84:87], v16 offset:36864
  s_waitcnt lgkmcnt(10)
  v_mfma_f32_32x32x16_bf16 v[128:143], v[104:107], v[88:91], v[128:143]
  v_mfma_f32_32x32x16_bf16 v[144:159], v[104:107], v[92:95], v[144:159]
  v_mfma_f32_32x32x16_bf16 v[160:175], v[104:107], v[96:99], v[160:175]
  v_mfma_f32_32x32x16_bf16 v[176:191], v[104:107], v[100:103], v[176:191]
  v_mfma_f32_32x32x16_bf16 v[192:207], v[108:111], v[88:91], v[192:207]
  v_mfma_f32_32x32x16_bf16 v[208:223], v[108:111], v[92:95], v[208:223]
  v_mfma_f32_32x32x16_bf16 v[224:239], v[108:111], v[96:99], v[224:239]
  v_mfma_f32_32x32x16_bf16 v[240:255], v[108:111], v[100:103], v[240:255]
  s_waitcnt vmcnt(0)
  s_barrier
  ds_read_b64_tr_b16 v[88:89], v10 offset:57344
  ds_read_b64_tr_b16 v[90:91], v10 offset:59392
  ds_read_b64_tr_b16 v[92:93], v11 offset:57344
  ds_read_b64_tr_b16 v[94:95], v11 offset:59392
  ds_read_b64_tr_b16 v[96:97], v12 offset:57344
  ds_read_b64_tr_b16 v[98:99], v12 offset:59392
  ds_read_b64_tr_b16 v[100:101], v13 offset:57344
  ds_read_b64_tr_b16 v[102:103], v13 offset:59392
  ds_read_b128 v[104:107], v17 offset:32768
  ds_read_b128 v[108:111], v17 offset:36864
  s_waitcnt lgkmcnt(10)
  v_mfma_f32_32x32x16_bf16 v[128:143], v[80:83], v[64:67], v[128:143]
  v_mfma_f32_32x32x16_bf16 v[144:159], v[80:83], v[68:71], v[144:159]
  v_mfma_f32_32x32x16_bf16 v[160:175], v[80:83], v[72:75], v[160:175]
  v_mfma_f32_32x32x16_bf16 v[176:191], v[80:83], v[76:79], v[176:191]
  v_mfma_f32_32x32x16_bf16 v[192:207], v[84:87], v[64:67], v[192:207]
  v_mfma_f32_32x32x16_bf16 v[208:223], v[84:87], v[68:71], v[208:223]
  v_mfma_f32_32x32x16_bf16 v[224:239], v[84:87], v[72:75], v[224:239]
  v_mfma_f32_32x32x16_bf16 v[240:255], v[84:87], v[76:79], v[240:255]
  s_waitcnt lgkmcnt(0)
  v_mfma_f32_32x32x16_bf16 v[128:143], v[104:107], v[88:91], v[128:143]
  v_mfma_f32_32x32x16_bf16 v[144:159], v[104:107], v[92:95], v[144:159]
  v_mfma_f32_32x32x16_bf16 v[160:175], v[104:107], v[96:99], v[160:175]
  v_mfma_f32_32x32x16_bf16 v[176:191], v[104:107], v[100:103], v[176:191]
  v_mfma_f32_32x32x16_bf16 v[192:207], v[108:111], v[88:91], v[192:207]
  v_mfma_f32_32x32x16_bf16 v[208:223], v[108:111], v[92:95], v[208:223]
  v_mfma_f32_32x32x16_bf16 v[224:239], v[108:111], v[96:99], v[224:239]
  v_mfma_f32_32x32x16_bf16 v[240:255], v[108:111], v[100:103], v[240:255]
  s_mov_b32 s56, s52
  s_and_b32 s57, s53, 0xffff
  s_mov_b32 s58, 4194304
  s_mov_b32 s59, 0x20000
  s_cmp_ge_u32 s3, 2
  s_cbranch_scc1 k1_kernel_pf3
  s_lshr_b32 s50, s2, 3
  s_lshl_b32 s50, s50, 1
  s_add_u32 s50, s50, s3
  s_lshl_b32 s50, s50, 16
  s_lshl_b32 s51, s17, 10
  s_add_u32 s50, s50, s51
  v_lshrrev_b32 v20, 3, v1
  v_lshlrev_b32 v20, 13, v20
  v_and_b32 v21, 7, v1
  v_lshl_add_u32 v20, v21, 7, v20
  buffer_load_dword v21, v20, s[56:59], s50 offen
k1_kernel_pf3:
  s_lshl_b32 s50, s16, 1
  s_add_u32 s50, s50, s40
  s_lshl_b32 s50, s50, 5
  s_lshl_b32 s51, s14, 2
  s_add_u32 s50, s50, s51
  s_lshr_b32 s51, s3, 1
  s_add_u32 s50, s50, s51
  s_lshl_b32 s50, s50, 15
  v_lshlrev_b32 v20, 4, v1
  v_cvt_pk_bf16_f32 v64, v128, v129
  v_cvt_pk_bf16_f32 v65, v130, v131
  v_cvt_pk_bf16_f32 v66, v132, v133
  v_cvt_pk_bf16_f32 v67, v134, v135
  s_add_u32 s51, s50, 16384
  buffer_store_dwordx4 v[64:67], v20, s[36:39], s51 offen
  v_cvt_pk_bf16_f32 v68, v136, v137
  v_cvt_pk_bf16_f32 v69, v138, v139
  v_cvt_pk_bf16_f32 v70, v140, v141
  v_cvt_pk_bf16_f32 v71, v142, v143
  s_add_u32 s51, s50, 20480
  buffer_store_dwordx4 v[68:71], v20, s[36:39], s51 offen
  v_cvt_pk_bf16_f32 v72, v144, v145
  v_cvt_pk_bf16_f32 v73, v146, v147
  v_cvt_pk_bf16_f32 v74, v148, v149
  v_cvt_pk_bf16_f32 v75, v150, v151
  s_add_u32 s51, s50, 17408
  buffer_store_dwordx4 v[72:75], v20, s[36:39], s51 offen
  v_cvt_pk_bf16_f32 v76, v152, v153
  v_cvt_pk_bf16_f32 v77, v154, v155
  v_cvt_pk_bf16_f32 v78, v156, v157
  v_cvt_pk_bf16_f32 v79, v158, v159
  s_add_u32 s51, s50, 21504
  buffer_store_dwordx4 v[76:79], v20, s[36:39], s51 offen
  v_cvt_pk_bf16_f32 v80, v160, v161
  v_cvt_pk_bf16_f32 v81, v162, v163
  v_cvt_pk_bf16_f32 v82, v164, v165
  v_cvt_pk_bf16_f32 v83, v166, v167
  s_add_u32 s51, s50, 18432
  buffer_store_dwordx4 v[80:83], v20, s[36:39], s51 offen
  v_cvt_pk_bf16_f32 v84, v168, v169
  v_cvt_pk_bf16_f32 v85, v170, v171
  v_cvt_pk_bf16_f32 v86, v172, v173
  v_cvt_pk_bf16_f32 v87, v174, v175
  s_add_u32 s51, s50, 22528
  buffer_store_dwordx4 v[84:87], v20, s[36:39], s51 offen
  v_cvt_pk_bf16_f32 v88, v176, v177
  v_cvt_pk_bf16_f32 v89, v178, v179
  v_cvt_pk_bf16_f32 v90, v180, v181
  v_cvt_pk_bf16_f32 v91, v182, v183
  s_add_u32 s51, s50, 19456
  buffer_store_dwordx4 v[88:91], v20, s[36:39], s51 offen
  v_cvt_pk_bf16_f32 v92, v184, v185
  v_cvt_pk_bf16_f32 v93, v186, v187
  v_cvt_pk_bf16_f32 v94, v188, v189
  v_cvt_pk_bf16_f32 v95, v190, v191
  s_add_u32 s51, s50, 23552
  buffer_store_dwordx4 v[92:95], v20, s[36:39], s51 offen
  v_cvt_pk_bf16_f32 v64, v192, v193
  v_cvt_pk_bf16_f32 v65, v194, v195
  v_cvt_pk_bf16_f32 v66, v196, v197
  v_cvt_pk_bf16_f32 v67, v198, v199
  s_add_u32 s51, s50, 24576
  buffer_store_dwordx4 v[64:67], v20, s[36:39], s51 offen
  v_cvt_pk_bf16_f32 v68, v200, v201
  v_cvt_pk_bf16_f32 v69, v202, v203
  v_cvt_pk_bf16_f32 v70, v204, v205
  v_cvt_pk_bf16_f32 v71, v206, v207
  s_add_u32 s51, s50, 28672
  buffer_store_dwordx4 v[68:71], v20, s[36:39], s51 offen
  v_cvt_pk_bf16_f32 v72, v208, v209
  v_cvt_pk_bf16_f32 v73, v210, v211
  v_cvt_pk_bf16_f32 v74, v212, v213
  v_cvt_pk_bf16_f32 v75, v214, v215
  s_add_u32 s51, s50, 25600
  buffer_store_dwordx4 v[72:75], v20, s[36:39], s51 offen
  v_cvt_pk_bf16_f32 v76, v216, v217
  v_cvt_pk_bf16_f32 v77, v218, v219
  v_cvt_pk_bf16_f32 v78, v220, v221
  v_cvt_pk_bf16_f32 v79, v222, v223
  s_add_u32 s51, s50, 29696
  buffer_store_dwordx4 v[76:79], v20, s[36:39], s51 offen
  v_cvt_pk_bf16_f32 v80, v224, v225
  v_cvt_pk_bf16_f32 v81, v226, v227
  v_cvt_pk_bf16_f32 v82, v228, v229
  v_cvt_pk_bf16_f32 v83, v230, v231
  s_add_u32 s51, s50, 26624
  buffer_store_dwordx4 v[80:83], v20, s[36:39], s51 offen
  v_cvt_pk_bf16_f32 v84, v232, v233
  v_cvt_pk_bf16_f32 v85, v234, v235
  v_cvt_pk_bf16_f32 v86, v236, v237
  v_cvt_pk_bf16_f32 v87, v238, v239
  s_add_u32 s51, s50, 30720
  buffer_store_dwordx4 v[84:87], v20, s[36:39], s51 offen
  v_cvt_pk_bf16_f32 v88, v240, v241
  v_cvt_pk_bf16_f32 v89, v242, v243
  v_cvt_pk_bf16_f32 v90, v244, v245
  v_cvt_pk_bf16_f32 v91, v246, v247
  s_add_u32 s51, s50, 27648
  buffer_store_dwordx4 v[88:91], v20, s[36:39], s51 offen
  v_cvt_pk_bf16_f32 v92, v248, v249
  v_cvt_pk_bf16_f32 v93, v250, v251
  v_cvt_pk_bf16_f32 v94, v252, v253
  v_cvt_pk_bf16_f32 v95, v254, v255
  s_add_u32 s51, s50, 31744
  buffer_store_dwordx4 v[92:95], v20, s[36:39], s51 offen
  s_waitcnt vmcnt(0)
k1_kernel_end:
  s_endpgm
.globl k2_kernel
.p2align 8
.type k2_kernel,@function
k2_kernel:
  s_cmp_ge_u32 s2, 256
  s_cbranch_scc1 k2_kernel_end
  s_load_dwordx2 s[4:5], s[0:1], 16
  s_load_dwordx2 s[6:7], s[0:1], 104
  s_load_dwordx2 s[74:75], s[0:1], 40
  s_load_dwordx2 s[76:77], s[0:1], 56
  s_load_dwordx2 s[78:79], s[0:1], 72
  v_and_b32 v1, 63, v0
  v_lshrrev_b32 v2, 6, v0
  s_nop 0
  v_readfirstlane_b32 s3, v2
  s_waitcnt lgkmcnt(0)
  s_mov_b32 s8, s4
  s_and_b32 s9, s5, 0xffff
  s_mov_b32 s10, 4194304
  s_mov_b32 s11, 0x20000
  s_add_u32 s12, s6, 0
  s_addc_u32 s13, s7, 0
  s_and_b32 s13, s13, 0xffff
  s_mov_b32 s14, 2097152
  s_mov_b32 s15, 0x20000
  s_add_u32 s16, s6, 2097152
  s_addc_u32 s17, s7, 0
  s_and_b32 s17, s17, 0xffff
  s_mov_b32 s18, 33554432
  s_mov_b32 s19, 0x20000
  s_add_u32 s24, s6, 52428800
  s_addc_u32 s25, s7, 0
  s_and_b32 s25, s25, 0xffff
  s_mov_b32 s26, 16777216
  s_mov_b32 s27, 0x20000
  s_and_b32 s38, s2, 7
  s_lshr_b32 s29, s2, 3
  s_and_b32 s28, s29, 3
  s_lshl_b32 s38, s38, 2
  s_add_u32 s28, s28, s38
  s_lshr_b32 s29, s29, 2
  s_lshr_b32 s39, s3, 2
  s_and_b32 s40, s3, 3
  s_mov_b32 s41, 0x3e0293ee
  s_add_u32 s59, s29, 1
  s_lshl_b32 s30, s59, 1
  s_sub_u32 s60, 16, s29
  v_lshlrev_b32 v2, 4, v1
  s_sub_u32 s38, 15, s29
  s_cmp_eq_u32 s39, 0
  s_cselect_b32 s38, s38, s29
  s_lshl_b32 s38, s38, 2
  s_add_u32 s38, s38, s40
  s_lshl_b32 s52, s38, 15
  v_lshrrev_b32 v20, 4, v1
  v_bfe_u32 v21, v1, 2, 2
  v_xor_b32 v21, v21, v20
  v_lshlrev_b32 v21, 6, v21
  v_lshl_add_u32 v21, v20, 13, v21
  v_and_b32 v22, 3, v1
  v_lshl_add_u32 v16, v22, 4, v21
  s_lshl_b32 s53, s3, 15
  s_lshl_b32 s54, s28, 8
  s_add_u32 s53, s53, s54
  s_lshl_b32 s54, s3, 10
  s_mov_b32 s65, s52
  s_add_u32 m0, s54, 0
  s_add_u32 s38, s53, 0
  buffer_load_dwordx4 v16, s[8:11], s38 offen lds
  s_add_u32 s38, s65, 0
  buffer_load_dwordx4 v[64:67], v2, s[12:15], s38 offen offset:0
  buffer_load_dwordx4 v[68:71], v2, s[12:15], s38 offen offset:1024
  buffer_load_dwordx4 v[72:75], v2, s[12:15], s38 offen offset:2048
  buffer_load_dwordx4 v[76:79], v2, s[12:15], s38 offen offset:3072
  s_add_u32 m0, s54, 8192
  s_add_u32 s38, s53, 262144
  buffer_load_dwordx4 v16, s[8:11], s38 offen lds
  s_add_u32 m0, s54, 16384
  s_add_u32 s38, s53, 524288
  buffer_load_dwordx4 v16, s[8:11], s38 offen lds
  s_add_u32 s38, s65, 4096
  buffer_load_dwordx4 v[80:83], v2, s[12:15], s38 offen offset:0
  buffer_load_dwordx4 v[84:87], v2, s[12:15], s38 offen offset:1024
  buffer_load_dwordx4 v[88:91], v2, s[12:15], s38 offen offset:2048
  buffer_load_dwordx4 v[92:95], v2, s[12:15], s38 offen offset:3072
  s_add_u32 m0, s54, 24576
  s_add_u32 s38, s53, 786432
  buffer_load_dwordx4 v16, s[8:11], s38 offen lds
  s_add_u32 m0, s54, 32768
  s_add_u32 s38, s53, 1048576
  buffer_load_dwordx4 v16, s[8:11], s38 offen lds
  s_add_u32 s38, s65, 8192
  buffer_load_dwordx4 v[96:99], v2, s[12:15], s38 offen offset:0
  buffer_load_dwordx4 v[100:103], v2, s[12:15], s38 offen offset:1024
  buffer_load_dwordx4 v[104:107], v2, s[12:15], s38 offen offset:2048
  buffer_load_dwordx4 v[108:111], v2, s[12:15], s38 offen offset:3072
  s_add_u32 m0, s54, 40960
  s_add_u32 s38, s53, 1310720
  buffer_load_dwordx4 v16, s[8:11], s38 offen lds
  s_add_u32 m0, s54, 49152
  s_add_u32 s38, s53, 1572864
  buffer_load_dwordx4 v16, s[8:11], s38 offen lds
  s_add_u32 s38, s65, 12288
  buffer_load_dwordx4 v[112:115], v2, s[12:15], s38 offen offset:0
  buffer_load_dwordx4 v[116:119], v2, s[12:15], s38 offen offset:1024
  buffer_load_dwordx4 v[120:123], v2, s[12:15], s38 offen offset:2048
  buffer_load_dwordx4 v[124:127], v2, s[12:15], s38 offen offset:3072
  s_add_u32 m0, s54, 57344
  s_add_u32 s38, s53, 1835008
  buffer_load_dwordx4 v16, s[8:11], s38 offen lds
  s_lshl_b32 s34, s28, 20
  s_lshl_b32 s38, s39, 15
  s_add_u32 s34, s34, s38
  s_lshl_b32 s38, s40, 12
  s_add_u32 s34, s34, s38
  s_lshl_b32 s35, s3, 12
  v_bfe_u32 v24, v1, 2, 2
  v_lshrrev_b32 v25, 5, v1
  v_lshl_add_u32 v25, v25, 3, v24
  v_lshlrev_b32 v25, 8, v25
  v_and_b32 v26, 16, v1
  v_lshl_add_u32 v25, v26, 1, v25
  v_and_b32 v26, 3, v1
  v_lshl_add_u32 v25, v26, 3, v25
  v_xor_b32 v26, 0, v24
  v_lshl_add_u32 v20, v26, 6, v25
  v_xor_b32 v26, 1, v24
  v_lshl_add_u32 v21, v26, 6, v25
  v_xor_b32 v26, 2, v24
  v_lshl_add_u32 v22, v26, 6, v25
  v_xor_b32 v26, 3, v24
  v_lshl_add_u32 v23, v26, 6, v25
  s_waitcnt vmcnt(12)
  s_barrier
  ds_read_b64_tr_b16 v[32:33], v20 offset:0
  ds_read_b64_tr_b16 v[34:35], v20 offset:1024
  ds_read_b64_tr_b16 v[36:37], v21 offset:0
  ds_read_b64_tr_b16 v[38:39], v21 offset:1024
  ds_read_b64_tr_b16 v[40:41], v22 offset:0
  ds_read_b64_tr_b16 v[42:43], v22 offset:1024
  ds_read_b64_tr_b16 v[44:45], v23 offset:0
  ds_read_b64_tr_b16 v[46:47], v23 offset:1024
  ds_read_b64_tr_b16 v[48:49], v20 offset:4096
  ds_read_b64_tr_b16 v[50:51], v20 offset:5120
  ds_read_b64_tr_b16 v[52:53], v21 offset:4096
  ds_read_b64_tr_b16 v[54:55], v21 offset:5120
  ds_read_b64_tr_b16 v[56:57], v22 offset:4096
  ds_read_b64_tr_b16 v[58:59], v22 offset:5120
  ds_read_b64_tr_b16 v[60:61], v23 offset:4096
  ds_read_b64_tr_b16 v[62:63], v23 offset:5120
  s_waitcnt lgkmcnt(8)
  v_mfma_f32_32x32x16_bf16 v[192:207], v[32:35], v[64:67], 0
  v_mfma_f32_32x32x16_bf16 v[208:223], v[36:39], v[64:67], 0
  v_mfma_f32_32x32x16_bf16 v[224:239], v[40:43], v[64:67], 0
  v_mfma_f32_32x32x16_bf16 v[240:255], v[44:47], v[64:67], 0
  s_add_u32 m0, s54, 65536
  s_add_u32 s38, s53, 2097152
  buffer_load_dwordx4 v16, s[8:11], s38 offen lds
  s_add_u32 s38, s65, 16384
  buffer_load_dwordx4 v[128:131], v2, s[12:15], s38 offen offset:0
  buffer_load_dwordx4 v[132:135], v2, s[12:15], s38 offen offset:1024
  buffer_load_dwordx4 v[136:139], v2, s[12:15], s38 offen offset:2048
  buffer_load_dwordx4 v[140:143], v2, s[12:15], s38 offen offset:3072
  ds_read_b64_tr_b16 v[32:33], v20 offset:8192
  ds_read_b64_tr_b16 v[34:35], v20 offset:9216
  ds_read_b64_tr_b16 v[36:37], v21 offset:8192
  ds_read_b64_tr_b16 v[38:39], v21 offset:9216
  ds_read_b64_tr_b16 v[40:41], v22 offset:8192
  ds_read_b64_tr_b16 v[42:43], v22 offset:9216
  ds_read_b64_tr_b16 v[44:45], v23 offset:8192
  ds_read_b64_tr_b16 v[46:47], v23 offset:9216
  s_waitcnt lgkmcnt(8)
  v_mfma_f32_32x32x16_bf16 v[192:207], v[48:51], v[68:71], v[192:207]
  v_mfma_f32_32x32x16_bf16 v[208:223], v[52:55], v[68:71], v[208:223]
  v_mfma_f32_32x32x16_bf16 v[224:239], v[56:59], v[68:71], v[224:239]
  v_mfma_f32_32x32x16_bf16 v[240:255], v[60:63], v[68:71], v[240:255]
  ds_read_b64_tr_b16 v[48:49], v20 offset:12288
  ds_read_b64_tr_b16 v[50:51], v20 offset:13312
  ds_read_b64_tr_b16 v[52:53], v21 offset:12288
  ds_read_b64_tr_b16 v[54:55], v21 offset:13312
  ds_read_b64_tr_b16 v[56:57], v22 offset:12288
  ds_read_b64_tr_b16 v[58:59], v22 offset:13312
  ds_read_b64_tr_b16 v[60:61], v23 offset:12288
  ds_read_b64_tr_b16 v[62:63], v23 offset:13312
  s_waitcnt lgkmcnt(8)
  v_mfma_f32_32x32x16_bf16 v[192:207], v[32:35], v[72:75], v[192:207]
  v_mfma_f32_32x32x16_bf16 v[208:223], v[36:39], v[72:75], v[208:223]
  v_mfma_f32_32x32x16_bf16 v[224:239], v[40:43], v[72:75], v[224:239]
  v_mfma_f32_32x32x16_bf16 v[240:255], v[44:47], v[72:75], v[240:255]
  s_add_u32 m0, s54, 73728
  s_add_u32 s38, s53, 2359296
  buffer_load_dwordx4 v16, s[8:11], s38 offen lds
  ds_read_b64_tr_b16 v[32:33], v20 offset:16384
  ds_read_b64_tr_b16 v[34:35], v20 offset:17408
  ds_read_b64_tr_b16 v[36:37], v21 offset:16384
  ds_read_b64_tr_b16 v[38:39], v21 offset:17408
  ds_read_b64_tr_b16 v[40:41], v22 offset:16384
  ds_read_b64_tr_b16 v[42:43], v22 offset:17408
  ds_read_b64_tr_b16 v[44:45], v23 offset:16384
  ds_read_b64_tr_b16 v[46:47], v23 offset:17408
  s_waitcnt lgkmcnt(8)
  v_mfma_f32_32x32x16_bf16 v[192:207], v[48:51], v[76:79], v[192:207]
  v_mfma_f32_32x32x16_bf16 v[208:223], v[52:55], v[76:79], v[208:223]
  v_mfma_f32_32x32x16_bf16 v[224:239], v[56:59], v[76:79], v[224:239]
  v_mfma_f32_32x32x16_bf16 v[240:255], v[60:63], v[76:79], v[240:255]
  ds_read_b64_tr_b16 v[48:49], v20 offset:20480
  ds_read_b64_tr_b16 v[50:51], v20 offset:21504
  ds_read_b64_tr_b16 v[52:53], v21 offset:20480
  ds_read_b64_tr_b16 v[54:55], v21 offset:21504
  ds_read_b64_tr_b16 v[56:57], v22 offset:20480
  ds_read_b64_tr_b16 v[58:59], v22 offset:21504
  ds_read_b64_tr_b16 v[60:61], v23 offset:20480
  ds_read_b64_tr_b16 v[62:63], v23 offset:21504
  s_waitcnt lgkmcnt(8)
  v_mfma_f32_32x32x16_bf16 v[192:207], v[32:35], v[80:83], v[192:207]
  v_mfma_f32_32x32x16_bf16 v[208:223], v[36:39], v[80:83], v[208:223]
  v_mfma_f32_32x32x16_bf16 v[224:239], v[40:43], v[80:83], v[224:239]
  v_mfma_f32_32x32x16_bf16 v[240:255], v[44:47], v[80:83], v[240:255]
  s_add_u32 m0, s54, 81920
  s_add_u32 s38, s53, 2621440
  buffer_load_dwordx4 v16, s[8:11], s38 offen lds
  s_add_u32 s38, s65, 20480
  buffer_load_dwordx4 v[144:147], v2, s[12:15], s38 offen offset:0
  buffer_load_dwordx4 v[148:151], v2, s[12:15], s38 offen offset:1024
  buffer_load_dwordx4 v[152:155], v2, s[12:15], s38 offen offset:2048
  buffer_load_dwordx4 v[156:159], v2, s[12:15], s38 offen offset:3072
  ds_read_b64_tr_b16 v[32:33], v20 offset:24576
  ds_read_b64_tr_b16 v[34:35], v20 offset:25600
  ds_read_b64_tr_b16 v[36:37], v21 offset:24576
  ds_read_b64_tr_b16 v[38:39], v21 offset:25600
  ds_read_b64_tr_b16 v[40:41], v22 offset:24576
  ds_read_b64_tr_b16 v[42:43], v22 offset:25600
  ds_read_b64_tr_b16 v[44:45], v23 offset:24576
  ds_read_b64_tr_b16 v[46:47], v23 offset:25600
  s_waitcnt lgkmcnt(8)
  v_mfma_f32_32x32x16_bf16 v[192:207], v[48:51], v[84:87], v[192:207]
  v_mfma_f32_32x32x16_bf16 v[208:223], v[52:55], v[84:87], v[208:223]
  v_mfma_f32_32x32x16_bf16 v[224:239], v[56:59], v[84:87], v[224:239]
  v_mfma_f32_32x32x16_bf16 v[240:255], v[60:63], v[84:87], v[240:255]
  ds_read_b64_tr_b16 v[48:49], v20 offset:28672
  ds_read_b64_tr_b16 v[50:51], v20 offset:29696
  ds_read_b64_tr_b16 v[52:53], v21 offset:28672
  ds_read_b64_tr_b16 v[54:55], v21 offset:29696
  ds_read_b64_tr_b16 v[56:57], v22 offset:28672
  ds_read_b64_tr_b16 v[58:59], v22 offset:29696
  ds_read_b64_tr_b16 v[60:61], v23 offset:28672
  ds_read_b64_tr_b16 v[62:63], v23 offset:29696
  s_waitcnt lgkmcnt(8)
  v_mfma_f32_32x32x16_bf16 v[192:207], v[32:35], v[88:91], v[192:207]
  v_mfma_f32_32x32x16_bf16 v[208:223], v[36:39], v[88:91], v[208:223]
  v_mfma_f32_32x32x16_bf16 v[224:239], v[40:43], v[88:91], v[224:239]
  v_mfma_f32_32x32x16_bf16 v[240:255], v[44:47], v[88:91], v[240:255]
  s_add_u32 m0, s54, 90112
  s_add_u32 s38, s53, 2883584
  buffer_load_dwordx4 v16, s[8:11], s38 offen lds
  s_waitcnt lgkmcnt(0)
  v_mfma_f32_32x32x16_bf16 v[192:207], v[48:51], v[92:95], v[192:207]
  v_mfma_f32_32x32x16_bf16 v[208:223], v[52:55], v[92:95], v[208:223]
  v_mfma_f32_32x32x16_bf16 v[224:239], v[56:59], v[92:95], v[224:239]
  v_mfma_f32_32x32x16_bf16 v[240:255], v[60:63], v[92:95], v[240:255]
  s_waitcnt vmcnt(12)
  s_barrier
  ds_read_b64_tr_b16 v[32:33], v20 offset:32768
  ds_read_b64_tr_b16 v[34:35], v20 offset:33792
  ds_read_b64_tr_b16 v[36:37], v21 offset:32768
  ds_read_b64_tr_b16 v[38:39], v21 offset:33792
  ds_read_b64_tr_b16 v[40:41], v22 offset:32768
  ds_read_b64_tr_b16 v[42:43], v22 offset:33792
  ds_read_b64_tr_b16 v[44:45], v23 offset:32768
  ds_read_b64_tr_b16 v[46:47], v23 offset:33792
  ds_read_b64_tr_b16 v[48:49], v20 offset:36864
  ds_read_b64_tr_b16 v[50:51], v20 offset:37888
  ds_read_b64_tr_b16 v[52:53], v21 offset:36864
  ds_read_b64_tr_b16 v[54:55], v21 offset:37888
  ds_read_b64_tr_b16 v[56:57], v22 offset:36864
  ds_read_b64_tr_b16 v[58:59], v22 offset:37888
  ds_read_b64_tr_b16 v[60:61], v23 offset:36864
  ds_read_b64_tr_b16 v[62:63], v23 offset:37888
  s_waitcnt lgkmcnt(8)
  v_mfma_f32_32x32x16_bf16 v[192:207], v[32:35], v[96:99], v[192:207]
  v_mfma_f32_32x32x16_bf16 v[208:223], v[36:39], v[96:99], v[208:223]
  v_mfma_f32_32x32x16_bf16 v[224:239], v[40:43], v[96:99], v[224:239]
  v_mfma_f32_32x32x16_bf16 v[240:255], v[44:47], v[96:99], v[240:255]
  s_add_u32 m0, s54, 98304
  s_add_u32 s38, s53, 3145728
  buffer_load_dwordx4 v16, s[8:11], s38 offen lds
  s_add_u32 s38, s65, 24576
  buffer_load_dwordx4 v[160:163], v2, s[12:15], s38 offen offset:0
  buffer_load_dwordx4 v[164:167], v2, s[12:15], s38 offen offset:1024
  buffer_load_dwordx4 v[168:171], v2, s[12:15], s38 offen offset:2048
  buffer_load_dwordx4 v[172:175], v2, s[12:15], s38 offen offset:3072
  ds_read_b64_tr_b16 v[32:33], v20 offset:40960
  ds_read_b64_tr_b16 v[34:35], v20 offset:41984
  ds_read_b64_tr_b16 v[36:37], v21 offset:40960
  ds_read_b64_tr_b16 v[38:39], v21 offset:41984
  ds_read_b64_tr_b16 v[40:41], v22 offset:40960
  ds_read_b64_tr_b16 v[42:43], v22 offset:41984
  ds_read_b64_tr_b16 v[44:45], v23 offset:40960
  ds_read_b64_tr_b16 v[46:47], v23 offset:41984
  s_waitcnt lgkmcnt(8)
  v_mfma_f32_32x32x16_bf16 v[192:207], v[48:51], v[100:103], v[192:207]
  v_mfma_f32_32x32x16_bf16 v[208:223], v[52:55], v[100:103], v[208:223]
  v_mfma_f32_32x32x16_bf16 v[224:239], v[56:59], v[100:103], v[224:239]
  v_mfma_f32_32x32x16_bf16 v[240:255], v[60:63], v[100:103], v[240:255]
  ds_read_b64_tr_b16 v[48:49], v20 offset:45056
  ds_read_b64_tr_b16 v[50:51], v20 offset:46080
  ds_read_b64_tr_b16 v[52:53], v21 offset:45056
  ds_read_b64_tr_b16 v[54:55], v21 offset:46080
  ds_read_b64_tr_b16 v[56:57], v22 offset:45056
  ds_read_b64_tr_b16 v[58:59], v22 offset:46080
  ds_read_b64_tr_b16 v[60:61], v23 offset:45056
  ds_read_b64_tr_b16 v[62:63], v23 offset:46080
  s_waitcnt lgkmcnt(8)
  v_mfma_f32_32x32x16_bf16 v[192:207], v[32:35], v[104:107], v[192:207]
  v_mfma_f32_32x32x16_bf16 v[208:223], v[36:39], v[104:107], v[208:223]
  v_mfma_f32_32x32x16_bf16 v[224:239], v[40:43], v[104:107], v[224:239]
  v_mfma_f32_32x32x16_bf16 v[240:255], v[44:47], v[104:107], v[240:255]
  s_add_u32 m0, s54, 106496
  s_add_u32 s38, s53, 3407872
  buffer_load_dwordx4 v16, s[8:11], s38 offen lds
  ds_read_b64_tr_b16 v[32:33], v20 offset:49152
  ds_read_b64_tr_b16 v[34:35], v20 offset:50176
  ds_read_b64_tr_b16 v[36:37], v21 offset:49152
  ds_read_b64_tr_b16 v[38:39], v21 offset:50176
  ds_read_b64_tr_b16 v[40:41], v22 offset:49152
  ds_read_b64_tr_b16 v[42:43], v22 offset:50176
  ds_read_b64_tr_b16 v[44:45], v23 offset:49152
  ds_read_b64_tr_b16 v[46:47], v23 offset:50176
  s_waitcnt lgkmcnt(8)
  v_mfma_f32_32x32x16_bf16 v[192:207], v[48:51], v[108:111], v[192:207]
  v_mfma_f32_32x32x16_bf16 v[208:223], v[52:55], v[108:111], v[208:223]
  v_mfma_f32_32x32x16_bf16 v[224:239], v[56:59], v[108:111], v[224:239]
  v_mfma_f32_32x32x16_bf16 v[240:255], v[60:63], v[108:111], v[240:255]
  ds_read_b64_tr_b16 v[48:49], v20 offset:53248
  ds_read_b64_tr_b16 v[50:51], v20 offset:54272
  ds_read_b64_tr_b16 v[52:53], v21 offset:53248
  ds_read_b64_tr_b16 v[54:55], v21 offset:54272
  ds_read_b64_tr_b16 v[56:57], v22 offset:53248
  ds_read_b64_tr_b16 v[58:59], v22 offset:54272
  ds_read_b64_tr_b16 v[60:61], v23 offset:53248
  ds_read_b64_tr_b16 v[62:63], v23 offset:54272
  s_waitcnt lgkmcnt(8)
  v_mfma_f32_32x32x16_bf16 v[192:207], v[32:35], v[112:115], v[192:207]
  v_mfma_f32_32x32x16_bf16 v[208:223], v[36:39], v[112:115], v[208:223]
  v_mfma_f32_32x32x16_bf16 v[224:239], v[40:43], v[112:115], v[224:239]
  v_mfma_f32_32x32x16_bf16 v[240:255], v[44:47], v[112:115], v[240:255]
  s_add_u32 m0, s54, 114688
  s_add_u32 s38, s53, 3670016
  buffer_load_dwordx4 v16, s[8:11], s38 offen lds
  s_add_u32 s38, s65, 28672
  buffer_load_dwordx4 v[176:179], v2, s[12:15], s38 offen offset:0
  buffer_load_dwordx4 v[180:183], v2, s[12:15], s38 offen offset:1024
  buffer_load_dwordx4 v[184:187], v2, s[12:15], s38 offen offset:2048
  buffer_load_dwordx4 v[188:191], v2, s[12:15], s38 offen offset:3072
  ds_read_b64_tr_b16 v[32:33], v20 offset:57344
  ds_read_b64_tr_b16 v[34:35], v20 offset:58368
  ds_read_b64_tr_b16 v[36:37], v21 offset:57344
  ds_read_b64_tr_b16 v[38:39], v21 offset:58368
  ds_read_b64_tr_b16 v[40:41], v22 offset:57344
  ds_read_b64_tr_b16 v[42:43], v22 offset:58368
  ds_read_b64_tr_b16 v[44:45], v23 offset:57344
  ds_read_b64_tr_b16 v[46:47], v23 offset:58368
  s_waitcnt lgkmcnt(8)
  v_mfma_f32_32x32x16_bf16 v[192:207], v[48:51], v[116:119], v[192:207]
  v_mfma_f32_32x32x16_bf16 v[208:223], v[52:55], v[116:119], v[208:223]
  v_mfma_f32_32x32x16_bf16 v[224:239], v[56:59], v[116:119], v[224:239]
  v_mfma_f32_32x32x16_bf16 v[240:255], v[60:63], v[116:119], v[240:255]
  ds_read_b64_tr_b16 v[48:49], v20 offset:61440
  ds_read_b64_tr_b16 v[50:51], v20 offset:62464
  ds_read_b64_tr_b16 v[52:53], v21 offset:61440
  ds_read_b64_tr_b16 v[54:55], v21 offset:62464
  ds_read_b64_tr_b16 v[56:57], v22 offset:61440
  ds_read_b64_tr_b16 v[58:59], v22 offset:62464
  ds_read_b64_tr_b16 v[60:61], v23 offset:61440
  ds_read_b64_tr_b16 v[62:63], v23 offset:62464
  s_waitcnt lgkmcnt(8)
  v_mfma_f32_32x32x16_bf16 v[192:207], v[32:35], v[120:123], v[192:207]
  v_mfma_f32_32x32x16_bf16 v[208:223], v[36:39], v[120:123], v[208:223]
  v_mfma_f32_32x32x16_bf16 v[224:239], v[40:43], v[120:123], v[224:239]
  v_mfma_f32_32x32x16_bf16 v[240:255], v[44:47], v[120:123], v[240:255]
  s_add_u32 m0, s54, 122880
  s_add_u32 s38, s53, 3932160
  buffer_load_dwordx4 v16, s[8:11], s38 offen lds
  s_waitcnt lgkmcnt(0)
  v_mfma_f32_32x32x16_bf16 v[192:207], v[48:51], v[124:127], v[192:207]
  v_mfma_f32_32x32x16_bf16 v[208:223], v[52:55], v[124:127], v[208:223]
  v_mfma_f32_32x32x16_bf16 v[224:239], v[56:59], v[124:127], v[224:239]
  v_mfma_f32_32x32x16_bf16 v[240:255], v[60:63], v[124:127], v[240:255]
  s_waitcnt vmcnt(12)
  s_barrier
  v_add_u32 v20, 0x10000, v20
  v_add_u32 v21, 0x10000, v21
  v_add_u32 v22, 0x10000, v22
  v_add_u32 v23, 0x10000, v23
  ds_read_b64_tr_b16 v[32:33], v20 offset:0
  ds_read_b64_tr_b16 v[34:35], v20 offset:1024
  ds_read_b64_tr_b16 v[36:37], v21 offset:0
  ds_read_b64_tr_b16 v[38:39], v21 offset:1024
  ds_read_b64_tr_b16 v[40:41], v22 offset:0
  ds_read_b64_tr_b16 v[42:43], v22 offset:1024
  ds_read_b64_tr_b16 v[44:45], v23 offset:0
  ds_read_b64_tr_b16 v[46:47], v23 offset:1024
  s_add_u32 s38, s34, 0
  s_add_u32 m0, s35, 0
  s_nop 0
  buffer_load_dwordx4 v2, s[16:19], s38 offen offset:0 lds
  buffer_load_dwordx4 v2, s[16:19], s38 offen offset:1024 lds
  buffer_load_dwordx4 v2, s[16:19], s38 offen offset:2048 lds
  buffer_load_dwordx4 v2, s[16:19], s38 offen offset:3072 lds
  s_add_u32 s38, s34, 65536
  s_add_u32 m0, s35, 32768
  s_nop 0
  buffer_load_dwordx4 v2, s[16:19], s38 offen offset:0 lds
  buffer_load_dwordx4 v2, s[16:19], s38 offen offset:1024 lds
  buffer_load_dwordx4 v2, s[16:19], s38 offen offset:2048 lds
  buffer_load_dwordx4 v2, s[16:19], s38 offen offset:3072 lds
  ds_read_b64_tr_b16 v[48:49], v20 offset:4096
  ds_read_b64_tr_b16 v[50:51], v20 offset:5120
  ds_read_b64_tr_b16 v[52:53], v21 offset:4096
  ds_read_b64_tr_b16 v[54:55], v21 offset:5120
  ds_read_b64_tr_b16 v[56:57], v22 offset:4096
  ds_read_b64_tr_b16 v[58:59], v22 offset:5120
  ds_read_b64_tr_b16 v[60:61], v23 offset:4096
  ds_read_b64_tr_b16 v[62:63], v23 offset:5120
  s_waitcnt lgkmcnt(8)
  v_mfma_f32_32x32x16_bf16 v[192:207], v[32:35], v[128:131], v[192:207]
  v_mfma_f32_32x32x16_bf16 v[208:223], v[36:39], v[128:131], v[208:223]
  v_mfma_f32_32x32x16_bf16 v[224:239], v[40:43], v[128:131], v[224:239]
  v_mfma_f32_32x32x16_bf16 v[240:255], v[44:47], v[128:131], v[240:255]
  ds_read_b64_tr_b16 v[32:33], v20 offset:8192
  ds_read_b64_tr_b16 v[34:35], v20 offset:9216
  ds_read_b64_tr_b16 v[36:37], v21 offset:8192
  ds_read_b64_tr_b16 v[38:39], v21 offset:9216
  ds_read_b64_tr_b16 v[40:41], v22 offset:8192
  ds_read_b64_tr_b16 v[42:43], v22 offset:9216
  ds_read_b64_tr_b16 v[44:45], v23 offset:8192
  ds_read_b64_tr_b16 v[46:47], v23 offset:9216
  s_waitcnt lgkmcnt(8)
  v_mfma_f32_32x32x16_bf16 v[192:207], v[48:51], v[132:135], v[192:207]
  v_mfma_f32_32x32x16_bf16 v[208:223], v[52:55], v[132:135], v[208:223]
  v_mfma_f32_32x32x16_bf16 v[224:239], v[56:59], v[132:135], v[224:239]
  v_mfma_f32_32x32x16_bf16 v[240:255], v[60:63], v[132:135], v[240:255]
  ds_read_b64_tr_b16 v[48:49], v20 offset:12288
  ds_read_b64_tr_b16 v[50:51], v20 offset:13312
  ds_read_b64_tr_b16 v[52:53], v21 offset:12288
  ds_read_b64_tr_b16 v[54:55], v21 offset:13312
  ds_read_b64_tr_b16 v[56:57], v22 offset:12288
  ds_read_b64_tr_b16 v[58:59], v22 offset:13312
  ds_read_b64_tr_b16 v[60:61], v23 offset:12288
  ds_read_b64_tr_b16 v[62:63], v23 offset:13312
  s_waitcnt lgkmcnt(8)
  v_mfma_f32_32x32x16_bf16 v[192:207], v[32:35], v[136:139], v[192:207]
  v_mfma_f32_32x32x16_bf16 v[208:223], v[36:39], v[136:139], v[208:223]
  v_mfma_f32_32x32x16_bf16 v[224:239], v[40:43], v[136:139], v[224:239]
  v_mfma_f32_32x32x16_bf16 v[240:255], v[44:47], v[136:139], v[240:255]
  ds_read_b64_tr_b16 v[32:33], v20 offset:16384
  ds_read_b64_tr_b16 v[34:35], v20 offset:17408
  ds_read_b64_tr_b16 v[36:37], v21 offset:16384
  ds_read_b64_tr_b16 v[38:39], v21 offset:17408
  ds_read_b64_tr_b16 v[40:41], v22 offset:16384
  ds_read_b64_tr_b16 v[42:43], v22 offset:17408
  ds_read_b64_tr_b16 v[44:45], v23 offset:16384
  ds_read_b64_tr_b16 v[46:47], v23 offset:17408
  s_waitcnt lgkmcnt(8)
  v_mfma_f32_32x32x16_bf16 v[192:207], v[48:51], v[140:143], v[192:207]
  v_mfma_f32_32x32x16_bf16 v[208:223], v[52:55], v[140:143], v[208:223]
  v_mfma_f32_32x32x16_bf16 v[224:239], v[56:59], v[140:143], v[224:239]
  v_mfma_f32_32x32x16_bf16 v[240:255], v[60:63], v[140:143], v[240:255]
  ds_read_b64_tr_b16 v[48:49], v20 offset:20480
  ds_read_b64_tr_b16 v[50:51], v20 offset:21504
  ds_read_b64_tr_b16 v[52:53], v21 offset:20480
  ds_read_b64_tr_b16 v[54:55], v21 offset:21504
  ds_read_b64_tr_b16 v[56:57], v22 offset:20480
  ds_read_b64_tr_b16 v[58:59], v22 offset:21504
  ds_read_b64_tr_b16 v[60:61], v23 offset:20480
  ds_read_b64_tr_b16 v[62:63], v23 offset:21504
  s_waitcnt lgkmcnt(8)
  v_mfma_f32_32x32x16_bf16 v[192:207], v[32:35], v[144:147], v[192:207]
  v_mfma_f32_32x32x16_bf16 v[208:223], v[36:39], v[144:147], v[208:223]
  v_mfma_f32_32x32x16_bf16 v[224:239], v[40:43], v[144:147], v[224:239]
  v_mfma_f32_32x32x16_bf16 v[240:255], v[44:47], v[144:147], v[240:255]
  ds_read_b64_tr_b16 v[32:33], v20 offset:24576
  ds_read_b64_tr_b16 v[34:35], v20 offset:25600
  ds_read_b64_tr_b16 v[36:37], v21 offset:24576
  ds_read_b64_tr_b16 v[38:39], v21 offset:25600
  ds_read_b64_tr_b16 v[40:41], v22 offset:24576
  ds_read_b64_tr_b16 v[42:43], v22 offset:25600
  ds_read_b64_tr_b16 v[44:45], v23 offset:24576
  ds_read_b64_tr_b16 v[46:47], v23 offset:25600
  s_waitcnt lgkmcnt(8)
  v_mfma_f32_32x32x16_bf16 v[192:207], v[48:51], v[148:151], v[192:207]
  v_mfma_f32_32x32x16_bf16 v[208:223], v[52:55], v[148:151], v[208:223]
  v_mfma_f32_32x32x16_bf16 v[224:239], v[56:59], v[148:151], v[224:239]
  v_mfma_f32_32x32x16_bf16 v[240:255], v[60:63], v[148:151], v[240:255]
  ds_read_b64_tr_b16 v[48:49], v20 offset:28672
  ds_read_b64_tr_b16 v[50:51], v20 offset:29696
  ds_read_b64_tr_b16 v[52:53], v21 offset:28672
  ds_read_b64_tr_b16 v[54:55], v21 offset:29696
  ds_read_b64_tr_b16 v[56:57], v22 offset:28672
  ds_read_b64_tr_b16 v[58:59], v22 offset:29696
  ds_read_b64_tr_b16 v[60:61], v23 offset:28672
  ds_read_b64_tr_b16 v[62:63], v23 offset:29696
  s_waitcnt lgkmcnt(8)
  v_mfma_f32_32x32x16_bf16 v[192:207], v[32:35], v[152:155], v[192:207]
  v_mfma_f32_32x32x16_bf16 v[208:223], v[36:39], v[152:155], v[208:223]
  v_mfma_f32_32x32x16_bf16 v[224:239], v[40:43], v[152:155], v[224:239]
  v_mfma_f32_32x32x16_bf16 v[240:255], v[44:47], v[152:155], v[240:255]
  s_waitcnt lgkmcnt(0)
  v_mfma_f32_32x32x16_bf16 v[192:207], v[48:51], v[156:159], v[192:207]
  v_mfma_f32_32x32x16_bf16 v[208:223], v[52:55], v[156:159], v[208:223]
  v_mfma_f32_32x32x16_bf16 v[224:239], v[56:59], v[156:159], v[224:239]
  v_mfma_f32_32x32x16_bf16 v[240:255], v[60:63], v[156:159], v[240:255]
  s_waitcnt vmcnt(8)
  s_barrier
  ds_read_b64_tr_b16 v[32:33], v20 offset:32768
  ds_read_b64_tr_b16 v[34:35], v20 offset:33792
  ds_read_b64_tr_b16 v[36:37], v21 offset:32768
  ds_read_b64_tr_b16 v[38:39], v21 offset:33792
  ds_read_b64_tr_b16 v[40:41], v22 offset:32768
  ds_read_b64_tr_b16 v[42:43], v22 offset:33792
  ds_read_b64_tr_b16 v[44:45], v23 offset:32768
  ds_read_b64_tr_b16 v[46:47], v23 offset:33792
  s_add_u32 s38, s34, 16384
  s_add_u32 m0, s35, 65536
  s_nop 0
  buffer_load_dwordx4 v2, s[16:19], s38 offen offset:0 lds
  buffer_load_dwordx4 v2, s[16:19], s38 offen offset:1024 lds
  buffer_load_dwordx4 v2, s[16:19], s38 offen offset:2048 lds
  buffer_load_dwordx4 v2, s[16:19], s38 offen offset:3072 lds
  ds_read_b64_tr_b16 v[48:49], v20 offset:36864
  ds_read_b64_tr_b16 v[50:51], v20 offset:37888
  ds_read_b64_tr_b16 v[52:53], v21 offset:36864
  ds_read_b64_tr_b16 v[54:55], v21 offset:37888
  ds_read_b64_tr_b16 v[56:57], v22 offset:36864
  ds_read_b64_tr_b16 v[58:59], v22 offset:37888
  ds_read_b64_tr_b16 v[60:61], v23 offset:36864
  ds_read_b64_tr_b16 v[62:63], v23 offset:37888
  s_waitcnt lgkmcnt(8)
  v_mfma_f32_32x32x16_bf16 v[192:207], v[32:35], v[160:163], v[192:207]
  v_mfma_f32_32x32x16_bf16 v[208:223], v[36:39], v[160:163], v[208:223]
  v_mfma_f32_32x32x16_bf16 v[224:239], v[40:43], v[160:163], v[224:239]
  v_mfma_f32_32x32x16_bf16 v[240:255], v[44:47], v[160:163], v[240:255]
  ds_read_b64_tr_b16 v[32:33], v20 offset:40960
  ds_read_b64_tr_b16 v[34:35], v20 offset:41984
  ds_read_b64_tr_b16 v[36:37], v21 offset:40960
  ds_read_b64_tr_b16 v[38:39], v21 offset:41984
  ds_read_b64_tr_b16 v[40:41], v22 offset:40960
  ds_read_b64_tr_b16 v[42:43], v22 offset:41984
  ds_read_b64_tr_b16 v[44:45], v23 offset:40960
  ds_read_b64_tr_b16 v[46:47], v23 offset:41984
  s_waitcnt lgkmcnt(8)
  v_mfma_f32_32x32x16_bf16 v[192:207], v[48:51], v[164:167], v[192:207]
  v_mfma_f32_32x32x16_bf16 v[208:223], v[52:55], v[164:167], v[208:223]
  v_mfma_f32_32x32x16_bf16 v[224:239], v[56:59], v[164:167], v[224:239]
  v_mfma_f32_32x32x16_bf16 v[240:255], v[60:63], v[164:167], v[240:255]
  ds_read_b64_tr_b16 v[48:49], v20 offset:45056
  ds_read_b64_tr_b16 v[50:51], v20 offset:46080
  ds_read_b64_tr_b16 v[52:53], v21 offset:45056
  ds_read_b64_tr_b16 v[54:55], v21 offset:46080
  ds_read_b64_tr_b16 v[56:57], v22 offset:45056
  ds_read_b64_tr_b16 v[58:59], v22 offset:46080
  ds_read_b64_tr_b16 v[60:61], v23 offset:45056
  ds_read_b64_tr_b16 v[62:63], v23 offset:46080
  s_waitcnt lgkmcnt(8)
  v_mfma_f32_32x32x16_bf16 v[192:207], v[32:35], v[168:171], v[192:207]
  v_mfma_f32_32x32x16_bf16 v[208:223], v[36:39], v[168:171], v[208:223]
  v_mfma_f32_32x32x16_bf16 v[224:239], v[40:43], v[168:171], v[224:239]
  v_mfma_f32_32x32x16_bf16 v[240:255], v[44:47], v[168:171], v[240:255]
  ds_read_b64_tr_b16 v[32:33], v20 offset:49152
  ds_read_b64_tr_b16 v[34:35], v20 offset:50176
  ds_read_b64_tr_b16 v[36:37], v21 offset:49152
  ds_read_b64_tr_b16 v[38:39], v21 offset:50176
  ds_read_b64_tr_b16 v[40:41], v22 offset:49152
  ds_read_b64_tr_b16 v[42:43], v22 offset:50176
  ds_read_b64_tr_b16 v[44:45], v23 offset:49152
  ds_read_b64_tr_b16 v[46:47], v23 offset:50176
  s_waitcnt lgkmcnt(8)
  v_mfma_f32_32x32x16_bf16 v[192:207], v[48:51], v[172:175], v[192:207]
  v_mfma_f32_32x32x16_bf16 v[208:223], v[52:55], v[172:175], v[208:223]
  v_mfma_f32_32x32x16_bf16 v[224:239], v[56:59], v[172:175], v[224:239]
  v_mfma_f32_32x32x16_bf16 v[240:255], v[60:63], v[172:175], v[240:255]
  ds_read_b64_tr_b16 v[48:49], v20 offset:53248
  ds_read_b64_tr_b16 v[50:51], v20 offset:54272
  ds_read_b64_tr_b16 v[52:53], v21 offset:53248
  ds_read_b64_tr_b16 v[54:55], v21 offset:54272
  ds_read_b64_tr_b16 v[56:57], v22 offset:53248
  ds_read_b64_tr_b16 v[58:59], v22 offset:54272
  ds_read_b64_tr_b16 v[60:61], v23 offset:53248
  ds_read_b64_tr_b16 v[62:63], v23 offset:54272
  s_waitcnt lgkmcnt(8)
  v_mfma_f32_32x32x16_bf16 v[192:207], v[32:35], v[176:179], v[192:207]
  v_mfma_f32_32x32x16_bf16 v[208:223], v[36:39], v[176:179], v[208:223]
  v_mfma_f32_32x32x16_bf16 v[224:239], v[40:43], v[176:179], v[224:239]
  v_mfma_f32_32x32x16_bf16 v[240:255], v[44:47], v[176:179], v[240:255]
  ds_read_b64_tr_b16 v[32:33], v20 offset:57344
  ds_read_b64_tr_b16 v[34:35], v20 offset:58368
  ds_read_b64_tr_b16 v[36:37], v21 offset:57344
  ds_read_b64_tr_b16 v[38:39], v21 offset:58368
  ds_read_b64_tr_b16 v[40:41], v22 offset:57344
  ds_read_b64_tr_b16 v[42:43], v22 offset:58368
  ds_read_b64_tr_b16 v[44:45], v23 offset:57344
  ds_read_b64_tr_b16 v[46:47], v23 offset:58368
  s_waitcnt lgkmcnt(8)
  v_mfma_f32_32x32x16_bf16 v[192:207], v[48:51], v[180:183], v[192:207]
  v_mfma_f32_32x32x16_bf16 v[208:223], v[52:55], v[180:183], v[208:223]
  v_mfma_f32_32x32x16_bf16 v[224:239], v[56:59], v[180:183], v[224:239]
  v_mfma_f32_32x32x16_bf16 v[240:255], v[60:63], v[180:183], v[240:255]
  ds_read_b64_tr_b16 v[48:49], v20 offset:61440
  ds_read_b64_tr_b16 v[50:51], v20 offset:62464
  ds_read_b64_tr_b16 v[52:53], v21 offset:61440
  ds_read_b64_tr_b16 v[54:55], v21 offset:62464
  ds_read_b64_tr_b16 v[56:57], v22 offset:61440
  ds_read_b64_tr_b16 v[58:59], v22 offset:62464
  ds_read_b64_tr_b16 v[60:61], v23 offset:61440
  ds_read_b64_tr_b16 v[62:63], v23 offset:62464
  s_waitcnt lgkmcnt(8)
  v_mfma_f32_32x32x16_bf16 v[192:207], v[32:35], v[184:187], v[192:207]
  v_mfma_f32_32x32x16_bf16 v[208:223], v[36:39], v[184:187], v[208:223]
  v_mfma_f32_32x32x16_bf16 v[224:239], v[40:43], v[184:187], v[224:239]
  v_mfma_f32_32x32x16_bf16 v[240:255], v[44:47], v[184:187], v[240:255]
  s_waitcnt lgkmcnt(0)
  v_mfma_f32_32x32x16_bf16 v[192:207], v[48:51], v[188:191], v[192:207]
  v_mfma_f32_32x32x16_bf16 v[208:223], v[52:55], v[188:191], v[208:223]
  v_mfma_f32_32x32x16_bf16 v[224:239], v[56:59], v[188:191], v[224:239]
  v_mfma_f32_32x32x16_bf16 v[240:255], v[60:63], v[188:191], v[240:255]
  s_nop 8
  v_mul_f32 v192, s41, v192
  v_mul_f32 v193, s41, v193
  v_mul_f32 v194, s41, v194
  v_mul_f32 v195, s41, v195
  v_mul_f32 v196, s41, v196
  v_mul_f32 v197, s41, v197
  v_mul_f32 v198, s41, v198
  v_mul_f32 v199, s41, v199
  v_mul_f32 v200, s41, v200
  v_mul_f32 v201, s41, v201
  v_mul_f32 v202, s41, v202
  v_mul_f32 v203, s41, v203
  v_mul_f32 v204, s41, v204
  v_mul_f32 v205, s41, v205
  v_mul_f32 v206, s41, v206
  v_mul_f32 v207, s41, v207
  v_mul_f32 v208, s41, v208
  v_mul_f32 v209, s41, v209
  v_mul_f32 v210, s41, v210
  v_mul_f32 v211, s41, v211
  v_mul_f32 v212, s41, v212
  v_mul_f32 v213, s41, v213
  v_mul_f32 v214, s41, v214
  v_mul_f32 v215, s41, v215
  v_mul_f32 v216, s41, v216
  v_mul_f32 v217, s41, v217
  v_mul_f32 v218, s41, v218
  v_mul_f32 v219, s41, v219
  v_mul_f32 v220, s41, v220
  v_mul_f32 v221, s41, v221
  v_mul_f32 v222, s41, v222
  v_mul_f32 v223, s41, v223
  v_mul_f32 v224, s41, v224
  v_mul_f32 v225, s41, v225
  v_mul_f32 v226, s41, v226
  v_mul_f32 v227, s41, v227
  v_mul_f32 v228, s41, v228
  v_mul_f32 v229, s41, v229
  v_mul_f32 v230, s41, v230
  v_mul_f32 v231, s41, v231
  v_mul_f32 v232, s41, v232
  v_mul_f32 v233, s41, v233
  v_mul_f32 v234, s41, v234
  v_mul_f32 v235, s41, v235
  v_mul_f32 v236, s41, v236
  v_mul_f32 v237, s41, v237
  v_mul_f32 v238, s41, v238
  v_mul_f32 v239, s41, v239
  v_mul_f32 v240, s41, v240
  v_mul_f32 v241, s41, v241
  v_mul_f32 v242, s41, v242
  v_mul_f32 v243, s41, v243
  v_mul_f32 v244, s41, v244
  v_mul_f32 v245, s41, v245
  v_mul_f32 v246, s41, v246
  v_mul_f32 v247, s41, v247
  v_mul_f32 v248, s41, v248
  v_mul_f32 v249, s41, v249
  v_mul_f32 v250, s41, v250
  v_mul_f32 v251, s41, v251
  v_mul_f32 v252, s41, v252
  v_mul_f32 v253, s41, v253
  v_mul_f32 v254, s41, v254
  v_mul_f32 v255, s41, v255
  v_cvt_pk_bf16_f32 v96, v192, v193
  v_cvt_pk_bf16_f32 v97, v194, v195
  v_cvt_pk_bf16_f32 v98, v196, v197
  v_cvt_pk_bf16_f32 v99, v198, v199
  v_cvt_pk_bf16_f32 v100, v200, v201
  v_cvt_pk_bf16_f32 v101, v202, v203
  v_cvt_pk_bf16_f32 v102, v204, v205
  v_cvt_pk_bf16_f32 v103, v206, v207
  v_cvt_pk_bf16_f32 v104, v208, v209
  v_cvt_pk_bf16_f32 v105, v210, v211
  v_cvt_pk_bf16_f32 v106, v212, v213
  v_cvt_pk_bf16_f32 v107, v214, v215
  v_cvt_pk_bf16_f32 v108, v216, v217
  v_cvt_pk_bf16_f32 v109, v218, v219
  v_cvt_pk_bf16_f32 v110, v220, v221
  v_cvt_pk_bf16_f32 v111, v222, v223
  v_cvt_pk_bf16_f32 v112, v224, v225
  v_cvt_pk_bf16_f32 v113, v226, v227
  v_cvt_pk_bf16_f32 v114, v228, v229
  v_cvt_pk_bf16_f32 v115, v230, v231
  v_cvt_pk_bf16_f32 v116, v232, v233
  v_cvt_pk_bf16_f32 v117, v234, v235
  v_cvt_pk_bf16_f32 v118, v236, v237
  v_cvt_pk_bf16_f32 v119, v238, v239
  v_cvt_pk_bf16_f32 v120, v240, v241
  v_cvt_pk_bf16_f32 v121, v242, v243
  v_cvt_pk_bf16_f32 v122, v244, v245
  v_cvt_pk_bf16_f32 v123, v246, v247
  v_cvt_pk_bf16_f32 v124, v248, v249
  v_cvt_pk_bf16_f32 v125, v250, v251
  v_cvt_pk_bf16_f32 v126, v252, v253
  v_cvt_pk_bf16_f32 v127, v254, v255
  s_lshl_b32 s61, s40, 13
  s_add_u32 s61, s61, 0x20000
  v_add_u32 v20, s61, v2
  s_cmp_eq_u32 s39, 1
  s_cbranch_scc1 k2_kernel_qa1
  ds_write_b128 v20, v[96:99] offset:0
  ds_write_b128 v20, v[100:103] offset:1024
  ds_write_b128 v20, v[104:107] offset:2048
  ds_write_b128 v20, v[108:111] offset:3072
  ds_write_b128 v20, v[112:115] offset:4096
  ds_write_b128 v20, v[116:119] offset:5120
  ds_write_b128 v20, v[120:123] offset:6144
  ds_write_b128 v20, v[124:127] offset:7168
k2_kernel_qa1:
  v_and_b32 v20, 31, v1
  v_lshrrev_b32 v21, 5, v1
  v_lshlrev_b32 v21, 2, v21
  v_sub_u32 v20, v20, v21
  s_lshl_b32 s38, s40, 5
  v_add_u32 v13, s38, v20
  v_mov_b32 v14, 0xff800000
  v_mov_b32 v3, v2
  v_mov_b32 v5, 0
  v_mov_b32 v8, 0
  v_mov_b32 v9, 0
  s_mov_b32 s31, 0
  s_mov_b32 s32, 2
  s_mov_b32 s33, 1
  s_mov_b32 s62, 0
  s_mov_b32 s63, 0
  v_mov_b32 v192, 0
  v_mov_b32 v193, 0
  v_mov_b32 v194, 0
  v_mov_b32 v195, 0
  v_mov_b32 v196, 0
  v_mov_b32 v197, 0
  v_mov_b32 v198, 0
  v_mov_b32 v199, 0
  v_mov_b32 v200, 0
  v_mov_b32 v201, 0
  v_mov_b32 v202, 0
  v_mov_b32 v203, 0
  v_mov_b32 v204, 0
  v_mov_b32 v205, 0
  v_mov_b32 v206, 0
  v_mov_b32 v207, 0
  v_mov_b32 v208, 0
  v_mov_b32 v209, 0
  v_mov_b32 v210, 0
  v_mov_b32 v211, 0
  v_mov_b32 v212, 0
  v_mov_b32 v213, 0
  v_mov_b32 v214, 0
  v_mov_b32 v215, 0
  v_mov_b32 v216, 0
  v_mov_b32 v217, 0
  v_mov_b32 v218, 0
  v_mov_b32 v219, 0
  v_mov_b32 v220, 0
  v_mov_b32 v221, 0
  v_mov_b32 v222, 0
  v_mov_b32 v223, 0
  v_mov_b32 v224, 0
  v_mov_b32 v225, 0
  v_mov_b32 v226, 0
  v_mov_b32 v227, 0
  v_mov_b32 v228, 0
  v_mov_b32 v229, 0
  v_mov_b32 v230, 0
  v_mov_b32 v231, 0
  v_mov_b32 v232, 0
  v_mov_b32 v233, 0
  v_mov_b32 v234, 0
  v_mov_b32 v235, 0
  v_mov_b32 v236, 0
  v_mov_b32 v237, 0
  v_mov_b32 v238, 0
  v_mov_b32 v239, 0
  v_mov_b32 v240, 0
  v_mov_b32 v241, 0
  v_mov_b32 v242, 0
  v_mov_b32 v243, 0
  v_mov_b32 v244, 0
  v_mov_b32 v245, 0
  v_mov_b32 v246, 0
  v_mov_b32 v247, 0
  v_mov_b32 v248, 0
  v_mov_b32 v249, 0
  v_mov_b32 v250, 0
  v_mov_b32 v251, 0
  v_mov_b32 v252, 0
  v_mov_b32 v253, 0
  v_mov_b32 v254, 0
  v_mov_b32 v255, 0
  s_waitcnt vmcnt(4) lgkmcnt(0)
  s_barrier
  ds_read_b128 v[32:35], v3 offset:0
  ds_read_b128 v[36:39], v3 offset:8192
  ds_read_b128 v[40:43], v3 offset:1024
  ds_read_b128 v[44:47], v3 offset:9216
  ds_read_b128 v[48:51], v3 offset:2048
  ds_read_b128 v[52:55], v3 offset:10240
  s_waitcnt lgkmcnt(4)
  v_mfma_f32_32x32x16_bf16 v[128:143], v[32:35], v[96:99], 0
  v_mfma_f32_32x32x16_bf16 v[144:159], v[36:39], v[96:99], 0
  ds_read_b128 v[56:59], v3 offset:3072
  ds_read_b128 v[60:63], v3 offset:11264
  s_waitcnt lgkmcnt(4)
  v_mfma_f32_32x32x16_bf16 v[128:143], v[40:43], v[100:103], v[128:143]
  v_mfma_f32_32x32x16_bf16 v[144:159], v[44:47], v[100:103], v[144:159]
  ds_read_b128 v[32:35], v3 offset:4096
  ds_read_b128 v[36:39], v3 offset:12288
  s_waitcnt lgkmcnt(4)
  v_mfma_f32_32x32x16_bf16 v[128:143], v[48:51], v[104:107], v[128:143]
  v_mfma_f32_32x32x16_bf16 v[144:159], v[52:55], v[104:107], v[144:159]
  ds_read_b128 v[40:43], v3 offset:5120
  ds_read_b128 v[44:47], v3 offset:13312
  s_waitcnt lgkmcnt(4)
  v_mfma_f32_32x32x16_bf16 v[128:143], v[56:59], v[108:111], v[128:143]
  v_mfma_f32_32x32x16_bf16 v[144:159], v[60:63], v[108:111], v[144:159]
  ds_read_b128 v[48:51], v3 offset:6144
  ds_read_b128 v[52:55], v3 offset:14336
  s_waitcnt lgkmcnt(4)
  v_mfma_f32_32x32x16_bf16 v[128:143], v[32:35], v[112:115], v[128:143]
  v_mfma_f32_32x32x16_bf16 v[144:159], v[36:39], v[112:115], v[144:159]
  ds_read_b128 v[56:59], v3 offset:7168
  ds_read_b128 v[60:63], v3 offset:15360
  s_waitcnt lgkmcnt(4)
  v_mfma_f32_32x32x16_bf16 v[128:143], v[40:43], v[116:119], v[128:143]
  v_mfma_f32_32x32x16_bf16 v[144:159], v[44:47], v[116:119], v[144:159]
  s_waitcnt lgkmcnt(2)
  v_mfma_f32_32x32x16_bf16 v[128:143], v[48:51], v[120:123], v[128:143]
  v_mfma_f32_32x32x16_bf16 v[144:159], v[52:55], v[120:123], v[144:159]
  s_waitcnt lgkmcnt(0)
  v_mfma_f32_32x32x16_bf16 v[128:143], v[56:59], v[124:127], v[128:143]
  v_mfma_f32_32x32x16_bf16 v[144:159], v[60:63], v[124:127], v[144:159]
  s_lshl_b32 s52, s39, 6
  s_cmp_eq_u32 s31, 16
  s_cbranch_scc1 k2_kernel_domask3
  s_cmp_eq_u32 s39, 0
  s_cbranch_scc1 k2_kernel_nomask2
  s_sub_i32 s52, s30, s31
  s_cmp_gt_i32 s52, 2
  s_cbranch_scc1 k2_kernel_nomask2
  s_cmp_lt_i32 s52, 1
  s_cbranch_scc1 k2_kernel_nomask2
  s_sub_u32 s52, 2, s52
  s_lshl_b32 s52, s52, 6
k2_kernel_domask3:
  v_subrev_u32 v7, s52, v13
  v_cmp_le_i32 s[44:45], 0, v7
  v_cmp_le_i32 s[46:47], 1, v7
  v_cmp_le_i32 s[48:49], 2, v7
  v_cmp_le_i32 s[50:51], 3, v7
  v_cndmask_b32 v128, v14, v128, s[44:45]
  v_cndmask_b32 v129, v14, v129, s[46:47]
  v_cndmask_b32 v130, v14, v130, s[48:49]
  v_cndmask_b32 v131, v14, v131, s[50:51]
  v_cmp_le_i32 s[44:45], 8, v7
  v_cmp_le_i32 s[46:47], 9, v7
  v_cmp_le_i32 s[48:49], 10, v7
  v_cmp_le_i32 s[50:51], 11, v7
  v_cndmask_b32 v132, v14, v132, s[44:45]
  v_cndmask_b32 v133, v14, v133, s[46:47]
  v_cndmask_b32 v134, v14, v134, s[48:49]
  v_cndmask_b32 v135, v14, v135, s[50:51]
  v_cmp_le_i32 s[44:45], 16, v7
  v_cmp_le_i32 s[46:47], 17, v7
  v_cmp_le_i32 s[48:49], 18, v7
  v_cmp_le_i32 s[50:51], 19, v7
  v_cndmask_b32 v136, v14, v136, s[44:45]
  v_cndmask_b32 v137, v14, v137, s[46:47]
  v_cndmask_b32 v138, v14, v138, s[48:49]
  v_cndmask_b32 v139, v14, v139, s[50:51]
  v_cmp_le_i32 s[44:45], 24, v7
  v_cmp_le_i32 s[46:47], 25, v7
  v_cmp_le_i32 s[48:49], 26, v7
  v_cmp_le_i32 s[50:51], 27, v7
  v_cndmask_b32 v140, v14, v140, s[44:45]
  v_cndmask_b32 v141, v14, v141, s[46:47]
  v_cndmask_b32 v142, v14, v142, s[48:49]
  v_cndmask_b32 v143, v14, v143, s[50:51]
  v_cmp_le_i32 s[44:45], 32, v7
  v_cmp_le_i32 s[46:47], 33, v7
  v_cmp_le_i32 s[48:49], 34, v7
  v_cmp_le_i32 s[50:51], 35, v7
  v_cndmask_b32 v144, v14, v144, s[44:45]
  v_cndmask_b32 v145, v14, v145, s[46:47]
  v_cndmask_b32 v146, v14, v146, s[48:49]
  v_cndmask_b32 v147, v14, v147, s[50:51]
  v_cmp_le_i32 s[44:45], 40, v7
  v_cmp_le_i32 s[46:47], 41, v7
  v_cmp_le_i32 s[48:49], 42, v7
  v_cmp_le_i32 s[50:51], 43, v7
  v_cndmask_b32 v148, v14, v148, s[44:45]
  v_cndmask_b32 v149, v14, v149, s[46:47]
  v_cndmask_b32 v150, v14, v150, s[48:49]
  v_cndmask_b32 v151, v14, v151, s[50:51]
  v_cmp_le_i32 s[44:45], 48, v7
  v_cmp_le_i32 s[46:47], 49, v7
  v_cmp_le_i32 s[48:49], 50, v7
  v_cmp_le_i32 s[50:51], 51, v7
  v_cndmask_b32 v152, v14, v152, s[44:45]
  v_cndmask_b32 v153, v14, v153, s[46:47]
  v_cndmask_b32 v154, v14, v154, s[48:49]
  v_cndmask_b32 v155, v14, v155, s[50:51]
  v_cmp_le_i32 s[44:45], 56, v7
  v_cmp_le_i32 s[46:47], 57, v7
  v_cmp_le_i32 s[48:49], 58, v7
  v_cmp_le_i32 s[50:51], 59, v7
  v_cndmask_b32 v156, v14, v156, s[44:45]
  v_cndmask_b32 v157, v14, v157, s[46:47]
  v_cndmask_b32 v158, v14, v158, s[48:49]
  v_cndmask_b32 v159, v14, v159, s[50:51]
k2_kernel_nomask2:
  v_max3_f32 v10, v128, v129, v130
  v_max3_f32 v12, v131, v132, v133
  v_max3_f32 v10, v10, v134, v135
  v_max3_f32 v12, v12, v136, v137
  v_max3_f32 v10, v10, v138, v139
  v_max3_f32 v12, v12, v140, v141
  v_max3_f32 v10, v10, v142, v143
  v_max3_f32 v12, v12, v144, v145
  v_max3_f32 v10, v10, v146, v147
  v_max3_f32 v12, v12, v148, v149
  v_max3_f32 v10, v10, v150, v151
  v_max3_f32 v12, v12, v152, v153
  v_max3_f32 v10, v10, v154, v155
  v_max3_f32 v12, v12, v156, v157
  v_max3_f32 v10, v10, v158, v159
  v_max_f32 v10, v10, v12
  v_mov_b32 v11, v10
  v_nop
  s_nop 0
  v_permlane32_swap_b32 v11, v10
  v_max_f32 v10, v10, v11
  v_max_f32 v7, 0xf149f2ca, v10
  v_add_f32 v5, v5, v7
  v_sub_f32 v64, 0, v5
  v_mov_b32 v65, v64
  v_mov_b32 v66, v64
  v_mov_b32 v67, v64
  v_mov_b32 v68, v64
  v_mov_b32 v69, v64
  v_mov_b32 v70, v64
  v_mov_b32 v71, v64
  v_mov_b32 v72, v64
  v_mov_b32 v73, v64
  v_mov_b32 v74, v64
  v_mov_b32 v75, v64
  v_mov_b32 v76, v64
  v_mov_b32 v77, v64
  v_mov_b32 v78, v64
  v_mov_b32 v79, v64
  v_sub_f32 v128, v128, v7
  v_sub_f32 v129, v129, v7
  v_sub_f32 v130, v130, v7
  v_sub_f32 v131, v131, v7
  v_sub_f32 v132, v132, v7
  v_sub_f32 v133, v133, v7
  v_sub_f32 v134, v134, v7
  v_sub_f32 v135, v135, v7
  v_sub_f32 v136, v136, v7
  v_sub_f32 v137, v137, v7
  v_sub_f32 v138, v138, v7
  v_sub_f32 v139, v139, v7
  v_sub_f32 v140, v140, v7
  v_sub_f32 v141, v141, v7
  v_sub_f32 v142, v142, v7
  v_sub_f32 v143, v143, v7
  v_sub_f32 v144, v144, v7
  v_sub_f32 v145, v145, v7
  v_sub_f32 v146, v146, v7
  v_sub_f32 v147, v147, v7
  v_sub_f32 v148, v148, v7
  v_sub_f32 v149, v149, v7
  v_sub_f32 v150, v150, v7
  v_sub_f32 v151, v151, v7
  v_sub_f32 v152, v152, v7
  v_sub_f32 v153, v153, v7
  v_sub_f32 v154, v154, v7
  v_sub_f32 v155, v155, v7
  v_sub_f32 v156, v156, v7
  v_sub_f32 v157, v157, v7
  v_sub_f32 v158, v158, v7
  v_sub_f32 v159, v159, v7
  s_waitcnt vmcnt(0)
  s_mov_b32 s68, s74
  s_and_b32 s69, s75, 0xffff
  s_mov_b32 s70, 4194304
  s_mov_b32 s71, 0x20000
  s_lshl_b32 s72, s2, 13
  v_lshlrev_b32 v24, 7, v1
  s_and_b32 s77, s77, 0xffff
  s_and_b32 s79, s79, 0xffff
  s_movk_i32 s64, 8
k2_kernel_loop5:
  s_cmp_lt_u32 s31, s30
  s_cbranch_scc1 k2_kernel_w06
  s_cmp_eq_u32 s31, s30
  s_cselect_b32 s38, s39, 0
  s_cmp_eq_u32 s38, 1
  s_cbranch_scc0 k2_kernel_w28
  s_waitcnt vmcnt(8)
  s_branch k2_kernel_w17
k2_kernel_w28:
  s_waitcnt vmcnt(0)
  s_branch k2_kernel_w17
k2_kernel_w06:
  s_waitcnt vmcnt(4)
k2_kernel_w17:
  s_barrier
  s_and_b32 s38, s63, 3
  s_lshl_b32 s38, s38, 14
  s_add_u32 s38, s38, 0x10000
  v_add_u32 v4, s38, v2
  s_add_u32 s58, s31, 1
  s_lshr_b32 s56, s58, 1
  s_sub_u32 s38, s58, s59
  s_lshl_b32 s52, s38, 1
  s_add_u32 s52, s52, s39
  s_cmp_lt_u32 s58, s30
  s_cselect_b32 s56, s56, s38
  s_cselect_b32 s57, s58, s52
  s_and_b32 s38, s57, 3
  s_lshl_b32 s38, s38, 14
  v_add_u32 v3, s38, v2
  s_cmp_eq_u32 s58, s30
  s_cselect_b32 s38, s39, 0
  s_cmp_eq_u32 s38, 1
  s_cbranch_scc0 k2_kernel_sw9
  v_add_u32 v11, s61, v2
  ds_read_b128 v[96:99], v11 offset:0
  ds_read_b128 v[100:103], v11 offset:1024
  ds_read_b128 v[104:107], v11 offset:2048
  ds_read_b128 v[108:111], v11 offset:3072
  ds_read_b128 v[112:115], v11 offset:4096
  ds_read_b128 v[116:119], v11 offset:5120
  ds_read_b128 v[120:123], v11 offset:6144
  ds_read_b128 v[124:127], v11 offset:7168
  v_mov_b32 v64, 0
  v_mov_b32 v65, 0
  v_mov_b32 v66, 0
  v_mov_b32 v67, 0
  v_mov_b32 v68, 0
  v_mov_b32 v69, 0
  v_mov_b32 v70, 0
  v_mov_b32 v71, 0
  v_mov_b32 v72, 0
  v_mov_b32 v73, 0
  v_mov_b32 v74, 0
  v_mov_b32 v75, 0
  v_mov_b32 v76, 0
  v_mov_b32 v77, 0
  v_mov_b32 v78, 0
  v_mov_b32 v79, 0
  s_waitcnt lgkmcnt(0)
k2_kernel_sw9:
  ds_read_b128 v[32:35], v3 offset:0
  ds_read_b128 v[36:39], v3 offset:8192
  ds_read_b128 v[40:43], v3 offset:1024
  ds_read_b128 v[44:47], v3 offset:9216
  ds_read_b128 v[48:51], v3 offset:2048
  ds_read_b128 v[52:55], v3 offset:10240
  v_exp_f32 v128, v128
  v_exp_f32 v129, v129
  v_exp_f32 v130, v130
  v_exp_f32 v131, v131
  s_waitcnt lgkmcnt(4)
  v_mfma_f32_32x32x16_bf16 v[160:175], v[32:35], v[96:99], v[64:79]
  v_add_f32 v8, v8, v128
  v_add_f32 v9, v9, v129
  s_and_b32 s73, s64, 7
  s_cmp_eq_u32 s3, s73
  s_cbranch_scc0 k2_kernel_pf12
  buffer_load_dword v25, v24, s[68:71], s72 offen
k2_kernel_pf12:
  s_add_u32 s72, s72, 0x200000
  v_mfma_f32_32x32x16_bf16 v[176:191], v[36:39], v[96:99], v[64:79]
  ds_read_b128 v[56:59], v3 offset:3072
  ds_read_b128 v[60:63], v3 offset:11264
  v_cvt_pk_bf16_f32 v80, v128, v129
  v_exp_f32 v132, v132
  v_exp_f32 v133, v133
  s_waitcnt lgkmcnt(4)
  v_mfma_f32_32x32x16_bf16 v[160:175], v[40:43], v[100:103], v[160:175]
  v_add_f32 v8, v8, v130
  v_add_f32 v9, v9, v131
  v_cvt_pk_bf16_f32 v81, v130, v131
  s_add_u32 s38, s56, 1
  s_cmp_eq_u32 s38, s32
  s_cbranch_scc0 k2_kernel_nk10
  s_cmp_lt_u32 s32, s60
  s_cbranch_scc0 k2_kernel_nk10
  s_lshl_b32 s38, s32, 16
  s_add_u32 s38, s38, s34
  s_and_b32 s52, s32, 1
  s_lshl_b32 s52, s52, 15
  s_add_u32 s52, s52, s35
  s_add_u32 m0, s52, 0
  s_nop 0
  buffer_load_dwordx4 v2, s[16:19], s38 offen offset:0 lds
  buffer_load_dwordx4 v2, s[16:19], s38 offen offset:1024 lds
  buffer_load_dwordx4 v2, s[16:19], s38 offen offset:2048 lds
  buffer_load_dwordx4 v2, s[16:19], s38 offen offset:3072 lds
  s_add_u32 s32, s32, 1
k2_kernel_nk10:
  v_mfma_f32_32x32x16_bf16 v[176:191], v[44:47], v[100:103], v[176:191]
  ds_read_b128 v[32:35], v3 offset:4096
  ds_read_b128 v[36:39], v3 offset:12288
  v_exp_f32 v134, v134
  v_exp_f32 v135, v135
  v_add_f32 v8, v8, v132
  s_waitcnt lgkmcnt(4)
  v_mfma_f32_32x32x16_bf16 v[160:175], v[48:51], v[104:107], v[160:175]
  v_add_f32 v9, v9, v133
  v_cvt_pk_bf16_f32 v82, v132, v133
  v_mfma_f32_32x32x16_bf16 v[176:191], v[52:55], v[104:107], v[176:191]
  ds_read_b128 v[40:43], v3 offset:5120
  ds_read_b128 v[44:47], v3 offset:13312
  v_add_f32 v8, v8, v134
  v_add_f32 v9, v9, v135
  v_cvt_pk_bf16_f32 v83, v134, v135
  s_waitcnt lgkmcnt(4)
  v_mfma_f32_32x32x16_bf16 v[160:175], v[56:59], v[108:111], v[160:175]
  v_exp_f32 v136, v136
  v_exp_f32 v137, v137
  v_exp_f32 v138, v138
  v_mfma_f32_32x32x16_bf16 v[176:191], v[60:63], v[108:111], v[176:191]
  ds_read_b128 v[48:51], v3 offset:6144
  ds_read_b128 v[52:55], v3 offset:14336
  v_exp_f32 v139, v139
  v_add_f32 v8, v8, v136
  v_add_f32 v9, v9, v137
  s_waitcnt lgkmcnt(4)
  v_mfma_f32_32x32x16_bf16 v[160:175], v[32:35], v[112:115], v[160:175]
  v_cvt_pk_bf16_f32 v84, v136, v137
  v_exp_f32 v140, v140
  s_add_u32 s38, s62, 1
  s_cmp_eq_u32 s38, s33
  s_cbranch_scc0 k2_kernel_nv11
  s_cmp_lt_u32 s33, s60
  s_cbranch_scc0 k2_kernel_nv11
  s_lshl_b32 s38, s33, 16
  s_add_u32 s38, s38, s34
  s_add_u32 s38, s38, 0x4000
  s_and_b32 s52, s33, 1
  s_lshl_b32 s52, s52, 15
  s_add_u32 s52, s52, s35
  s_add_u32 m0, s52, 65536
  s_nop 0
  buffer_load_dwordx4 v2, s[16:19], s38 offen offset:0 lds
  buffer_load_dwordx4 v2, s[16:19], s38 offen offset:1024 lds
  buffer_load_dwordx4 v2, s[16:19], s38 offen offset:2048 lds
  buffer_load_dwordx4 v2, s[16:19], s38 offen offset:3072 lds
  s_add_u32 s33, s33, 1
k2_kernel_nv11:
  v_mfma_f32_32x32x16_bf16 v[176:191], v[36:39], v[112:115], v[176:191]
  ds_read_b128 v[56:59], v3 offset:7168
  ds_read_b128 v[60:63], v3 offset:15360
  v_exp_f32 v141, v141
  v_add_f32 v8, v8, v138
  v_add_f32 v9, v9, v139
  s_waitcnt lgkmcnt(4)
  v_mfma_f32_32x32x16_bf16 v[160:175], v[40:43], v[116:119], v[160:175]
  v_cvt_pk_bf16_f32 v85, v138, v139
  v_exp_f32 v142, v142
  v_exp_f32 v143, v143
  v_mfma_f32_32x32x16_bf16 v[176:191], v[44:47], v[116:119], v[176:191]
  ds_read_b128 v[32:35], v4 offset:0
  ds_read_b128 v[36:39], v4 offset:1024
  v_add_f32 v8, v8, v140
  v_add_f32 v9, v9, v141
  v_cvt_pk_bf16_f32 v86, v140, v141
  s_waitcnt lgkmcnt(4)
  v_mfma_f32_32x32x16_bf16 v[160:175], v[48:51], v[120:123], v[160:175]
  v_add_f32 v8, v8, v142
  v_add_f32 v9, v9, v143
  v_cvt_pk_bf16_f32 v87, v142, v143
  v_mfma_f32_32x32x16_bf16 v[176:191], v[52:55], v[120:123], v[176:191]
  ds_read_b128 v[40:43], v4 offset:2048
  ds_read_b128 v[44:47], v4 offset:3072
  v_exp_f32 v144, v144
  v_exp_f32 v145, v145
  s_waitcnt lgkmcnt(4)
  v_mfma_f32_32x32x16_bf16 v[160:175], v[56:59], v[124:127], v[160:175]
  v_exp_f32 v146, v146
  v_exp_f32 v147, v147
  v_add_f32 v8, v8, v144
  v_mfma_f32_32x32x16_bf16 v[176:191], v[60:63], v[124:127], v[176:191]
  ds_read_b128 v[48:51], v4 offset:4096
  ds_read_b128 v[52:55], v4 offset:5120
  v_add_f32 v9, v9, v145
  v_cvt_pk_bf16_f32 v88, v144, v145
  v_exp_f32 v148, v148
  s_waitcnt lgkmcnt(4)
  v_mfma_f32_32x32x16_bf16 v[192:207], v[32:35], v[80:83], v[192:207]
  v_exp_f32 v149, v149
  v_add_f32 v8, v8, v146
  v_add_f32 v9, v9, v147
  v_mfma_f32_32x32x16_bf16 v[208:223], v[36:39], v[80:83], v[208:223]
  ds_read_b128 v[56:59], v4 offset:6144
  ds_read_b128 v[60:63], v4 offset:7168
  v_cvt_pk_bf16_f32 v89, v146, v147
  v_exp_f32 v150, v150
  v_exp_f32 v151, v151
  s_waitcnt lgkmcnt(4)
  v_mfma_f32_32x32x16_bf16 v[224:239], v[40:43], v[80:83], v[224:239]
  v_add_f32 v8, v8, v148
  v_add_f32 v9, v9, v149
  v_cvt_pk_bf16_f32 v90, v148, v149
  v_mfma_f32_32x32x16_bf16 v[240:255], v[44:47], v[80:83], v[240:255]
  ds_read_b128 v[32:35], v4 offset:8192
  ds_read_b128 v[36:39], v4 offset:9216
  v_add_f32 v8, v8, v150
  v_add_f32 v9, v9, v151
  v_cvt_pk_bf16_f32 v91, v150, v151
  s_lshl_b32 s52, s39, 6
  s_cmp_eq_u32 s58, 16
  s_cbranch_scc1 k2_kernel_domask14
  s_cmp_eq_u32 s39, 0
  s_cbranch_scc1 k2_kernel_nomask13
  s_sub_i32 s52, s30, s58
  s_cmp_gt_i32 s52, 2
  s_cbranch_scc1 k2_kernel_nomask13
  s_cmp_lt_i32 s52, 1
  s_cbranch_scc1 k2_kernel_nomask13
  s_sub_u32 s52, 2, s52
  s_lshl_b32 s52, s52, 6
k2_kernel_domask14:
  v_subrev_u32 v7, s52, v13
  v_cmp_le_i32 s[44:45], 0, v7
  v_cmp_le_i32 s[46:47], 1, v7
  v_cmp_le_i32 s[48:49], 2, v7
  v_cmp_le_i32 s[50:51], 3, v7
  v_cndmask_b32 v160, v14, v160, s[44:45]
  v_cndmask_b32 v161, v14, v161, s[46:47]
  v_cndmask_b32 v162, v14, v162, s[48:49]
  v_cndmask_b32 v163, v14, v163, s[50:51]
  v_cmp_le_i32 s[44:45], 8, v7
  v_cmp_le_i32 s[46:47], 9, v7
  v_cmp_le_i32 s[48:49], 10, v7
  v_cmp_le_i32 s[50:51], 11, v7
  v_cndmask_b32 v164, v14, v164, s[44:45]
  v_cndmask_b32 v165, v14, v165, s[46:47]
  v_cndmask_b32 v166, v14, v166, s[48:49]
  v_cndmask_b32 v167, v14, v167, s[50:51]
  v_cmp_le_i32 s[44:45], 16, v7
  v_cmp_le_i32 s[46:47], 17, v7
  v_cmp_le_i32 s[48:49], 18, v7
  v_cmp_le_i32 s[50:51], 19, v7
  v_cndmask_b32 v168, v14, v168, s[44:45]
  v_cndmask_b32 v169, v14, v169, s[46:47]
  v_cndmask_b32 v170, v14, v170, s[48:49]
  v_cndmask_b32 v171, v14, v171, s[50:51]
  v_cmp_le_i32 s[44:45], 24, v7
  v_cmp_le_i32 s[46:47], 25, v7
  v_cmp_le_i32 s[48:49], 26, v7
  v_cmp_le_i32 s[50:51], 27, v7
  v_cndmask_b32 v172, v14, v172, s[44:45]
  v_cndmask_b32 v173, v14, v173, s[46:47]
  v_cndmask_b32 v174, v14, v174, s[48:49]
  v_cndmask_b32 v175, v14, v175, s[50:51]
  v_cmp_le_i32 s[44:45], 32, v7
  v_cmp_le_i32 s[46:47], 33, v7
  v_cmp_le_i32 s[48:49], 34, v7
  v_cmp_le_i32 s[50:51], 35, v7
  v_cndmask_b32 v176, v14, v176, s[44:45]
  v_cndmask_b32 v177, v14, v177, s[46:47]
  v_cndmask_b32 v178, v14, v178, s[48:49]
  v_cndmask_b32 v179, v14, v179, s[50:51]
  v_cmp_le_i32 s[44:45], 40, v7
  v_cmp_le_i32 s[46:47], 41, v7
  v_cmp_le_i32 s[48:49], 42, v7
  v_cmp_le_i32 s[50:51], 43, v7
  v_cndmask_b32 v180, v14, v180, s[44:45]
  v_cndmask_b32 v181, v14, v181, s[46:47]
  v_cndmask_b32 v182, v14, v182, s[48:49]
  v_cndmask_b32 v183, v14, v183, s[50:51]
  v_cmp_le_i32 s[44:45], 48, v7
  v_cmp_le_i32 s[46:47], 49, v7
  v_cmp_le_i32 s[48:49], 50, v7
  v_cmp_le_i32 s[50:51], 51, v7
  v_cndmask_b32 v184, v14, v184, s[44:45]
  v_cndmask_b32 v185, v14, v185, s[46:47]
  v_cndmask_b32 v186, v14, v186, s[48:49]
  v_cndmask_b32 v187, v14, v187, s[50:51]
  v_cmp_le_i32 s[44:45], 56, v7
  v_cmp_le_i32 s[46:47], 57, v7
  v_cmp_le_i32 s[48:49], 58, v7
  v_cmp_le_i32 s[50:51], 59, v7
  v_cndmask_b32 v188, v14, v188, s[44:45]
  v_cndmask_b32 v189, v14, v189, s[46:47]
  v_cndmask_b32 v190, v14, v190, s[48:49]
  v_cndmask_b32 v191, v14, v191, s[50:51]
k2_kernel_nomask13:
  s_waitcnt lgkmcnt(4)
  v_mfma_f32_32x32x16_bf16 v[192:207], v[48:51], v[84:87], v[192:207]
  v_exp_f32 v152, v152
  v_exp_f32 v153, v153
  v_exp_f32 v154, v154
  v_max3_f32 v10, v160, v161, v162
  v_mfma_f32_32x32x16_bf16 v[208:223], v[52:55], v[84:87], v[208:223]
  ds_read_b128 v[40:43], v4 offset:10240
  ds_read_b128 v[44:47], v4 offset:11264
  v_exp_f32 v155, v155
  v_add_f32 v8, v8, v152
  v_add_f32 v9, v9, v153
  v_max3_f32 v12, v163, v164, v165
  v_max3_f32 v10, v10, v166, v167
  s_waitcnt lgkmcnt(4)
  v_mfma_f32_32x32x16_bf16 v[224:239], v[56:59], v[84:87], v[224:239]
  v_cvt_pk_bf16_f32 v92, v152, v153
  v_exp_f32 v156, v156
  v_exp_f32 v157, v157
  v_add_f32 v8, v8, v154
  v_max3_f32 v12, v12, v168, v169
  v_max3_f32 v10, v10, v170, v171
  v_mfma_f32_32x32x16_bf16 v[240:255], v[60:63], v[84:87], v[240:255]
  ds_read_b128 v[48:51], v4 offset:12288
  ds_read_b128 v[52:55], v4 offset:13312
  v_add_f32 v9, v9, v155
  v_cvt_pk_bf16_f32 v93, v154, v155
  v_exp_f32 v158, v158
  v_max3_f32 v12, v12, v172, v173
  s_waitcnt lgkmcnt(4)
  v_mfma_f32_32x32x16_bf16 v[192:207], v[32:35], v[88:91], v[192:207]
  v_exp_f32 v159, v159
  v_add_f32 v8, v8, v156
  v_add_f32 v9, v9, v157
  v_max3_f32 v10, v10, v174, v175
  v_max3_f32 v12, v12, v176, v177
  v_mfma_f32_32x32x16_bf16 v[208:223], v[36:39], v[88:91], v[208:223]
  ds_read_b128 v[56:59], v4 offset:14336
  ds_read_b128 v[60:63], v4 offset:15360
  v_cvt_pk_bf16_f32 v94, v156, v157
  v_add_f32 v8, v8, v158
  v_add_f32 v9, v9, v159
  v_cvt_pk_bf16_f32 v95, v158, v159
  v_max3_f32 v10, v10, v178, v179
  v_max3_f32 v12, v12, v180, v181
  s_waitcnt lgkmcnt(4)
  v_mfma_f32_32x32x16_bf16 v[224:239], v[40:43], v[88:91], v[224:239]
  v_max3_f32 v10, v10, v182, v183
  v_mfma_f32_32x32x16_bf16 v[240:255], v[44:47], v[88:91], v[240:255]
  v_max3_f32 v12, v12, v184, v185
  v_max3_f32 v10, v10, v186, v187
  s_waitcnt lgkmcnt(2)
  v_mfma_f32_32x32x16_bf16 v[192:207], v[48:51], v[92:95], v[192:207]
  v_max3_f32 v12, v12, v188, v189
  v_max3_f32 v10, v10, v190, v191
  v_mfma_f32_32x32x16_bf16 v[208:223], v[52:55], v[92:95], v[208:223]
  v_max_f32 v10, v10, v12
  s_waitcnt lgkmcnt(0)
  v_mfma_f32_32x32x16_bf16 v[224:239], v[56:59], v[92:95], v[224:239]
  v_mov_b32 v11, v10
  v_nop
  v_mfma_f32_32x32x16_bf16 v[240:255], v[60:63], v[92:95], v[240:255]
  v_permlane32_swap_b32 v11, v10
  v_max_f32 v10, v10, v11
  s_cmp_eq_u32 s58, s30
  s_cselect_b32 s38, s39, 0
  s_cmp_eq_u32 s38, 1
  s_cbranch_scc0 k2_kernel_nb15
  v_add_f32 v8, v8, v9
  v_mov_b32 v11, v8
  v_nop
  s_nop 0
  v_permlane32_swap_b32 v11, v8
  v_add_f32 v8, v8, v11
  v_rcp_f32 v8, v8
  s_lshl_b32 s38, s29, 2
  s_add_u32 s38, s38, s40
  s_lshl_b32 s38, s38, 18
  s_lshl_b32 s52, s28, 13
  s_add_u32 s55, s38, s52
  v_mul_f32 v192, v192, v8
  v_mul_f32 v193, v193, v8
  v_mul_f32 v194, v194, v8
  v_mul_f32 v195, v195, v8
  v_mul_f32 v196, v196, v8
  v_mul_f32 v197, v197, v8
  v_mul_f32 v198, v198, v8
  v_mul_f32 v199, v199, v8
  v_mul_f32 v200, v200, v8
  v_mul_f32 v201, v201, v8
  v_mul_f32 v202, v202, v8
  v_mul_f32 v203, v203, v8
  v_mul_f32 v204, v204, v8
  v_mul_f32 v205, v205, v8
  v_mul_f32 v206, v206, v8
  v_mul_f32 v207, v207, v8
  v_mul_f32 v208, v208, v8
  v_mul_f32 v209, v209, v8
  v_mul_f32 v210, v210, v8
  v_mul_f32 v211, v211, v8
  v_mul_f32 v212, v212, v8
  v_mul_f32 v213, v213, v8
  v_mul_f32 v214, v214, v8
  v_mul_f32 v215, v215, v8
  v_mul_f32 v216, v216, v8
  v_mul_f32 v217, v217, v8
  v_mul_f32 v218, v218, v8
  v_mul_f32 v219, v219, v8
  v_mul_f32 v220, v220, v8
  v_mul_f32 v221, v221, v8
  v_mul_f32 v222, v222, v8
  v_mul_f32 v223, v223, v8
  v_mul_f32 v224, v224, v8
  v_mul_f32 v225, v225, v8
  v_mul_f32 v226, v226, v8
  v_mul_f32 v227, v227, v8
  v_mul_f32 v228, v228, v8
  v_mul_f32 v229, v229, v8
  v_mul_f32 v230, v230, v8
  v_mul_f32 v231, v231, v8
  v_mul_f32 v232, v232, v8
  v_mul_f32 v233, v233, v8
  v_mul_f32 v234, v234, v8
  v_mul_f32 v235, v235, v8
  v_mul_f32 v236, v236, v8
  v_mul_f32 v237, v237, v8
  v_mul_f32 v238, v238, v8
  v_mul_f32 v239, v239, v8
  v_mul_f32 v240, v240, v8
  v_mul_f32 v241, v241, v8
  v_mul_f32 v242, v242, v8
  v_mul_f32 v243, v243, v8
  v_mul_f32 v244, v244, v8
  v_mul_f32 v245, v245, v8
  v_mul_f32 v246, v246, v8
  v_mul_f32 v247, v247, v8
  v_mul_f32 v248, v248, v8
  v_mul_f32 v249, v249, v8
  v_mul_f32 v250, v250, v8
  v_mul_f32 v251, v251, v8
  v_mul_f32 v252, v252, v8
  v_mul_f32 v253, v253, v8
  v_mul_f32 v254, v254, v8
  v_mul_f32 v255, v255, v8
  v_cvt_pk_bf16_f32 v32, v192, v193
  v_cvt_pk_bf16_f32 v33, v194, v195
  v_cvt_pk_bf16_f32 v34, v196, v197
  v_cvt_pk_bf16_f32 v35, v198, v199
  buffer_store_dwordx4 v[32:35], v2, s[24:27], s55 offen offset:0 sc1
  v_cvt_pk_bf16_f32 v36, v200, v201
  v_cvt_pk_bf16_f32 v37, v202, v203
  v_cvt_pk_bf16_f32 v38, v204, v205
  v_cvt_pk_bf16_f32 v39, v206, v207
  buffer_store_dwordx4 v[36:39], v2, s[24:27], s55 offen offset:1024 sc1
  v_cvt_pk_bf16_f32 v40, v208, v209
  v_cvt_pk_bf16_f32 v41, v210, v211
  v_cvt_pk_bf16_f32 v42, v212, v213
  v_cvt_pk_bf16_f32 v43, v214, v215
  buffer_store_dwordx4 v[40:43], v2, s[24:27], s55 offen offset:2048 sc1
  v_cvt_pk_bf16_f32 v44, v216, v217
  v_cvt_pk_bf16_f32 v45, v218, v219
  v_cvt_pk_bf16_f32 v46, v220, v221
  v_cvt_pk_bf16_f32 v47, v222, v223
  buffer_store_dwordx4 v[44:47], v2, s[24:27], s55 offen offset:3072 sc1
  v_cvt_pk_bf16_f32 v32, v224, v225
  v_cvt_pk_bf16_f32 v33, v226, v227
  v_cvt_pk_bf16_f32 v34, v228, v229
  v_cvt_pk_bf16_f32 v35, v230, v231
  s_add_u32 s55, s55, 4096
  buffer_store_dwordx4 v[32:35], v2, s[24:27], s55 offen offset:0 sc1
  v_cvt_pk_bf16_f32 v36, v232, v233
  v_cvt_pk_bf16_f32 v37, v234, v235
  v_cvt_pk_bf16_f32 v38, v236, v237
  v_cvt_pk_bf16_f32 v39, v238, v239
  buffer_store_dwordx4 v[36:39], v2, s[24:27], s55 offen offset:1024 sc1
  v_cvt_pk_bf16_f32 v40, v240, v241
  v_cvt_pk_bf16_f32 v41, v242, v243
  v_cvt_pk_bf16_f32 v42, v244, v245
  v_cvt_pk_bf16_f32 v43, v246, v247
  buffer_store_dwordx4 v[40:43], v2, s[24:27], s55 offen offset:2048 sc1
  v_cvt_pk_bf16_f32 v44, v248, v249
  v_cvt_pk_bf16_f32 v45, v250, v251
  v_cvt_pk_bf16_f32 v46, v252, v253
  v_cvt_pk_bf16_f32 v47, v254, v255
  buffer_store_dwordx4 v[44:47], v2, s[24:27], s55 offen offset:3072 sc1
  v_mov_b32 v192, 0
  v_mov_b32 v193, 0
  v_mov_b32 v194, 0
  v_mov_b32 v195, 0
  v_mov_b32 v196, 0
  v_mov_b32 v197, 0
  v_mov_b32 v198, 0
  v_mov_b32 v199, 0
  v_mov_b32 v200, 0
  v_mov_b32 v201, 0
  v_mov_b32 v202, 0
  v_mov_b32 v203, 0
  v_mov_b32 v204, 0
  v_mov_b32 v205, 0
  v_mov_b32 v206, 0
  v_mov_b32 v207, 0
  v_mov_b32 v208, 0
  v_mov_b32 v209, 0
  v_mov_b32 v210, 0
  v_mov_b32 v211, 0
  v_mov_b32 v212, 0
  v_mov_b32 v213, 0
  v_mov_b32 v214, 0
  v_mov_b32 v215, 0
  v_mov_b32 v216, 0
  v_mov_b32 v217, 0
  v_mov_b32 v218, 0
  v_mov_b32 v219, 0
  v_mov_b32 v220, 0
  v_mov_b32 v221, 0
  v_mov_b32 v222, 0
  v_mov_b32 v223, 0
  v_mov_b32 v224, 0
  v_mov_b32 v225, 0
  v_mov_b32 v226, 0
  v_mov_b32 v227, 0
  v_mov_b32 v228, 0
  v_mov_b32 v229, 0
  v_mov_b32 v230, 0
  v_mov_b32 v231, 0
  v_mov_b32 v232, 0
  v_mov_b32 v233, 0
  v_mov_b32 v234, 0
  v_mov_b32 v235, 0
  v_mov_b32 v236, 0
  v_mov_b32 v237, 0
  v_mov_b32 v238, 0
  v_mov_b32 v239, 0
  v_mov_b32 v240, 0
  v_mov_b32 v241, 0
  v_mov_b32 v242, 0
  v_mov_b32 v243, 0
  v_mov_b32 v244, 0
  v_mov_b32 v245, 0
  v_mov_b32 v246, 0
  v_mov_b32 v247, 0
  v_mov_b32 v248, 0
  v_mov_b32 v249, 0
  v_mov_b32 v250, 0
  v_mov_b32 v251, 0
  v_mov_b32 v252, 0
  v_mov_b32 v253, 0
  v_mov_b32 v254, 0
  v_mov_b32 v255, 0
  v_mov_b32 v8, 0
  v_mov_b32 v9, 0
  v_mov_b32 v5, 0
  v_max_f32 v7, 0xf149f2ca, v10
  v_add_f32 v5, v5, v7
  v_sub_f32 v64, 0, v5
  v_mov_b32 v65, v64
  v_mov_b32 v66, v64
  v_mov_b32 v67, v64
  v_mov_b32 v68, v64
  v_mov_b32 v69, v64
  v_mov_b32 v70, v64
  v_mov_b32 v71, v64
  v_mov_b32 v72, v64
  v_mov_b32 v73, v64
  v_mov_b32 v74, v64
  v_mov_b32 v75, v64
  v_mov_b32 v76, v64
  v_mov_b32 v77, v64
  v_mov_b32 v78, v64
  v_mov_b32 v79, v64
  v_sub_f32 v160, v160, v7
  v_sub_f32 v161, v161, v7
  v_sub_f32 v162, v162, v7
  v_sub_f32 v163, v163, v7
  v_sub_f32 v164, v164, v7
  v_sub_f32 v165, v165, v7
  v_sub_f32 v166, v166, v7
  v_sub_f32 v167, v167, v7
  v_sub_f32 v168, v168, v7
  v_sub_f32 v169, v169, v7
  v_sub_f32 v170, v170, v7
  v_sub_f32 v171, v171, v7
  v_sub_f32 v172, v172, v7
  v_sub_f32 v173, v173, v7
  v_sub_f32 v174, v174, v7
  v_sub_f32 v175, v175, v7
  v_sub_f32 v176, v176, v7
  v_sub_f32 v177, v177, v7
  v_sub_f32 v178, v178, v7
  v_sub_f32 v179, v179, v7
  v_sub_f32 v180, v180, v7
  v_sub_f32 v181, v181, v7
  v_sub_f32 v182, v182, v7
  v_sub_f32 v183, v183, v7
  v_sub_f32 v184, v184, v7
  v_sub_f32 v185, v185, v7
  v_sub_f32 v186, v186, v7
  v_sub_f32 v187, v187, v7
  v_sub_f32 v188, v188, v7
  v_sub_f32 v189, v189, v7
  v_sub_f32 v190, v190, v7
  v_sub_f32 v191, v191, v7
  s_branch k2_kernel_jn16
k2_kernel_nb15:
  v_cmp_lt_f32 vcc, 0x42200000, v10
  s_cbranch_vccz k2_kernel_nors18
  v_max_f32 v7, 0, v10
  v_add_f32 v5, v5, v7
  v_sub_f32 v64, 0, v5
  v_mov_b32 v65, v64
  v_mov_b32 v66, v64
  v_mov_b32 v67, v64
  v_mov_b32 v68, v64
  v_mov_b32 v69, v64
  v_mov_b32 v70, v64
  v_mov_b32 v71, v64
  v_mov_b32 v72, v64
  v_mov_b32 v73, v64
  v_mov_b32 v74, v64
  v_mov_b32 v75, v64
  v_mov_b32 v76, v64
  v_mov_b32 v77, v64
  v_mov_b32 v78, v64
  v_mov_b32 v79, v64
  v_sub_f32 v160, v160, v7
  v_sub_f32 v161, v161, v7
  v_sub_f32 v162, v162, v7
  v_sub_f32 v163, v163, v7
  v_sub_f32 v164, v164, v7
  v_sub_f32 v165, v165, v7
  v_sub_f32 v166, v166, v7
  v_sub_f32 v167, v167, v7
  v_sub_f32 v168, v168, v7
  v_sub_f32 v169, v169, v7
  v_sub_f32 v170, v170, v7
  v_sub_f32 v171, v171, v7
  v_sub_f32 v172, v172, v7
  v_sub_f32 v173, v173, v7
  v_sub_f32 v174, v174, v7
  v_sub_f32 v175, v175, v7
  v_sub_f32 v176, v176, v7
  v_sub_f32 v177, v177, v7
  v_sub_f32 v178, v178, v7
  v_sub_f32 v179, v179, v7
  v_sub_f32 v180, v180, v7
  v_sub_f32 v181, v181, v7
  v_sub_f32 v182, v182, v7
  v_sub_f32 v183, v183, v7
  v_sub_f32 v184, v184, v7
  v_sub_f32 v185, v185, v7
  v_sub_f32 v186, v186, v7
  v_sub_f32 v187, v187, v7
  v_sub_f32 v188, v188, v7
  v_sub_f32 v189, v189, v7
  v_sub_f32 v190, v190, v7
  v_sub_f32 v191, v191, v7
  v_sub_f32 v15, 0, v7
  v_exp_f32 v15, v15
  s_nop 0
  v_mul_f32 v8, v8, v15
  v_mul_f32 v9, v9, v15
  v_mul_f32 v192, v192, v15
  v_mul_f32 v193, v193, v15
  v_mul_f32 v194, v194, v15
  v_mul_f32 v195, v195, v15
  v_mul_f32 v196, v196, v15
  v_mul_f32 v197, v197, v15
  v_mul_f32 v198, v198, v15
  v_mul_f32 v199, v199, v15
  v_mul_f32 v200, v200, v15
  v_mul_f32 v201, v201, v15
  v_mul_f32 v202, v202, v15
  v_mul_f32 v203, v203, v15
  v_mul_f32 v204, v204, v15
  v_mul_f32 v205, v205, v15
  v_mul_f32 v206, v206, v15
  v_mul_f32 v207, v207, v15
  v_mul_f32 v208, v208, v15
  v_mul_f32 v209, v209, v15
  v_mul_f32 v210, v210, v15
  v_mul_f32 v211, v211, v15
  v_mul_f32 v212, v212, v15
  v_mul_f32 v213, v213, v15
  v_mul_f32 v214, v214, v15
  v_mul_f32 v215, v215, v15
  v_mul_f32 v216, v216, v15
  v_mul_f32 v217, v217, v15
  v_mul_f32 v218, v218, v15
  v_mul_f32 v219, v219, v15
  v_mul_f32 v220, v220, v15
  v_mul_f32 v221, v221, v15
  v_mul_f32 v222, v222, v15
  v_mul_f32 v223, v223, v15
  v_mul_f32 v224, v224, v15
  v_mul_f32 v225, v225, v15
  v_mul_f32 v226, v226, v15
  v_mul_f32 v227, v227, v15
  v_mul_f32 v228, v228, v15
  v_mul_f32 v229, v229, v15
  v_mul_f32 v230, v230, v15
  v_mul_f32 v231, v231, v15
  v_mul_f32 v232, v232, v15
  v_mul_f32 v233, v233, v15
  v_mul_f32 v234, v234, v15
  v_mul_f32 v235, v235, v15
  v_mul_f32 v236, v236, v15
  v_mul_f32 v237, v237, v15
  v_mul_f32 v238, v238, v15
  v_mul_f32 v239, v239, v15
  v_mul_f32 v240, v240, v15
  v_mul_f32 v241, v241, v15
  v_mul_f32 v242, v242, v15
  v_mul_f32 v243, v243, v15
  v_mul_f32 v244, v244, v15
  v_mul_f32 v245, v245, v15
  v_mul_f32 v246, v246, v15
  v_mul_f32 v247, v247, v15
  v_mul_f32 v248, v248, v15
  v_mul_f32 v249, v249, v15
  v_mul_f32 v250, v250, v15
  v_mul_f32 v251, v251, v15
  v_mul_f32 v252, v252, v15
  v_mul_f32 v253, v253, v15
  v_mul_f32 v254, v254, v15
  v_mul_f32 v255, v255, v15
k2_kernel_nors18:
k2_kernel_jn16:
  s_mov_b32 s31, s58
  s_mov_b32 s62, s56
  s_mov_b32 s63, s57
  s_cmp_lt_u32 s31, s30
  s_cbranch_scc1 k2_kernel_w019
  s_cmp_eq_u32 s31, s30
  s_cselect_b32 s38, s39, 0
  s_cmp_eq_u32 s38, 1
  s_cbranch_scc0 k2_kernel_w221
  s_waitcnt vmcnt(8)
  s_branch k2_kernel_w120
k2_kernel_w221:
  s_waitcnt vmcnt(0)
  s_branch k2_kernel_w120
k2_kernel_w019:
  s_waitcnt vmcnt(4)
k2_kernel_w120:
  s_barrier
  s_and_b32 s38, s63, 3
  s_lshl_b32 s38, s38, 14
  s_add_u32 s38, s38, 0x10000
  v_add_u32 v4, s38, v2
  s_add_u32 s58, s31, 1
  s_lshr_b32 s56, s58, 1
  s_sub_u32 s38, s58, s59
  s_lshl_b32 s52, s38, 1
  s_add_u32 s52, s52, s39
  s_cmp_lt_u32 s58, s30
  s_cselect_b32 s56, s56, s38
  s_cselect_b32 s57, s58, s52
  s_and_b32 s38, s57, 3
  s_lshl_b32 s38, s38, 14
  v_add_u32 v3, s38, v2
  s_cmp_eq_u32 s58, s30
  s_cselect_b32 s38, s39, 0
  s_cmp_eq_u32 s38, 1
  s_cbranch_scc0 k2_kernel_sw22
  v_add_u32 v11, s61, v2
  ds_read_b128 v[96:99], v11 offset:0
  ds_read_b128 v[100:103], v11 offset:1024
  ds_read_b128 v[104:107], v11 offset:2048
  ds_read_b128 v[108:111], v11 offset:3072
  ds_read_b128 v[112:115], v11 offset:4096
  ds_read_b128 v[116:119], v11 offset:5120
  ds_read_b128 v[120:123], v11 offset:6144
  ds_read_b128 v[124:127], v11 offset:7168
  v_mov_b32 v64, 0
  v_mov_b32 v65, 0
  v_mov_b32 v66, 0
  v_mov_b32 v67, 0
  v_mov_b32 v68, 0
  v_mov_b32 v69, 0
  v_mov_b32 v70, 0
  v_mov_b32 v71, 0
  v_mov_b32 v72, 0
  v_mov_b32 v73, 0
  v_mov_b32 v74, 0
  v_mov_b32 v75, 0
  v_mov_b32 v76, 0
  v_mov_b32 v77, 0
  v_mov_b32 v78, 0
  v_mov_b32 v79, 0
  s_waitcnt lgkmcnt(0)
k2_kernel_sw22:
  ds_read_b128 v[32:35], v3 offset:0
  ds_read_b128 v[36:39], v3 offset:8192
  ds_read_b128 v[40:43], v3 offset:1024
  ds_read_b128 v[44:47], v3 offset:9216
  ds_read_b128 v[48:51], v3 offset:2048
  ds_read_b128 v[52:55], v3 offset:10240
  v_exp_f32 v160, v160
  v_exp_f32 v161, v161
  v_exp_f32 v162, v162
  v_exp_f32 v163, v163
  s_waitcnt lgkmcnt(4)
  v_mfma_f32_32x32x16_bf16 v[128:143], v[32:35], v[96:99], v[64:79]
  v_add_f32 v8, v8, v160
  v_add_f32 v9, v9, v161
  s_and_b32 s73, s64, 7
  s_cmp_eq_u32 s3, s73
  s_cbranch_scc0 k2_kernel_pf25
  buffer_load_dword v25, v24, s[68:71], s72 offen
k2_kernel_pf25:
  s_add_u32 s72, s72, 0x200000
  v_mfma_f32_32x32x16_bf16 v[144:159], v[36:39], v[96:99], v[64:79]
  ds_read_b128 v[56:59], v3 offset:3072
  ds_read_b128 v[60:63], v3 offset:11264
  v_cvt_pk_bf16_f32 v80, v160, v161
  v_exp_f32 v164, v164
  v_exp_f32 v165, v165
  s_waitcnt lgkmcnt(4)
  v_mfma_f32_32x32x16_bf16 v[128:143], v[40:43], v[100:103], v[128:143]
  v_add_f32 v8, v8, v162
  v_add_f32 v9, v9, v163
  v_cvt_pk_bf16_f32 v81, v162, v163
  s_add_u32 s38, s56, 1
  s_cmp_eq_u32 s38, s32
  s_cbranch_scc0 k2_kernel_nk23
  s_cmp_lt_u32 s32, s60
  s_cbranch_scc0 k2_kernel_nk23
  s_lshl_b32 s38, s32, 16
  s_add_u32 s38, s38, s34
  s_and_b32 s52, s32, 1
  s_lshl_b32 s52, s52, 15
  s_add_u32 s52, s52, s35
  s_add_u32 m0, s52, 0
  s_nop 0
  buffer_load_dwordx4 v2, s[16:19], s38 offen offset:0 lds
  buffer_load_dwordx4 v2, s[16:19], s38 offen offset:1024 lds
  buffer_load_dwordx4 v2, s[16:19], s38 offen offset:2048 lds
  buffer_load_dwordx4 v2, s[16:19], s38 offen offset:3072 lds
  s_add_u32 s32, s32, 1
k2_kernel_nk23:
  v_mfma_f32_32x32x16_bf16 v[144:159], v[44:47], v[100:103], v[144:159]
  ds_read_b128 v[32:35], v3 offset:4096
  ds_read_b128 v[36:39], v3 offset:12288
  v_exp_f32 v166, v166
  v_exp_f32 v167, v167
  v_add_f32 v8, v8, v164
  s_waitcnt lgkmcnt(4)
  v_mfma_f32_32x32x16_bf16 v[128:143], v[48:51], v[104:107], v[128:143]
  v_add_f32 v9, v9, v165
  v_cvt_pk_bf16_f32 v82, v164, v165
  v_mfma_f32_32x32x16_bf16 v[144:159], v[52:55], v[104:107], v[144:159]
  ds_read_b128 v[40:43], v3 offset:5120
  ds_read_b128 v[44:47], v3 offset:13312
  v_add_f32 v8, v8, v166
  v_add_f32 v9, v9, v167
  v_cvt_pk_bf16_f32 v83, v166, v167
  s_waitcnt lgkmcnt(4)
  v_mfma_f32_32x32x16_bf16 v[128:143], v[56:59], v[108:111], v[128:143]
  v_exp_f32 v168, v168
  v_exp_f32 v169, v169
  v_exp_f32 v170, v170
  v_mfma_f32_32x32x16_bf16 v[144:159], v[60:63], v[108:111], v[144:159]
  ds_read_b128 v[48:51], v3 offset:6144
  ds_read_b128 v[52:55], v3 offset:14336
  v_exp_f32 v171, v171
  v_add_f32 v8, v8, v168
  v_add_f32 v9, v9, v169
  s_waitcnt lgkmcnt(4)
  v_mfma_f32_32x32x16_bf16 v[128:143], v[32:35], v[112:115], v[128:143]
  v_cvt_pk_bf16_f32 v84, v168, v169
  v_exp_f32 v172, v172
  s_add_u32 s38, s62, 1
  s_cmp_eq_u32 s38, s33
  s_cbranch_scc0 k2_kernel_nv24
  s_cmp_lt_u32 s33, s60
  s_cbranch_scc0 k2_kernel_nv24
  s_lshl_b32 s38, s33, 16
  s_add_u32 s38, s38, s34
  s_add_u32 s38, s38, 0x4000
  s_and_b32 s52, s33, 1
  s_lshl_b32 s52, s52, 15
  s_add_u32 s52, s52, s35
  s_add_u32 m0, s52, 65536
  s_nop 0
  buffer_load_dwordx4 v2, s[16:19], s38 offen offset:0 lds
  buffer_load_dwordx4 v2, s[16:19], s38 offen offset:1024 lds
  buffer_load_dwordx4 v2, s[16:19], s38 offen offset:2048 lds
  buffer_load_dwordx4 v2, s[16:19], s38 offen offset:3072 lds
  s_add_u32 s33, s33, 1
k2_kernel_nv24:
  v_mfma_f32_32x32x16_bf16 v[144:159], v[36:39], v[112:115], v[144:159]
  ds_read_b128 v[56:59], v3 offset:7168
  ds_read_b128 v[60:63], v3 offset:15360
  v_exp_f32 v173, v173
  v_add_f32 v8, v8, v170
  v_add_f32 v9, v9, v171
  s_waitcnt lgkmcnt(4)
  v_mfma_f32_32x32x16_bf16 v[128:143], v[40:43], v[116:119], v[128:143]
  v_cvt_pk_bf16_f32 v85, v170, v171
  v_exp_f32 v174, v174
  v_exp_f32 v175, v175
  v_mfma_f32_32x32x16_bf16 v[144:159], v[44:47], v[116:119], v[144:159]
  ds_read_b128 v[32:35], v4 offset:0
  ds_read_b128 v[36:39], v4 offset:1024
  v_add_f32 v8, v8, v172
  v_add_f32 v9, v9, v173
  v_cvt_pk_bf16_f32 v86, v172, v173
  s_waitcnt lgkmcnt(4)
  v_mfma_f32_32x32x16_bf16 v[128:143], v[48:51], v[120:123], v[128:143]
  v_add_f32 v8, v8, v174
  v_add_f32 v9, v9, v175
  v_cvt_pk_bf16_f32 v87, v174, v175
  v_mfma_f32_32x32x16_bf16 v[144:159], v[52:55], v[120:123], v[144:159]
  ds_read_b128 v[40:43], v4 offset:2048
  ds_read_b128 v[44:47], v4 offset:3072
  v_exp_f32 v176, v176
  v_exp_f32 v177, v177
  s_waitcnt lgkmcnt(4)
  v_mfma_f32_32x32x16_bf16 v[128:143], v[56:59], v[124:127], v[128:143]
  v_exp_f32 v178, v178
  v_exp_f32 v179, v179
  v_add_f32 v8, v8, v176
  v_mfma_f32_32x32x16_bf16 v[144:159], v[60:63], v[124:127], v[144:159]
  ds_read_b128 v[48:51], v4 offset:4096
  ds_read_b128 v[52:55], v4 offset:5120
  v_add_f32 v9, v9, v177
  v_cvt_pk_bf16_f32 v88, v176, v177
  v_exp_f32 v180, v180
  s_waitcnt lgkmcnt(4)
  v_mfma_f32_32x32x16_bf16 v[192:207], v[32:35], v[80:83], v[192:207]
  v_exp_f32 v181, v181
  v_add_f32 v8, v8, v178
  v_add_f32 v9, v9, v179
  v_mfma_f32_32x32x16_bf16 v[208:223], v[36:39], v[80:83], v[208:223]
  ds_read_b128 v[56:59], v4 offset:6144
  ds_read_b128 v[60:63], v4 offset:7168
  v_cvt_pk_bf16_f32 v89, v178, v179
  v_exp_f32 v182, v182
  v_exp_f32 v183, v183
  s_waitcnt lgkmcnt(4)
  v_mfma_f32_32x32x16_bf16 v[224:239], v[40:43], v[80:83], v[224:239]
  v_add_f32 v8, v8, v180
  v_add_f32 v9, v9, v181
  v_cvt_pk_bf16_f32 v90, v180, v181
  v_mfma_f32_32x32x16_bf16 v[240:255], v[44:47], v[80:83], v[240:255]
  ds_read_b128 v[32:35], v4 offset:8192
  ds_read_b128 v[36:39], v4 offset:9216
  v_add_f32 v8, v8, v182
  v_add_f32 v9, v9, v183
  v_cvt_pk_bf16_f32 v91, v182, v183
  s_lshl_b32 s52, s39, 6
  s_cmp_eq_u32 s58, 16
  s_cbranch_scc1 k2_kernel_domask27
  s_cmp_eq_u32 s39, 0
  s_cbranch_scc1 k2_kernel_nomask26
  s_sub_i32 s52, s30, s58
  s_cmp_gt_i32 s52, 2
  s_cbranch_scc1 k2_kernel_nomask26
  s_cmp_lt_i32 s52, 1
  s_cbranch_scc1 k2_kernel_nomask26
  s_sub_u32 s52, 2, s52
  s_lshl_b32 s52, s52, 6
k2_kernel_domask27:
  v_subrev_u32 v7, s52, v13
  v_cmp_le_i32 s[44:45], 0, v7
  v_cmp_le_i32 s[46:47], 1, v7
  v_cmp_le_i32 s[48:49], 2, v7
  v_cmp_le_i32 s[50:51], 3, v7
  v_cndmask_b32 v128, v14, v128, s[44:45]
  v_cndmask_b32 v129, v14, v129, s[46:47]
  v_cndmask_b32 v130, v14, v130, s[48:49]
  v_cndmask_b32 v131, v14, v131, s[50:51]
  v_cmp_le_i32 s[44:45], 8, v7
  v_cmp_le_i32 s[46:47], 9, v7
  v_cmp_le_i32 s[48:49], 10, v7
  v_cmp_le_i32 s[50:51], 11, v7
  v_cndmask_b32 v132, v14, v132, s[44:45]
  v_cndmask_b32 v133, v14, v133, s[46:47]
  v_cndmask_b32 v134, v14, v134, s[48:49]
  v_cndmask_b32 v135, v14, v135, s[50:51]
  v_cmp_le_i32 s[44:45], 16, v7
  v_cmp_le_i32 s[46:47], 17, v7
  v_cmp_le_i32 s[48:49], 18, v7
  v_cmp_le_i32 s[50:51], 19, v7
  v_cndmask_b32 v136, v14, v136, s[44:45]
  v_cndmask_b32 v137, v14, v137, s[46:47]
  v_cndmask_b32 v138, v14, v138, s[48:49]
  v_cndmask_b32 v139, v14, v139, s[50:51]
  v_cmp_le_i32 s[44:45], 24, v7
  v_cmp_le_i32 s[46:47], 25, v7
  v_cmp_le_i32 s[48:49], 26, v7
  v_cmp_le_i32 s[50:51], 27, v7
  v_cndmask_b32 v140, v14, v140, s[44:45]
  v_cndmask_b32 v141, v14, v141, s[46:47]
  v_cndmask_b32 v142, v14, v142, s[48:49]
  v_cndmask_b32 v143, v14, v143, s[50:51]
  v_cmp_le_i32 s[44:45], 32, v7
  v_cmp_le_i32 s[46:47], 33, v7
  v_cmp_le_i32 s[48:49], 34, v7
  v_cmp_le_i32 s[50:51], 35, v7
  v_cndmask_b32 v144, v14, v144, s[44:45]
  v_cndmask_b32 v145, v14, v145, s[46:47]
  v_cndmask_b32 v146, v14, v146, s[48:49]
  v_cndmask_b32 v147, v14, v147, s[50:51]
  v_cmp_le_i32 s[44:45], 40, v7
  v_cmp_le_i32 s[46:47], 41, v7
  v_cmp_le_i32 s[48:49], 42, v7
  v_cmp_le_i32 s[50:51], 43, v7
  v_cndmask_b32 v148, v14, v148, s[44:45]
  v_cndmask_b32 v149, v14, v149, s[46:47]
  v_cndmask_b32 v150, v14, v150, s[48:49]
  v_cndmask_b32 v151, v14, v151, s[50:51]
  v_cmp_le_i32 s[44:45], 48, v7
  v_cmp_le_i32 s[46:47], 49, v7
  v_cmp_le_i32 s[48:49], 50, v7
  v_cmp_le_i32 s[50:51], 51, v7
  v_cndmask_b32 v152, v14, v152, s[44:45]
  v_cndmask_b32 v153, v14, v153, s[46:47]
  v_cndmask_b32 v154, v14, v154, s[48:49]
  v_cndmask_b32 v155, v14, v155, s[50:51]
  v_cmp_le_i32 s[44:45], 56, v7
  v_cmp_le_i32 s[46:47], 57, v7
  v_cmp_le_i32 s[48:49], 58, v7
  v_cmp_le_i32 s[50:51], 59, v7
  v_cndmask_b32 v156, v14, v156, s[44:45]
  v_cndmask_b32 v157, v14, v157, s[46:47]
  v_cndmask_b32 v158, v14, v158, s[48:49]
  v_cndmask_b32 v159, v14, v159, s[50:51]
k2_kernel_nomask26:
  s_waitcnt lgkmcnt(4)
  v_mfma_f32_32x32x16_bf16 v[192:207], v[48:51], v[84:87], v[192:207]
  v_exp_f32 v184, v184
  v_exp_f32 v185, v185
  v_exp_f32 v186, v186
  v_max3_f32 v10, v128, v129, v130
  v_mfma_f32_32x32x16_bf16 v[208:223], v[52:55], v[84:87], v[208:223]
  ds_read_b128 v[40:43], v4 offset:10240
  ds_read_b128 v[44:47], v4 offset:11264
  v_exp_f32 v187, v187
  v_add_f32 v8, v8, v184
  v_add_f32 v9, v9, v185
  v_max3_f32 v12, v131, v132, v133
  v_max3_f32 v10, v10, v134, v135
  s_waitcnt lgkmcnt(4)
  v_mfma_f32_32x32x16_bf16 v[224:239], v[56:59], v[84:87], v[224:239]
  v_cvt_pk_bf16_f32 v92, v184, v185
  v_exp_f32 v188, v188
  v_exp_f32 v189, v189
  v_add_f32 v8, v8, v186
  v_max3_f32 v12, v12, v136, v137
  v_max3_f32 v10, v10, v138, v139
  v_mfma_f32_32x32x16_bf16 v[240:255], v[60:63], v[84:87], v[240:255]
  ds_read_b128 v[48:51], v4 offset:12288
  ds_read_b128 v[52:55], v4 offset:13312
  v_add_f32 v9, v9, v187
  v_cvt_pk_bf16_f32 v93, v186, v187
  v_exp_f32 v190, v190
  v_max3_f32 v12, v12, v140, v141
  s_waitcnt lgkmcnt(4)
  v_mfma_f32_32x32x16_bf16 v[192:207], v[32:35], v[88:91], v[192:207]
  v_exp_f32 v191, v191
  v_add_f32 v8, v8, v188
  v_add_f32 v9, v9, v189
  v_max3_f32 v10, v10, v142, v143
  v_max3_f32 v12, v12, v144, v145
  v_mfma_f32_32x32x16_bf16 v[208:223], v[36:39], v[88:91], v[208:223]
  ds_read_b128 v[56:59], v4 offset:14336
  ds_read_b128 v[60:63], v4 offset:15360
  v_cvt_pk_bf16_f32 v94, v188, v189
  v_add_f32 v8, v8, v190
  v_add_f32 v9, v9, v191
  v_cvt_pk_bf16_f32 v95, v190, v191
  v_max3_f32 v10, v10, v146, v147
  v_max3_f32 v12, v12, v148, v149
  s_waitcnt lgkmcnt(4)
  v_mfma_f32_32x32x16_bf16 v[224:239], v[40:43], v[88:91], v[224:239]
  v_max3_f32 v10, v10, v150, v151
  v_mfma_f32_32x32x16_bf16 v[240:255], v[44:47], v[88:91], v[240:255]
  v_max3_f32 v12, v12, v152, v153
  v_max3_f32 v10, v10, v154, v155
  s_waitcnt lgkmcnt(2)
  v_mfma_f32_32x32x16_bf16 v[192:207], v[48:51], v[92:95], v[192:207]
  v_max3_f32 v12, v12, v156, v157
  v_max3_f32 v10, v10, v158, v159
  v_mfma_f32_32x32x16_bf16 v[208:223], v[52:55], v[92:95], v[208:223]
  v_max_f32 v10, v10, v12
  s_waitcnt lgkmcnt(0)
  v_mfma_f32_32x32x16_bf16 v[224:239], v[56:59], v[92:95], v[224:239]
  v_mov_b32 v11, v10
  v_nop
  v_mfma_f32_32x32x16_bf16 v[240:255], v[60:63], v[92:95], v[240:255]
  v_permlane32_swap_b32 v11, v10
  v_max_f32 v10, v10, v11
  s_cmp_eq_u32 s58, s30
  s_cselect_b32 s38, s39, 0
  s_cmp_eq_u32 s38, 1
  s_cbranch_scc0 k2_kernel_nb28
  v_add_f32 v8, v8, v9
  v_mov_b32 v11, v8
  v_nop
  s_nop 0
  v_permlane32_swap_b32 v11, v8
  v_add_f32 v8, v8, v11
  v_rcp_f32 v8, v8
  s_lshl_b32 s38, s29, 2
  s_add_u32 s38, s38, s40
  s_lshl_b32 s38, s38, 18
  s_lshl_b32 s52, s28, 13
  s_add_u32 s55, s38, s52
  v_mul_f32 v192, v192, v8
  v_mul_f32 v193, v193, v8
  v_mul_f32 v194, v194, v8
  v_mul_f32 v195, v195, v8
  v_mul_f32 v196, v196, v8
  v_mul_f32 v197, v197, v8
  v_mul_f32 v198, v198, v8
  v_mul_f32 v199, v199, v8
  v_mul_f32 v200, v200, v8
  v_mul_f32 v201, v201, v8
  v_mul_f32 v202, v202, v8
  v_mul_f32 v203, v203, v8
  v_mul_f32 v204, v204, v8
  v_mul_f32 v205, v205, v8
  v_mul_f32 v206, v206, v8
  v_mul_f32 v207, v207, v8
  v_mul_f32 v208, v208, v8
  v_mul_f32 v209, v209, v8
  v_mul_f32 v210, v210, v8
  v_mul_f32 v211, v211, v8
  v_mul_f32 v212, v212, v8
  v_mul_f32 v213, v213, v8
  v_mul_f32 v214, v214, v8
  v_mul_f32 v215, v215, v8
  v_mul_f32 v216, v216, v8
  v_mul_f32 v217, v217, v8
  v_mul_f32 v218, v218, v8
  v_mul_f32 v219, v219, v8
  v_mul_f32 v220, v220, v8
  v_mul_f32 v221, v221, v8
  v_mul_f32 v222, v222, v8
  v_mul_f32 v223, v223, v8
  v_mul_f32 v224, v224, v8
  v_mul_f32 v225, v225, v8
  v_mul_f32 v226, v226, v8
  v_mul_f32 v227, v227, v8
  v_mul_f32 v228, v228, v8
  v_mul_f32 v229, v229, v8
  v_mul_f32 v230, v230, v8
  v_mul_f32 v231, v231, v8
  v_mul_f32 v232, v232, v8
  v_mul_f32 v233, v233, v8
  v_mul_f32 v234, v234, v8
  v_mul_f32 v235, v235, v8
  v_mul_f32 v236, v236, v8
  v_mul_f32 v237, v237, v8
  v_mul_f32 v238, v238, v8
  v_mul_f32 v239, v239, v8
  v_mul_f32 v240, v240, v8
  v_mul_f32 v241, v241, v8
  v_mul_f32 v242, v242, v8
  v_mul_f32 v243, v243, v8
  v_mul_f32 v244, v244, v8
  v_mul_f32 v245, v245, v8
  v_mul_f32 v246, v246, v8
  v_mul_f32 v247, v247, v8
  v_mul_f32 v248, v248, v8
  v_mul_f32 v249, v249, v8
  v_mul_f32 v250, v250, v8
  v_mul_f32 v251, v251, v8
  v_mul_f32 v252, v252, v8
  v_mul_f32 v253, v253, v8
  v_mul_f32 v254, v254, v8
  v_mul_f32 v255, v255, v8
  v_cvt_pk_bf16_f32 v32, v192, v193
  v_cvt_pk_bf16_f32 v33, v194, v195
  v_cvt_pk_bf16_f32 v34, v196, v197
  v_cvt_pk_bf16_f32 v35, v198, v199
  buffer_store_dwordx4 v[32:35], v2, s[24:27], s55 offen offset:0 sc1
  v_cvt_pk_bf16_f32 v36, v200, v201
  v_cvt_pk_bf16_f32 v37, v202, v203
  v_cvt_pk_bf16_f32 v38, v204, v205
  v_cvt_pk_bf16_f32 v39, v206, v207
  buffer_store_dwordx4 v[36:39], v2, s[24:27], s55 offen offset:1024 sc1
  v_cvt_pk_bf16_f32 v40, v208, v209
  v_cvt_pk_bf16_f32 v41, v210, v211
  v_cvt_pk_bf16_f32 v42, v212, v213
  v_cvt_pk_bf16_f32 v43, v214, v215
  buffer_store_dwordx4 v[40:43], v2, s[24:27], s55 offen offset:2048 sc1
  v_cvt_pk_bf16_f32 v44, v216, v217
  v_cvt_pk_bf16_f32 v45, v218, v219
  v_cvt_pk_bf16_f32 v46, v220, v221
  v_cvt_pk_bf16_f32 v47, v222, v223
  buffer_store_dwordx4 v[44:47], v2, s[24:27], s55 offen offset:3072 sc1
  v_cvt_pk_bf16_f32 v32, v224, v225
  v_cvt_pk_bf16_f32 v33, v226, v227
  v_cvt_pk_bf16_f32 v34, v228, v229
  v_cvt_pk_bf16_f32 v35, v230, v231
  s_add_u32 s55, s55, 4096
  buffer_store_dwordx4 v[32:35], v2, s[24:27], s55 offen offset:0 sc1
  v_cvt_pk_bf16_f32 v36, v232, v233
  v_cvt_pk_bf16_f32 v37, v234, v235
  v_cvt_pk_bf16_f32 v38, v236, v237
  v_cvt_pk_bf16_f32 v39, v238, v239
  buffer_store_dwordx4 v[36:39], v2, s[24:27], s55 offen offset:1024 sc1
  v_cvt_pk_bf16_f32 v40, v240, v241
  v_cvt_pk_bf16_f32 v41, v242, v243
  v_cvt_pk_bf16_f32 v42, v244, v245
  v_cvt_pk_bf16_f32 v43, v246, v247
  buffer_store_dwordx4 v[40:43], v2, s[24:27], s55 offen offset:2048 sc1
  v_cvt_pk_bf16_f32 v44, v248, v249
  v_cvt_pk_bf16_f32 v45, v250, v251
  v_cvt_pk_bf16_f32 v46, v252, v253
  v_cvt_pk_bf16_f32 v47, v254, v255
  buffer_store_dwordx4 v[44:47], v2, s[24:27], s55 offen offset:3072 sc1
  v_mov_b32 v192, 0
  v_mov_b32 v193, 0
  v_mov_b32 v194, 0
  v_mov_b32 v195, 0
  v_mov_b32 v196, 0
  v_mov_b32 v197, 0
  v_mov_b32 v198, 0
  v_mov_b32 v199, 0
  v_mov_b32 v200, 0
  v_mov_b32 v201, 0
  v_mov_b32 v202, 0
  v_mov_b32 v203, 0
  v_mov_b32 v204, 0
  v_mov_b32 v205, 0
  v_mov_b32 v206, 0
  v_mov_b32 v207, 0
  v_mov_b32 v208, 0
  v_mov_b32 v209, 0
  v_mov_b32 v210, 0
  v_mov_b32 v211, 0
  v_mov_b32 v212, 0
  v_mov_b32 v213, 0
  v_mov_b32 v214, 0
  v_mov_b32 v215, 0
  v_mov_b32 v216, 0
  v_mov_b32 v217, 0
  v_mov_b32 v218, 0
  v_mov_b32 v219, 0
  v_mov_b32 v220, 0
  v_mov_b32 v221, 0
  v_mov_b32 v222, 0
  v_mov_b32 v223, 0
  v_mov_b32 v224, 0
  v_mov_b32 v225, 0
  v_mov_b32 v226, 0
  v_mov_b32 v227, 0
  v_mov_b32 v228, 0
  v_mov_b32 v229, 0
  v_mov_b32 v230, 0
  v_mov_b32 v231, 0
  v_mov_b32 v232, 0
  v_mov_b32 v233, 0
  v_mov_b32 v234, 0
  v_mov_b32 v235, 0
  v_mov_b32 v236, 0
  v_mov_b32 v237, 0
  v_mov_b32 v238, 0
  v_mov_b32 v239, 0
  v_mov_b32 v240, 0
  v_mov_b32 v241, 0
  v_mov_b32 v242, 0
  v_mov_b32 v243, 0
  v_mov_b32 v244, 0
  v_mov_b32 v245, 0
  v_mov_b32 v246, 0
  v_mov_b32 v247, 0
  v_mov_b32 v248, 0
  v_mov_b32 v249, 0
  v_mov_b32 v250, 0
  v_mov_b32 v251, 0
  v_mov_b32 v252, 0
  v_mov_b32 v253, 0
  v_mov_b32 v254, 0
  v_mov_b32 v255, 0
  v_mov_b32 v8, 0
  v_mov_b32 v9, 0
  v_mov_b32 v5, 0
  v_max_f32 v7, 0xf149f2ca, v10
  v_add_f32 v5, v5, v7
  v_sub_f32 v64, 0, v5
  v_mov_b32 v65, v64
  v_mov_b32 v66, v64
  v_mov_b32 v67, v64
  v_mov_b32 v68, v64
  v_mov_b32 v69, v64
  v_mov_b32 v70, v64
  v_mov_b32 v71, v64
  v_mov_b32 v72, v64
  v_mov_b32 v73, v64
  v_mov_b32 v74, v64
  v_mov_b32 v75, v64
  v_mov_b32 v76, v64
  v_mov_b32 v77, v64
  v_mov_b32 v78, v64
  v_mov_b32 v79, v64
  v_sub_f32 v128, v128, v7
  v_sub_f32 v129, v129, v7
  v_sub_f32 v130, v130, v7
  v_sub_f32 v131, v131, v7
  v_sub_f32 v132, v132, v7
  v_sub_f32 v133, v133, v7
  v_sub_f32 v134, v134, v7
  v_sub_f32 v135, v135, v7
  v_sub_f32 v136, v136, v7
  v_sub_f32 v137, v137, v7
  v_sub_f32 v138, v138, v7
  v_sub_f32 v139, v139, v7
  v_sub_f32 v140, v140, v7
  v_sub_f32 v141, v141, v7
  v_sub_f32 v142, v142, v7
  v_sub_f32 v143, v143, v7
  v_sub_f32 v144, v144, v7
  v_sub_f32 v145, v145, v7
  v_sub_f32 v146, v146, v7
  v_sub_f32 v147, v147, v7
  v_sub_f32 v148, v148, v7
  v_sub_f32 v149, v149, v7
  v_sub_f32 v150, v150, v7
  v_sub_f32 v151, v151, v7
  v_sub_f32 v152, v152, v7
  v_sub_f32 v153, v153, v7
  v_sub_f32 v154, v154, v7
  v_sub_f32 v155, v155, v7
  v_sub_f32 v156, v156, v7
  v_sub_f32 v157, v157, v7
  v_sub_f32 v158, v158, v7
  v_sub_f32 v159, v159, v7
  s_branch k2_kernel_jn29
k2_kernel_nb28:
  v_cmp_lt_f32 vcc, 0x42200000, v10
  s_cbranch_vccz k2_kernel_nors31
  v_max_f32 v7, 0, v10
  v_add_f32 v5, v5, v7
  v_sub_f32 v64, 0, v5
  v_mov_b32 v65, v64
  v_mov_b32 v66, v64
  v_mov_b32 v67, v64
  v_mov_b32 v68, v64
  v_mov_b32 v69, v64
  v_mov_b32 v70, v64
  v_mov_b32 v71, v64
  v_mov_b32 v72, v64
  v_mov_b32 v73, v64
  v_mov_b32 v74, v64
  v_mov_b32 v75, v64
  v_mov_b32 v76, v64
  v_mov_b32 v77, v64
  v_mov_b32 v78, v64
  v_mov_b32 v79, v64
  v_sub_f32 v128, v128, v7
  v_sub_f32 v129, v129, v7
  v_sub_f32 v130, v130, v7
  v_sub_f32 v131, v131, v7
  v_sub_f32 v132, v132, v7
  v_sub_f32 v133, v133, v7
  v_sub_f32 v134, v134, v7
  v_sub_f32 v135, v135, v7
  v_sub_f32 v136, v136, v7
  v_sub_f32 v137, v137, v7
  v_sub_f32 v138, v138, v7
  v_sub_f32 v139, v139, v7
  v_sub_f32 v140, v140, v7
  v_sub_f32 v141, v141, v7
  v_sub_f32 v142, v142, v7
  v_sub_f32 v143, v143, v7
  v_sub_f32 v144, v144, v7
  v_sub_f32 v145, v145, v7
  v_sub_f32 v146, v146, v7
  v_sub_f32 v147, v147, v7
  v_sub_f32 v148, v148, v7
  v_sub_f32 v149, v149, v7
  v_sub_f32 v150, v150, v7
  v_sub_f32 v151, v151, v7
  v_sub_f32 v152, v152, v7
  v_sub_f32 v153, v153, v7
  v_sub_f32 v154, v154, v7
  v_sub_f32 v155, v155, v7
  v_sub_f32 v156, v156, v7
  v_sub_f32 v157, v157, v7
  v_sub_f32 v158, v158, v7
  v_sub_f32 v159, v159, v7
  v_sub_f32 v15, 0, v7
  v_exp_f32 v15, v15
  s_nop 0
  v_mul_f32 v8, v8, v15
  v_mul_f32 v9, v9, v15
  v_mul_f32 v192, v192, v15
  v_mul_f32 v193, v193, v15
  v_mul_f32 v194, v194, v15
  v_mul_f32 v195, v195, v15
  v_mul_f32 v196, v196, v15
  v_mul_f32 v197, v197, v15
  v_mul_f32 v198, v198, v15
  v_mul_f32 v199, v199, v15
  v_mul_f32 v200, v200, v15
  v_mul_f32 v201, v201, v15
  v_mul_f32 v202, v202, v15
  v_mul_f32 v203, v203, v15
  v_mul_f32 v204, v204, v15
  v_mul_f32 v205, v205, v15
  v_mul_f32 v206, v206, v15
  v_mul_f32 v207, v207, v15
  v_mul_f32 v208, v208, v15
  v_mul_f32 v209, v209, v15
  v_mul_f32 v210, v210, v15
  v_mul_f32 v211, v211, v15
  v_mul_f32 v212, v212, v15
  v_mul_f32 v213, v213, v15
  v_mul_f32 v214, v214, v15
  v_mul_f32 v215, v215, v15
  v_mul_f32 v216, v216, v15
  v_mul_f32 v217, v217, v15
  v_mul_f32 v218, v218, v15
  v_mul_f32 v219, v219, v15
  v_mul_f32 v220, v220, v15
  v_mul_f32 v221, v221, v15
  v_mul_f32 v222, v222, v15
  v_mul_f32 v223, v223, v15
  v_mul_f32 v224, v224, v15
  v_mul_f32 v225, v225, v15
  v_mul_f32 v226, v226, v15
  v_mul_f32 v227, v227, v15
  v_mul_f32 v228, v228, v15
  v_mul_f32 v229, v229, v15
  v_mul_f32 v230, v230, v15
  v_mul_f32 v231, v231, v15
  v_mul_f32 v232, v232, v15
  v_mul_f32 v233, v233, v15
  v_mul_f32 v234, v234, v15
  v_mul_f32 v235, v235, v15
  v_mul_f32 v236, v236, v15
  v_mul_f32 v237, v237, v15
  v_mul_f32 v238, v238, v15
  v_mul_f32 v239, v239, v15
  v_mul_f32 v240, v240, v15
  v_mul_f32 v241, v241, v15
  v_mul_f32 v242, v242, v15
  v_mul_f32 v243, v243, v15
  v_mul_f32 v244, v244, v15
  v_mul_f32 v245, v245, v15
  v_mul_f32 v246, v246, v15
  v_mul_f32 v247, v247, v15
  v_mul_f32 v248, v248, v15
  v_mul_f32 v249, v249, v15
  v_mul_f32 v250, v250, v15
  v_mul_f32 v251, v251, v15
  v_mul_f32 v252, v252, v15
  v_mul_f32 v253, v253, v15
  v_mul_f32 v254, v254, v15
  v_mul_f32 v255, v255, v15
k2_kernel_nors31:
k2_kernel_jn29:
  s_mov_b32 s31, s58
  s_mov_b32 s62, s56
  s_mov_b32 s63, s57
  s_lshl_b32 s73, s2, 13
  s_cmp_eq_u32 s64, 8
  s_cselect_b32 s68, s76, s68
  s_cselect_b32 s69, s77, s69
  s_cselect_b32 s70, 7340032, s70
  s_cselect_b32 s72, s73, s72
  s_cmp_eq_u32 s64, 6
  s_cselect_b32 s68, s78, s68
  s_cselect_b32 s69, s79, s69
  s_cselect_b32 s72, s73, s72
  s_cmp_eq_u32 s64, 4
  s_cselect_b32 s70, 0, s70
  s_sub_u32 s64, s64, 1
  s_cmp_lg_u32 s64, 0
  s_cbranch_scc1 k2_kernel_loop5
  s_cmp_lt_u32 s31, s30
  s_cbranch_scc1 k2_kernel_w032
  s_cmp_eq_u32 s31, s30
  s_cselect_b32 s38, s39, 0
  s_cmp_eq_u32 s38, 1
  s_cbranch_scc0 k2_kernel_w234
  s_waitcnt vmcnt(8)
  s_branch k2_kernel_w133
k2_kernel_w234:
  s_waitcnt vmcnt(0)
  s_branch k2_kernel_w133
k2_kernel_w032:
  s_waitcnt vmcnt(4)
k2_kernel_w133:
  s_barrier
  s_and_b32 s38, s63, 3
  s_lshl_b32 s38, s38, 14
  s_add_u32 s38, s38, 0x10000
  v_add_u32 v4, s38, v2
  ds_read_b128 v[32:35], v4 offset:0
  ds_read_b128 v[36:39], v4 offset:1024
  ds_read_b128 v[40:43], v4 offset:2048
  ds_read_b128 v[44:47], v4 offset:3072
  ds_read_b128 v[48:51], v4 offset:4096
  ds_read_b128 v[52:55], v4 offset:5120
  v_exp_f32 v128, v128
  v_exp_f32 v129, v129
  v_exp_f32 v130, v130
  v_exp_f32 v131, v131
  v_add_f32 v8, v8, v128
  v_add_f32 v9, v9, v129
  v_cvt_pk_bf16_f32 v80, v128, v129
  v_exp_f32 v132, v132
  v_exp_f32 v133, v133
  v_add_f32 v8, v8, v130
  v_add_f32 v9, v9, v131
  v_cvt_pk_bf16_f32 v81, v130, v131
  v_exp_f32 v134, v134
  v_exp_f32 v135, v135
  v_add_f32 v8, v8, v132
  v_add_f32 v9, v9, v133
  v_cvt_pk_bf16_f32 v82, v132, v133
  v_add_f32 v8, v8, v134
  v_add_f32 v9, v9, v135
  v_cvt_pk_bf16_f32 v83, v134, v135
  s_waitcnt lgkmcnt(4)
  s_nop 0
  v_mfma_f32_32x32x16_bf16 v[192:207], v[32:35], v[80:83], v[192:207]
  v_exp_f32 v136, v136
  v_exp_f32 v137, v137
  v_exp_f32 v138, v138
  v_exp_f32 v139, v139
  v_add_f32 v8, v8, v136
  v_add_f32 v9, v9, v137
  v_mfma_f32_32x32x16_bf16 v[208:223], v[36:39], v[80:83], v[208:223]
  ds_read_b128 v[56:59], v4 offset:6144
  ds_read_b128 v[60:63], v4 offset:7168
  v_cvt_pk_bf16_f32 v84, v136, v137
  v_exp_f32 v140, v140
  v_exp_f32 v141, v141
  v_add_f32 v8, v8, v138
  v_add_f32 v9, v9, v139
  v_cvt_pk_bf16_f32 v85, v138, v139
  v_exp_f32 v142, v142
  s_waitcnt lgkmcnt(4)
  v_mfma_f32_32x32x16_bf16 v[224:239], v[40:43], v[80:83], v[224:239]
  v_exp_f32 v143, v143
  v_add_f32 v8, v8, v140
  v_add_f32 v9, v9, v141
  v_cvt_pk_bf16_f32 v86, v140, v141
  v_add_f32 v8, v8, v142
  v_add_f32 v9, v9, v143
  v_cvt_pk_bf16_f32 v87, v142, v143
  v_mfma_f32_32x32x16_bf16 v[240:255], v[44:47], v[80:83], v[240:255]
  ds_read_b128 v[32:35], v4 offset:8192
  ds_read_b128 v[36:39], v4 offset:9216
  s_waitcnt lgkmcnt(4)
  v_mfma_f32_32x32x16_bf16 v[192:207], v[48:51], v[84:87], v[192:207]
  v_exp_f32 v144, v144
  v_exp_f32 v145, v145
  v_exp_f32 v146, v146
  v_exp_f32 v147, v147
  v_add_f32 v8, v8, v144
  v_add_f32 v9, v9, v145
  v_mfma_f32_32x32x16_bf16 v[208:223], v[52:55], v[84:87], v[208:223]
  ds_read_b128 v[40:43], v4 offset:10240
  ds_read_b128 v[44:47], v4 offset:11264
  v_cvt_pk_bf16_f32 v88, v144, v145
  v_exp_f32 v148, v148
  v_exp_f32 v149, v149
  v_add_f32 v8, v8, v146
  v_add_f32 v9, v9, v147
  v_cvt_pk_bf16_f32 v89, v146, v147
  v_exp_f32 v150, v150
  s_waitcnt lgkmcnt(4)
  v_mfma_f32_32x32x16_bf16 v[224:239], v[56:59], v[84:87], v[224:239]
  v_exp_f32 v151, v151
  v_add_f32 v8, v8, v148
  v_add_f32 v9, v9, v149
  v_cvt_pk_bf16_f32 v90, v148, v149
  v_add_f32 v8, v8, v150
  v_add_f32 v9, v9, v151
  v_cvt_pk_bf16_f32 v91, v150, v151
  v_mfma_f32_32x32x16_bf16 v[240:255], v[60:63], v[84:87], v[240:255]
  ds_read_b128 v[48:51], v4 offset:12288
  ds_read_b128 v[52:55], v4 offset:13312
  s_waitcnt lgkmcnt(4)
  v_mfma_f32_32x32x16_bf16 v[192:207], v[32:35], v[88:91], v[192:207]
  v_exp_f32 v152, v152
  v_exp_f32 v153, v153
  v_exp_f32 v154, v154
  v_exp_f32 v155, v155
  v_add_f32 v8, v8, v152
  v_add_f32 v9, v9, v153
  v_mfma_f32_32x32x16_bf16 v[208:223], v[36:39], v[88:91], v[208:223]
  ds_read_b128 v[56:59], v4 offset:14336
  ds_read_b128 v[60:63], v4 offset:15360
  v_cvt_pk_bf16_f32 v92, v152, v153
  v_exp_f32 v156, v156
  v_exp_f32 v157, v157
  v_add_f32 v8, v8, v154
  v_add_f32 v9, v9, v155
  v_cvt_pk_bf16_f32 v93, v154, v155
  v_exp_f32 v158, v158
  s_waitcnt lgkmcnt(4)
  v_mfma_f32_32x32x16_bf16 v[224:239], v[40:43], v[88:91], v[224:239]
  v_exp_f32 v159, v159
  v_add_f32 v8, v8, v156
  v_add_f32 v9, v9, v157
  v_cvt_pk_bf16_f32 v94, v156, v157
  v_add_f32 v8, v8, v158
  v_add_f32 v9, v9, v159
  v_cvt_pk_bf16_f32 v95, v158, v159
  v_mfma_f32_32x32x16_bf16 v[240:255], v[44:47], v[88:91], v[240:255]
  s_waitcnt lgkmcnt(2)
  v_mfma_f32_32x32x16_bf16 v[192:207], v[48:51], v[92:95], v[192:207]
  v_mfma_f32_32x32x16_bf16 v[208:223], v[52:55], v[92:95], v[208:223]
  s_waitcnt lgkmcnt(0)
  v_mfma_f32_32x32x16_bf16 v[224:239], v[56:59], v[92:95], v[224:239]
  v_mfma_f32_32x32x16_bf16 v[240:255], v[60:63], v[92:95], v[240:255]
  v_add_f32 v8, v8, v9
  v_mov_b32 v11, v8
  v_nop
  s_nop 0
  v_permlane32_swap_b32 v11, v8
  v_add_f32 v9, v8, v11
  v_mov_b32 v8, v5
  s_mul_i32 s38, s3, 9216
  v_add_u32 v20, s38, v2
  s_xor_b32 s52, s3, 4
  s_mul_i32 s52, s52, 9216
  v_add_u32 v21, s52, v2
  v_lshrrev_b32 v22, 1, v2
  v_add_u32 v23, s52, v22
  v_add_u32 v22, s38, v22
  s_sub_u32 s38, 15, s29
  s_lshl_b32 s38, s38, 2
  s_add_u32 s38, s38, s40
  s_lshl_b32 s38, s38, 18
  s_lshl_b32 s52, s28, 13
  s_add_u32 s55, s38, s52
  s_lshl_b32 s52, s39, 12
  s_add_u32 s55, s55, s52
  s_barrier
  s_cmp_eq_u32 s39, 1
  s_cbranch_scc1 k2_kernel_g135
  ds_write_b128 v20, v[224:227] offset:0
  ds_write_b128 v20, v[228:231] offset:1024
  ds_write_b128 v20, v[232:235] offset:2048
  ds_write_b128 v20, v[236:239] offset:3072
  ds_write_b128 v20, v[240:243] offset:4096
  ds_write_b128 v20, v[244:247] offset:5120
  ds_write_b128 v20, v[248:251] offset:6144
  ds_write_b128 v20, v[252:255] offset:7168
  ds_write_b64 v22, v[8:9] offset:8192
  s_waitcnt lgkmcnt(0)
  s_barrier
  ds_read_b128 v[64:67], v21 offset:0
  ds_read_b128 v[68:71], v21 offset:1024
  ds_read_b128 v[72:75], v21 offset:2048
  ds_read_b128 v[76:79], v21 offset:3072
  ds_read_b128 v[80:83], v21 offset:4096
  ds_read_b128 v[84:87], v21 offset:5120
  ds_read_b128 v[88:91], v21 offset:6144
  ds_read_b128 v[92:95], v21 offset:7168
  ds_read_b64 v[24:25], v23 offset:8192
  s_waitcnt lgkmcnt(0)
  v_max_f32 v26, v8, v24
  v_sub_f32 v27, v8, v26
  v_sub_f32 v28, v24, v26
  v_exp_f32 v27, v27
  v_exp_f32 v28, v28
  v_mul_f32 v29, v27, v9
  v_fmac_f32 v29, v28, v25
  v_rcp_f32 v29, v29
  s_nop 0
  v_mul_f32 v27, v27, v29
  v_mul_f32 v28, v28, v29
  v_mul_f32 v192, v192, v27
  v_fmac_f32 v192, v64, v28
  v_mul_f32 v193, v193, v27
  v_fmac_f32 v193, v65, v28
  v_mul_f32 v194, v194, v27
  v_fmac_f32 v194, v66, v28
  v_mul_f32 v195, v195, v27
  v_fmac_f32 v195, v67, v28
  v_mul_f32 v196, v196, v27
  v_fmac_f32 v196, v68, v28
  v_mul_f32 v197, v197, v27
  v_fmac_f32 v197, v69, v28
  v_mul_f32 v198, v198, v27
  v_fmac_f32 v198, v70, v28
  v_mul_f32 v199, v199, v27
  v_fmac_f32 v199, v71, v28
  v_mul_f32 v200, v200, v27
  v_fmac_f32 v200, v72, v28
  v_mul_f32 v201, v201, v27
  v_fmac_f32 v201, v73, v28
  v_mul_f32 v202, v202, v27
  v_fmac_f32 v202, v74, v28
  v_mul_f32 v203, v203, v27
  v_fmac_f32 v203, v75, v28
  v_mul_f32 v204, v204, v27
  v_fmac_f32 v204, v76, v28
  v_mul_f32 v205, v205, v27
  v_fmac_f32 v205, v77, v28
  v_mul_f32 v206, v206, v27
  v_fmac_f32 v206, v78, v28
  v_mul_f32 v207, v207, v27
  v_fmac_f32 v207, v79, v28
  v_mul_f32 v208, v208, v27
  v_fmac_f32 v208, v80, v28
  v_mul_f32 v209, v209, v27
  v_fmac_f32 v209, v81, v28
  v_mul_f32 v210, v210, v27
  v_fmac_f32 v210, v82, v28
  v_mul_f32 v211, v211, v27
  v_fmac_f32 v211, v83, v28
  v_mul_f32 v212, v212, v27
  v_fmac_f32 v212, v84, v28
  v_mul_f32 v213, v213, v27
  v_fmac_f32 v213, v85, v28
  v_mul_f32 v214, v214, v27
  v_fmac_f32 v214, v86, v28
  v_mul_f32 v215, v215, v27
  v_fmac_f32 v215, v87, v28
  v_mul_f32 v216, v216, v27
  v_fmac_f32 v216, v88, v28
  v_mul_f32 v217, v217, v27
  v_fmac_f32 v217, v89, v28
  v_mul_f32 v218, v218, v27
  v_fmac_f32 v218, v90, v28
  v_mul_f32 v219, v219, v27
  v_fmac_f32 v219, v91, v28
  v_mul_f32 v220, v220, v27
  v_fmac_f32 v220, v92, v28
  v_mul_f32 v221, v221, v27
  v_fmac_f32 v221, v93, v28
  v_mul_f32 v222, v222, v27
  v_fmac_f32 v222, v94, v28
  v_mul_f32 v223, v223, v27
  v_fmac_f32 v223, v95, v28
  v_cvt_pk_bf16_f32 v32, v192, v193
  v_cvt_pk_bf16_f32 v33, v194, v195
  v_cvt_pk_bf16_f32 v34, v196, v197
  v_cvt_pk_bf16_f32 v35, v198, v199
  buffer_store_dwordx4 v[32:35], v2, s[24:27], s55 offen offset:0 sc1
  v_cvt_pk_bf16_f32 v36, v200, v201
  v_cvt_pk_bf16_f32 v37, v202, v203
  v_cvt_pk_bf16_f32 v38, v204, v205
  v_cvt_pk_bf16_f32 v39, v206, v207
  buffer_store_dwordx4 v[36:39], v2, s[24:27], s55 offen offset:1024 sc1
  v_cvt_pk_bf16_f32 v40, v208, v209
  v_cvt_pk_bf16_f32 v41, v210, v211
  v_cvt_pk_bf16_f32 v42, v212, v213
  v_cvt_pk_bf16_f32 v43, v214, v215
  buffer_store_dwordx4 v[40:43], v2, s[24:27], s55 offen offset:2048 sc1
  v_cvt_pk_bf16_f32 v44, v216, v217
  v_cvt_pk_bf16_f32 v45, v218, v219
  v_cvt_pk_bf16_f32 v46, v220, v221
  v_cvt_pk_bf16_f32 v47, v222, v223
  buffer_store_dwordx4 v[44:47], v2, s[24:27], s55 offen offset:3072 sc1
  s_branch k2_kernel_gj36
k2_kernel_g135:
  ds_write_b128 v20, v[192:195] offset:0
  ds_write_b128 v20, v[196:199] offset:1024
  ds_write_b128 v20, v[200:203] offset:2048
  ds_write_b128 v20, v[204:207] offset:3072
  ds_write_b128 v20, v[208:211] offset:4096
  ds_write_b128 v20, v[212:215] offset:5120
  ds_write_b128 v20, v[216:219] offset:6144
  ds_write_b128 v20, v[220:223] offset:7168
  ds_write_b64 v22, v[8:9] offset:8192
  s_waitcnt lgkmcnt(0)
  s_barrier
  ds_read_b128 v[64:67], v21 offset:0
  ds_read_b128 v[68:71], v21 offset:1024
  ds_read_b128 v[72:75], v21 offset:2048
  ds_read_b128 v[76:79], v21 offset:3072
  ds_read_b128 v[80:83], v21 offset:4096
  ds_read_b128 v[84:87], v21 offset:5120
  ds_read_b128 v[88:91], v21 offset:6144
  ds_read_b128 v[92:95], v21 offset:7168
  ds_read_b64 v[24:25], v23 offset:8192
  s_waitcnt lgkmcnt(0)
  v_max_f32 v26, v8, v24
  v_sub_f32 v27, v8, v26
  v_sub_f32 v28, v24, v26
  v_exp_f32 v27, v27
  v_exp_f32 v28, v28
  v_mul_f32 v29, v27, v9
  v_fmac_f32 v29, v28, v25
  v_rcp_f32 v29, v29
  s_nop 0
  v_mul_f32 v27, v27, v29
  v_mul_f32 v28, v28, v29
  v_mul_f32 v224, v224, v27
  v_fmac_f32 v224, v64, v28
  v_mul_f32 v225, v225, v27
  v_fmac_f32 v225, v65, v28
  v_mul_f32 v226, v226, v27
  v_fmac_f32 v226, v66, v28
  v_mul_f32 v227, v227, v27
  v_fmac_f32 v227, v67, v28
  v_mul_f32 v228, v228, v27
  v_fmac_f32 v228, v68, v28
  v_mul_f32 v229, v229, v27
  v_fmac_f32 v229, v69, v28
  v_mul_f32 v230, v230, v27
  v_fmac_f32 v230, v70, v28
  v_mul_f32 v231, v231, v27
  v_fmac_f32 v231, v71, v28
  v_mul_f32 v232, v232, v27
  v_fmac_f32 v232, v72, v28
  v_mul_f32 v233, v233, v27
  v_fmac_f32 v233, v73, v28
  v_mul_f32 v234, v234, v27
  v_fmac_f32 v234, v74, v28
  v_mul_f32 v235, v235, v27
  v_fmac_f32 v235, v75, v28
  v_mul_f32 v236, v236, v27
  v_fmac_f32 v236, v76, v28
  v_mul_f32 v237, v237, v27
  v_fmac_f32 v237, v77, v28
  v_mul_f32 v238, v238, v27
  v_fmac_f32 v238, v78, v28
  v_mul_f32 v239, v239, v27
  v_fmac_f32 v239, v79, v28
  v_mul_f32 v240, v240, v27
  v_fmac_f32 v240, v80, v28
  v_mul_f32 v241, v241, v27
  v_fmac_f32 v241, v81, v28
  v_mul_f32 v242, v242, v27
  v_fmac_f32 v242, v82, v28
  v_mul_f32 v243, v243, v27
  v_fmac_f32 v243, v83, v28
  v_mul_f32 v244, v244, v27
  v_fmac_f32 v244, v84, v28
  v_mul_f32 v245, v245, v27
  v_fmac_f32 v245, v85, v28
  v_mul_f32 v246, v246, v27
  v_fmac_f32 v246, v86, v28
  v_mul_f32 v247, v247, v27
  v_fmac_f32 v247, v87, v28
  v_mul_f32 v248, v248, v27
  v_fmac_f32 v248, v88, v28
  v_mul_f32 v249, v249, v27
  v_fmac_f32 v249, v89, v28
  v_mul_f32 v250, v250, v27
  v_fmac_f32 v250, v90, v28
  v_mul_f32 v251, v251, v27
  v_fmac_f32 v251, v91, v28
  v_mul_f32 v252, v252, v27
  v_fmac_f32 v252, v92, v28
  v_mul_f32 v253, v253, v27
  v_fmac_f32 v253, v93, v28
  v_mul_f32 v254, v254, v27
  v_fmac_f32 v254, v94, v28
  v_mul_f32 v255, v255, v27
  v_fmac_f32 v255, v95, v28
  v_cvt_pk_bf16_f32 v32, v224, v225
  v_cvt_pk_bf16_f32 v33, v226, v227
  v_cvt_pk_bf16_f32 v34, v228, v229
  v_cvt_pk_bf16_f32 v35, v230, v231
  buffer_store_dwordx4 v[32:35], v2, s[24:27], s55 offen offset:0 sc1
  v_cvt_pk_bf16_f32 v36, v232, v233
  v_cvt_pk_bf16_f32 v37, v234, v235
  v_cvt_pk_bf16_f32 v38, v236, v237
  v_cvt_pk_bf16_f32 v39, v238, v239
  buffer_store_dwordx4 v[36:39], v2, s[24:27], s55 offen offset:1024 sc1
  v_cvt_pk_bf16_f32 v40, v240, v241
  v_cvt_pk_bf16_f32 v41, v242, v243
  v_cvt_pk_bf16_f32 v42, v244, v245
  v_cvt_pk_bf16_f32 v43, v246, v247
  buffer_store_dwordx4 v[40:43], v2, s[24:27], s55 offen offset:2048 sc1
  v_cvt_pk_bf16_f32 v44, v248, v249
  v_cvt_pk_bf16_f32 v45, v250, v251
  v_cvt_pk_bf16_f32 v46, v252, v253
  v_cvt_pk_bf16_f32 v47, v254, v255
  buffer_store_dwordx4 v[44:47], v2, s[24:27], s55 offen offset:3072 sc1
k2_kernel_gj36:
k2_kernel_end:
  s_endpgm
.globl k3_kernel
.p2align 8
.type k3_kernel,@function
k3_kernel:
  s_cmp_ge_u32 s2, 256
  s_cbranch_scc1 k3_kernel_end
  s_load_dwordx2 s[4:5], s[0:1], 40
  s_load_dwordx2 s[6:7], s[0:1], 104
  v_and_b32 v1, 63, v0
  v_lshrrev_b32 v2, 6, v0
  s_nop 0
  v_readfirstlane_b32 s3, v2
  s_waitcnt lgkmcnt(0)
  s_mov_b32 s8, s4
  s_and_b32 s9, s5, 0xffff
  s_mov_b32 s10, 4194304
  s_mov_b32 s11, 0x20000
  s_add_u32 s12, s6, 52428800
  s_addc_u32 s13, s7, 0
  s_and_b32 s13, s13, 0xffff
  s_mov_b32 s14, 16777216
  s_mov_b32 s15, 0x20000
  s_add_u32 s16, s6, 69206016
  s_addc_u32 s17, s7, 0
  s_and_b32 s17, s17, 0xffff
  s_mov_b32 s18, 16777216
  s_mov_b32 s19, 0x20000
  s_and_b32 s20, s2, 7
  s_lshr_b32 s21, s2, 3
  s_lshr_b32 s22, s20, 1
  s_and_b32 s20, s20, 1
  s_lshl_b32 s20, s20, 3
  s_lshr_b32 s23, s21, 2
  s_add_u32 s23, s23, s20
  s_and_b32 s24, s21, 3
  v_lshrrev_b32 v20, 4, v1
  v_bfe_u32 v21, v1, 2, 2
  v_xor_b32 v21, v21, v20
  v_lshlrev_b32 v21, 6, v21
  v_lshl_add_u32 v21, v20, 10, v21
  v_and_b32 v22, 3, v1
  v_lshl_add_u32 v16, v22, 4, v21
  v_lshlrev_b32 v17, 4, v1
  s_lshl_b32 s25, s22, 20
  s_lshl_b32 s29, s3, 12
  s_add_u32 s25, s25, s29
  s_lshl_b32 s29, s24, 8
  s_add_u32 s25, s25, s29
  s_lshl_b32 s26, s23, 2
  s_add_u32 s26, s26, s3
  s_lshl_b32 s26, s26, 18
  s_lshl_b32 s29, s22, 16
  s_add_u32 s26, s26, s29
  s_lshl_b32 s27, s3, 10
  s_lshl_b32 s28, s3, 12
  s_add_u32 s28, s28, 16384
  s_add_u32 m0, s27, 0
  s_add_u32 s29, s25, 0
  buffer_load_dwordx4 v16, s[8:11], s29 offen lds
  s_add_u32 m0, s27, 4096
  s_add_u32 s29, s25, 16384
  buffer_load_dwordx4 v16, s[8:11], s29 offen lds
  s_add_u32 m0, s27, 8192
  s_add_u32 s29, s25, 32768
  buffer_load_dwordx4 v16, s[8:11], s29 offen lds
  s_add_u32 m0, s27, 12288
  s_add_u32 s29, s25, 49152
  buffer_load_dwordx4 v16, s[8:11], s29 offen lds
  s_add_u32 m0, s28, 0
  s_add_u32 s29, s26, 0
  buffer_load_dwordx4 v17, s[12:15], s29 offen offset:0 lds
  buffer_load_dwordx4 v17, s[12:15], s29 offen offset:1024 lds
  buffer_load_dwordx4 v17, s[12:15], s29 offen offset:2048 lds
  buffer_load_dwordx4 v17, s[12:15], s29 offen offset:3072 lds
  s_add_u32 m0, s27, 32768
  s_add_u32 s29, s25, 65536
  buffer_load_dwordx4 v16, s[8:11], s29 offen lds
  s_add_u32 m0, s27, 36864
  s_add_u32 s29, s25, 81920
  buffer_load_dwordx4 v16, s[8:11], s29 offen lds
  s_add_u32 m0, s27, 40960
  s_add_u32 s29, s25, 98304
  buffer_load_dwordx4 v16, s[8:11], s29 offen lds
  s_add_u32 m0, s27, 45056
  s_add_u32 s29, s25, 114688
  buffer_load_dwordx4 v16, s[8:11], s29 offen lds
  s_add_u32 m0, s28, 32768
  s_add_u32 s29, s26, 4096
  buffer_load_dwordx4 v17, s[12:15], s29 offen offset:0 lds
  buffer_load_dwordx4 v17, s[12:15], s29 offen offset:1024 lds
  buffer_load_dwordx4 v17, s[12:15], s29 offen offset:2048 lds
  buffer_load_dwordx4 v17, s[12:15], s29 offen offset:3072 lds
  s_add_u32 m0, s27, 65536
  s_add_u32 s29, s25, 131072
  buffer_load_dwordx4 v16, s[8:11], s29 offen lds
  s_add_u32 m0, s27, 69632
  s_add_u32 s29, s25, 147456
  buffer_load_dwordx4 v16, s[8:11], s29 offen lds
  s_add_u32 m0, s27, 73728
  s_add_u32 s29, s25, 163840
  buffer_load_dwordx4 v16, s[8:11], s29 offen lds
  s_add_u32 m0, s27, 77824
  s_add_u32 s29, s25, 180224
  buffer_load_dwordx4 v16, s[8:11], s29 offen lds
  s_add_u32 m0, s28, 65536
  s_add_u32 s29, s26, 8192
  buffer_load_dwordx4 v17, s[12:15], s29 offen offset:0 lds
  buffer_load_dwordx4 v17, s[12:15], s29 offen offset:1024 lds
  buffer_load_dwordx4 v17, s[12:15], s29 offen offset:2048 lds
  buffer_load_dwordx4 v17, s[12:15], s29 offen offset:3072 lds
  s_add_u32 m0, s27, 98304
  s_add_u32 s29, s25, 196608
  buffer_load_dwordx4 v16, s[8:11], s29 offen lds
  s_add_u32 m0, s27, 102400
  s_add_u32 s29, s25, 212992
  buffer_load_dwordx4 v16, s[8:11], s29 offen lds
  s_add_u32 m0, s27, 106496
  s_add_u32 s29, s25, 229376
  buffer_load_dwordx4 v16, s[8:11], s29 offen lds
  s_add_u32 m0, s27, 110592
  s_add_u32 s29, s25, 245760
  buffer_load_dwordx4 v16, s[8:11], s29 offen lds
  s_add_u32 m0, s28, 98304
  s_add_u32 s29, s26, 12288
  buffer_load_dwordx4 v17, s[12:15], s29 offen offset:0 lds
  buffer_load_dwordx4 v17, s[12:15], s29 offen offset:1024 lds
  buffer_load_dwordx4 v17, s[12:15], s29 offen offset:2048 lds
  buffer_load_dwordx4 v17, s[12:15], s29 offen offset:3072 lds
  s_and_b32 s30, s3, 1
  s_lshr_b32 s31, s3, 1
  v_bfe_u32 v24, v1, 2, 2
  v_lshrrev_b32 v25, 5, v1
  v_lshl_add_u32 v25, v25, 2, v24
  v_lshlrev_b32 v25, 8, v25
  v_and_b32 v26, 16, v1
  v_lshl_add_u32 v25, v26, 1, v25
  v_and_b32 v26, 3, v1
  v_lshl_add_u32 v25, v26, 3, v25
  s_lshl_b32 s29, s30, 1
  v_xor_b32 v26, s29, v24
  v_lshl_add_u32 v10, v26, 6, v25
  v_xor_b32 v26, 1, v26
  v_lshl_add_u32 v11, v26, 6, v25
  s_lshl_b32 s29, s31, 13
  s_add_u32 s29, s29, 16384
  v_add_u32 v12, s29, v17
  v_add_u32 v13, 0x10000, v10
  v_add_u32 v14, 0x10000, v11
  v_add_u32 v15, 0x10000, v12
  v_add_u32 v27, 0x20000, v10
  v_add_u32 v28, 0x20000, v11
  v_add_u32 v29, 0x20000, v12
  s_waitcnt vmcnt(24)
  s_barrier
  ds_read_b64_tr_b16 v[32:33], v10 offset:0
  ds_read_b64_tr_b16 v[34:35], v10 offset:2048
  ds_read_b64_tr_b16 v[36:37], v11 offset:0
  ds_read_b64_tr_b16 v[38:39], v11 offset:2048
  ds_read_b128 v[40:43], v12 offset:0
  ds_read_b128 v[44:47], v12 offset:4096
  ds_read_b64_tr_b16 v[48:49], v10 offset:4096
  ds_read_b64_tr_b16 v[50:51], v10 offset:6144
  ds_read_b64_tr_b16 v[52:53], v11 offset:4096
  ds_read_b64_tr_b16 v[54:55], v11 offset:6144
  ds_read_b128 v[56:59], v12 offset:1024
  ds_read_b128 v[60:63], v12 offset:5120
  s_waitcnt lgkmcnt(6)
  v_mfma_f32_32x32x16_bf16 v[64:79], v[32:35], v[40:43], 0
  s_add_u32 m0, s27, 131072
  s_add_u32 s29, s25, 262144
  buffer_load_dwordx4 v16, s[8:11], s29 offen lds
  v_mfma_f32_32x32x16_bf16 v[80:95], v[32:35], v[44:47], 0
  s_add_u32 m0, s27, 135168
  s_add_u32 s29, s25, 278528
  buffer_load_dwordx4 v16, s[8:11], s29 offen lds
  v_mfma_f32_32x32x16_bf16 v[96:111], v[36:39], v[40:43], 0
  s_add_u32 m0, s27, 139264
  s_add_u32 s29, s25, 294912
  buffer_load_dwordx4 v16, s[8:11], s29 offen lds
  v_mfma_f32_32x32x16_bf16 v[112:127], v[36:39], v[44:47], 0
  s_add_u32 m0, s27, 143360
  s_add_u32 s29, s25, 311296
  buffer_load_dwordx4 v16, s[8:11], s29 offen lds
  ds_read_b64_tr_b16 v[32:33], v10 offset:8192
  ds_read_b64_tr_b16 v[34:35], v10 offset:10240
  ds_read_b64_tr_b16 v[36:37], v11 offset:8192
  ds_read_b64_tr_b16 v[38:39], v11 offset:10240
  ds_read_b128 v[40:43], v12 offset:2048
  ds_read_b128 v[44:47], v12 offset:6144
  s_waitcnt lgkmcnt(6)
  v_mfma_f32_32x32x16_bf16 v[64:79], v[48:51], v[56:59], v[64:79]
  v_mfma_f32_32x32x16_bf16 v[80:95], v[48:51], v[60:63], v[80:95]
  v_mfma_f32_32x32x16_bf16 v[96:111], v[52:55], v[56:59], v[96:111]
  v_mfma_f32_32x32x16_bf16 v[112:127], v[52:55], v[60:63], v[112:127]
  s_add_u32 m0, s28, 131072
  s_add_u32 s29, s26, 16384
  buffer_load_dwordx4 v17, s[12:15], s29 offen offset:0 lds
  buffer_load_dwordx4 v17, s[12:15], s29 offen offset:1024 lds
  buffer_load_dwordx4 v17, s[12:15], s29 offen offset:2048 lds
  buffer_load_dwordx4 v17, s[12:15], s29 offen offset:3072 lds
  ds_read_b64_tr_b16 v[48:49], v10 offset:12288
  ds_read_b64_tr_b16 v[50:51], v10 offset:14336
  ds_read_b64_tr_b16 v[52:53], v11 offset:12288
  ds_read_b64_tr_b16 v[54:55], v11 offset:14336
  ds_read_b128 v[56:59], v12 offset:3072
  ds_read_b128 v[60:63], v12 offset:7168
  s_waitcnt lgkmcnt(6)
  v_mfma_f32_32x32x16_bf16 v[64:79], v[32:35], v[40:43], v[64:79]
  v_mfma_f32_32x32x16_bf16 v[80:95], v[32:35], v[44:47], v[80:95]
  v_mfma_f32_32x32x16_bf16 v[96:111], v[36:39], v[40:43], v[96:111]
  v_mfma_f32_32x32x16_bf16 v[112:127], v[36:39], v[44:47], v[112:127]
  s_waitcnt lgkmcnt(0)
  v_mfma_f32_32x32x16_bf16 v[64:79], v[48:51], v[56:59], v[64:79]
  v_mfma_f32_32x32x16_bf16 v[80:95], v[48:51], v[60:63], v[80:95]
  v_mfma_f32_32x32x16_bf16 v[96:111], v[52:55], v[56:59], v[96:111]
  v_mfma_f32_32x32x16_bf16 v[112:127], v[52:55], v[60:63], v[112:127]
  s_waitcnt vmcnt(24)
  s_barrier
  ds_read_b64_tr_b16 v[32:33], v10 offset:32768
  ds_read_b64_tr_b16 v[34:35], v10 offset:34816
  ds_read_b64_tr_b16 v[36:37], v11 offset:32768
  ds_read_b64_tr_b16 v[38:39], v11 offset:34816
  ds_read_b128 v[40:43], v12 offset:32768
  ds_read_b128 v[44:47], v12 offset:36864
  ds_read_b64_tr_b16 v[48:49], v10 offset:36864
  ds_read_b64_tr_b16 v[50:51], v10 offset:38912
  ds_read_b64_tr_b16 v[52:53], v11 offset:36864
  ds_read_b64_tr_b16 v[54:55], v11 offset:38912
  ds_read_b128 v[56:59], v12 offset:33792
  ds_read_b128 v[60:63], v12 offset:37888
  s_waitcnt lgkmcnt(6)
  v_mfma_f32_32x32x16_bf16 v[64:79], v[32:35], v[40:43], v[64:79]
  s_add_u32 m0, s27, 0
  s_add_u32 s29, s25, 327680
  buffer_load_dwordx4 v16, s[8:11], s29 offen lds
  v_mfma_f32_32x32x16_bf16 v[80:95], v[32:35], v[44:47], v[80:95]
  s_add_u32 m0, s27, 4096
  s_add_u32 s29, s25, 344064
  buffer_load_dwordx4 v16, s[8:11], s29 offen lds
  v_mfma_f32_32x32x16_bf16 v[96:111], v[36:39], v[40:43], v[96:111]
  s_add_u32 m0, s27, 8192
  s_add_u32 s29, s25, 360448
  buffer_load_dwordx4 v16, s[8:11], s29 offen lds
  v_mfma_f32_32x32x16_bf16 v[112:127], v[36:39], v[44:47], v[112:127]
  s_add_u32 m0, s27, 12288
  s_add_u32 s29, s25, 376832
  buffer_load_dwordx4 v16, s[8:11], s29 offen lds
  ds_read_b64_tr_b16 v[32:33], v10 offset:40960
  ds_read_b64_tr_b16 v[34:35], v10 offset:43008
  ds_read_b64_tr_b16 v[36:37], v11 offset:40960
  ds_read_b64_tr_b16 v[38:39], v11 offset:43008
  ds_read_b128 v[40:43], v12 offset:34816
  ds_read_b128 v[44:47], v12 offset:38912
  s_waitcnt lgkmcnt(6)
  v_mfma_f32_32x32x16_bf16 v[64:79], v[48:51], v[56:59], v[64:79]
  v_mfma_f32_32x32x16_bf16 v[80:95], v[48:51], v[60:63], v[80:95]
  v_mfma_f32_32x32x16_bf16 v[96:111], v[52:55], v[56:59], v[96:111]
  v_mfma_f32_32x32x16_bf16 v[112:127], v[52:55], v[60:63], v[112:127]
  s_add_u32 m0, s28, 0
  s_add_u32 s29, s26, 20480
  buffer_load_dwordx4 v17, s[12:15], s29 offen offset:0 lds
  buffer_load_dwordx4 v17, s[12:15], s29 offen offset:1024 lds
  buffer_load_dwordx4 v17, s[12:15], s29 offen offset:2048 lds
  buffer_load_dwordx4 v17, s[12:15], s29 offen offset:3072 lds
  ds_read_b64_tr_b16 v[48:49], v10 offset:45056
  ds_read_b64_tr_b16 v[50:51], v10 offset:47104
  ds_read_b64_tr_b16 v[52:53], v11 offset:45056
  ds_read_b64_tr_b16 v[54:55], v11 offset:47104
  ds_read_b128 v[56:59], v12 offset:35840
  ds_read_b128 v[60:63], v12 offset:39936
  s_waitcnt lgkmcnt(6)
  v_mfma_f32_32x32x16_bf16 v[64:79], v[32:35], v[40:43], v[64:79]
  v_mfma_f32_32x32x16_bf16 v[80:95], v[32:35], v[44:47], v[80:95]
  v_mfma_f32_32x32x16_bf16 v[96:111], v[36:39], v[40:43], v[96:111]
  v_mfma_f32_32x32x16_bf16 v[112:127], v[36:39], v[44:47], v[112:127]
  s_waitcnt lgkmcnt(0)
  v_mfma_f32_32x32x16_bf16 v[64:79], v[48:51], v[56:59], v[64:79]
  v_mfma_f32_32x32x16_bf16 v[80:95], v[48:51], v[60:63], v[80:95]
  v_mfma_f32_32x32x16_bf16 v[96:111], v[52:55], v[56:59], v[96:111]
  v_mfma_f32_32x32x16_bf16 v[112:127], v[52:55], v[60:63], v[112:127]
  s_waitcnt vmcnt(24)
  s_barrier
  ds_read_b64_tr_b16 v[32:33], v13 offset:0
  ds_read_b64_tr_b16 v[34:35], v13 offset:2048
  ds_read_b64_tr_b16 v[36:37], v14 offset:0
  ds_read_b64_tr_b16 v[38:39], v14 offset:2048
  ds_read_b128 v[40:43], v15 offset:0
  ds_read_b128 v[44:47], v15 offset:4096
  ds_read_b64_tr_b16 v[48:49], v13 offset:4096
  ds_read_b64_tr_b16 v[50:51], v13 offset:6144
  ds_read_b64_tr_b16 v[52:53], v14 offset:4096
  ds_read_b64_tr_b16 v[54:55], v14 offset:6144
  ds_read_b128 v[56:59], v15 offset:1024
  ds_read_b128 v[60:63], v15 offset:5120
  s_waitcnt lgkmcnt(6)
  v_mfma_f32_32x32x16_bf16 v[64:79], v[32:35], v[40:43], v[64:79]
  s_add_u32 m0, s27, 32768
  s_add_u32 s29, s25, 393216
  buffer_load_dwordx4 v16, s[8:11], s29 offen lds
  v_mfma_f32_32x32x16_bf16 v[80:95], v[32:35], v[44:47], v[80:95]
  s_add_u32 m0, s27, 36864
  s_add_u32 s29, s25, 409600
  buffer_load_dwordx4 v16, s[8:11], s29 offen lds
  v_mfma_f32_32x32x16_bf16 v[96:111], v[36:39], v[40:43], v[96:111]
  s_add_u32 m0, s27, 40960
  s_add_u32 s29, s25, 425984
  buffer_load_dwordx4 v16, s[8:11], s29 offen lds
  v_mfma_f32_32x32x16_bf16 v[112:127], v[36:39], v[44:47], v[112:127]
  s_add_u32 m0, s27, 45056
  s_add_u32 s29, s25, 442368
  buffer_load_dwordx4 v16, s[8:11], s29 offen lds
  ds_read_b64_tr_b16 v[32:33], v13 offset:8192
  ds_read_b64_tr_b16 v[34:35], v13 offset:10240
  ds_read_b64_tr_b16 v[36:37], v14 offset:8192
  ds_read_b64_tr_b16 v[38:39], v14 offset:10240
  ds_read_b128 v[40:43], v15 offset:2048
  ds_read_b128 v[44:47], v15 offset:6144
  s_waitcnt lgkmcnt(6)
  v_mfma_f32_32x32x16_bf16 v[64:79], v[48:51], v[56:59], v[64:79]
  v_mfma_f32_32x32x16_bf16 v[80:95], v[48:51], v[60:63], v[80:95]
  v_mfma_f32_32x32x16_bf16 v[96:111], v[52:55], v[56:59], v[96:111]
  v_mfma_f32_32x32x16_bf16 v[112:127], v[52:55], v[60:63], v[112:127]
  s_add_u32 m0, s28, 32768
  s_add_u32 s29, s26, 24576
  buffer_load_dwordx4 v17, s[12:15], s29 offen offset:0 lds
  buffer_load_dwordx4 v17, s[12:15], s29 offen offset:1024 lds
  buffer_load_dwordx4 v17, s[12:15], s29 offen offset:2048 lds
  buffer_load_dwordx4 v17, s[12:15], s29 offen offset:3072 lds
  ds_read_b64_tr_b16 v[48:49], v13 offset:12288
  ds_read_b64_tr_b16 v[50:51], v13 offset:14336
  ds_read_b64_tr_b16 v[52:53], v14 offset:12288
  ds_read_b64_tr_b16 v[54:55], v14 offset:14336
  ds_read_b128 v[56:59], v15 offset:3072
  ds_read_b128 v[60:63], v15 offset:7168
  s_waitcnt lgkmcnt(6)
  v_mfma_f32_32x32x16_bf16 v[64:79], v[32:35], v[40:43], v[64:79]
  v_mfma_f32_32x32x16_bf16 v[80:95], v[32:35], v[44:47], v[80:95]
  v_mfma_f32_32x32x16_bf16 v[96:111], v[36:39], v[40:43], v[96:111]
  v_mfma_f32_32x32x16_bf16 v[112:127], v[36:39], v[44:47], v[112:127]
  s_waitcnt lgkmcnt(0)
  v_mfma_f32_32x32x16_bf16 v[64:79], v[48:51], v[56:59], v[64:79]
  v_mfma_f32_32x32x16_bf16 v[80:95], v[48:51], v[60:63], v[80:95]
  v_mfma_f32_32x32x16_bf16 v[96:111], v[52:55], v[56:59], v[96:111]
  v_mfma_f32_32x32x16_bf16 v[112:127], v[52:55], v[60:63], v[112:127]
  s_waitcnt vmcnt(24)
  s_barrier
  ds_read_b64_tr_b16 v[32:33], v13 offset:32768
  ds_read_b64_tr_b16 v[34:35], v13 offset:34816
  ds_read_b64_tr_b16 v[36:37], v14 offset:32768
  ds_read_b64_tr_b16 v[38:39], v14 offset:34816
  ds_read_b128 v[40:43], v15 offset:32768
  ds_read_b128 v[44:47], v15 offset:36864
  ds_read_b64_tr_b16 v[48:49], v13 offset:36864
  ds_read_b64_tr_b16 v[50:51], v13 offset:38912
  ds_read_b64_tr_b16 v[52:53], v14 offset:36864
  ds_read_b64_tr_b16 v[54:55], v14 offset:38912
  ds_read_b128 v[56:59], v15 offset:33792
  ds_read_b128 v[60:63], v15 offset:37888
  s_waitcnt lgkmcnt(6)
  v_mfma_f32_32x32x16_bf16 v[64:79], v[32:35], v[40:43], v[64:79]
  s_add_u32 m0, s27, 65536
  s_add_u32 s29, s25, 458752
  buffer_load_dwordx4 v16, s[8:11], s29 offen lds
  v_mfma_f32_32x32x16_bf16 v[80:95], v[32:35], v[44:47], v[80:95]
  s_add_u32 m0, s27, 69632
  s_add_u32 s29, s25, 475136
  buffer_load_dwordx4 v16, s[8:11], s29 offen lds
  v_mfma_f32_32x32x16_bf16 v[96:111], v[36:39], v[40:43], v[96:111]
  s_add_u32 m0, s27, 73728
  s_add_u32 s29, s25, 491520
  buffer_load_dwordx4 v16, s[8:11], s29 offen lds
  v_mfma_f32_32x32x16_bf16 v[112:127], v[36:39], v[44:47], v[112:127]
  s_add_u32 m0, s27, 77824
  s_add_u32 s29, s25, 507904
  buffer_load_dwordx4 v16, s[8:11], s29 offen lds
  ds_read_b64_tr_b16 v[32:33], v13 offset:40960
  ds_read_b64_tr_b16 v[34:35], v13 offset:43008
  ds_read_b64_tr_b16 v[36:37], v14 offset:40960
  ds_read_b64_tr_b16 v[38:39], v14 offset:43008
  ds_read_b128 v[40:43], v15 offset:34816
  ds_read_b128 v[44:47], v15 offset:38912
  s_waitcnt lgkmcnt(6)
  v_mfma_f32_32x32x16_bf16 v[64:79], v[48:51], v[56:59], v[64:79]
  v_mfma_f32_32x32x16_bf16 v[80:95], v[48:51], v[60:63], v[80:95]
  v_mfma_f32_32x32x16_bf16 v[96:111], v[52:55], v[56:59], v[96:111]
  v_mfma_f32_32x32x16_bf16 v[112:127], v[52:55], v[60:63], v[112:127]
  s_add_u32 m0, s28, 65536
  s_add_u32 s29, s26, 28672
  buffer_load_dwordx4 v17, s[12:15], s29 offen offset:0 lds
  buffer_load_dwordx4 v17, s[12:15], s29 offen offset:1024 lds
  buffer_load_dwordx4 v17, s[12:15], s29 offen offset:2048 lds
  buffer_load_dwordx4 v17, s[12:15], s29 offen offset:3072 lds
  ds_read_b64_tr_b16 v[48:49], v13 offset:45056
  ds_read_b64_tr_b16 v[50:51], v13 offset:47104
  ds_read_b64_tr_b16 v[52:53], v14 offset:45056
  ds_read_b64_tr_b16 v[54:55], v14 offset:47104
  ds_read_b128 v[56:59], v15 offset:35840
  ds_read_b128 v[60:63], v15 offset:39936
  s_waitcnt lgkmcnt(6)
  v_mfma_f32_32x32x16_bf16 v[64:79], v[32:35], v[40:43], v[64:79]
  v_mfma_f32_32x32x16_bf16 v[80:95], v[32:35], v[44:47], v[80:95]
  v_mfma_f32_32x32x16_bf16 v[96:111], v[36:39], v[40:43], v[96:111]
  v_mfma_f32_32x32x16_bf16 v[112:127], v[36:39], v[44:47], v[112:127]
  s_waitcnt lgkmcnt(0)
  v_mfma_f32_32x32x16_bf16 v[64:79], v[48:51], v[56:59], v[64:79]
  v_mfma_f32_32x32x16_bf16 v[80:95], v[48:51], v[60:63], v[80:95]
  v_mfma_f32_32x32x16_bf16 v[96:111], v[52:55], v[56:59], v[96:111]
  v_mfma_f32_32x32x16_bf16 v[112:127], v[52:55], v[60:63], v[112:127]
  s_waitcnt vmcnt(24)
  s_barrier
  ds_read_b64_tr_b16 v[32:33], v27 offset:0
  ds_read_b64_tr_b16 v[34:35], v27 offset:2048
  ds_read_b64_tr_b16 v[36:37], v28 offset:0
  ds_read_b64_tr_b16 v[38:39], v28 offset:2048
  ds_read_b128 v[40:43], v29 offset:0
  ds_read_b128 v[44:47], v29 offset:4096
  ds_read_b64_tr_b16 v[48:49], v27 offset:4096
  ds_read_b64_tr_b16 v[50:51], v27 offset:6144
  ds_read_b64_tr_b16 v[52:53], v28 offset:4096
  ds_read_b64_tr_b16 v[54:55], v28 offset:6144
  ds_read_b128 v[56:59], v29 offset:1024
  ds_read_b128 v[60:63], v29 offset:5120
  s_waitcnt lgkmcnt(6)
  v_mfma_f32_32x32x16_bf16 v[64:79], v[32:35], v[40:43], v[64:79]
  s_add_u32 m0, s27, 98304
  s_add_u32 s29, s25, 524288
  buffer_load_dwordx4 v16, s[8:11], s29 offen lds
  v_mfma_f32_32x32x16_bf16 v[80:95], v[32:35], v[44:47], v[80:95]
  s_add_u32 m0, s27, 102400
  s_add_u32 s29, s25, 540672
  buffer_load_dwordx4 v16, s[8:11], s29 offen lds
  v_mfma_f32_32x32x16_bf16 v[96:111], v[36:39], v[40:43], v[96:111]
  s_add_u32 m0, s27, 106496
  s_add_u32 s29, s25, 557056
  buffer_load_dwordx4 v16, s[8:11], s29 offen lds
  v_mfma_f32_32x32x16_bf16 v[112:127], v[36:39], v[44:47], v[112:127]
  s_add_u32 m0, s27, 110592
  s_add_u32 s29, s25, 573440
  buffer_load_dwordx4 v16, s[8:11], s29 offen lds
  ds_read_b64_tr_b16 v[32:33], v27 offset:8192
  ds_read_b64_tr_b16 v[34:35], v27 offset:10240
  ds_read_b64_tr_b16 v[36:37], v28 offset:8192
  ds_read_b64_tr_b16 v[38:39], v28 offset:10240
  ds_read_b128 v[40:43], v29 offset:2048
  ds_read_b128 v[44:47], v29 offset:6144
  s_waitcnt lgkmcnt(6)
  v_mfma_f32_32x32x16_bf16 v[64:79], v[48:51], v[56:59], v[64:79]
  v_mfma_f32_32x32x16_bf16 v[80:95], v[48:51], v[60:63], v[80:95]
  v_mfma_f32_32x32x16_bf16 v[96:111], v[52:55], v[56:59], v[96:111]
  v_mfma_f32_32x32x16_bf16 v[112:127], v[52:55], v[60:63], v[112:127]
  s_add_u32 m0, s28, 98304
  s_add_u32 s29, s26, 32768
  buffer_load_dwordx4 v17, s[12:15], s29 offen offset:0 lds
  buffer_load_dwordx4 v17, s[12:15], s29 offen offset:1024 lds
  buffer_load_dwordx4 v17, s[12:15], s29 offen offset:2048 lds
  buffer_load_dwordx4 v17, s[12:15], s29 offen offset:3072 lds
  ds_read_b64_tr_b16 v[48:49], v27 offset:12288
  ds_read_b64_tr_b16 v[50:51], v27 offset:14336
  ds_read_b64_tr_b16 v[52:53], v28 offset:12288
  ds_read_b64_tr_b16 v[54:55], v28 offset:14336
  ds_read_b128 v[56:59], v29 offset:3072
  ds_read_b128 v[60:63], v29 offset:7168
  s_waitcnt lgkmcnt(6)
  v_mfma_f32_32x32x16_bf16 v[64:79], v[32:35], v[40:43], v[64:79]
  v_mfma_f32_32x32x16_bf16 v[80:95], v[32:35], v[44:47], v[80:95]
  v_mfma_f32_32x32x16_bf16 v[96:111], v[36:39], v[40:43], v[96:111]
  v_mfma_f32_32x32x16_bf16 v[112:127], v[36:39], v[44:47], v[112:127]
  s_waitcnt lgkmcnt(0)
  v_mfma_f32_32x32x16_bf16 v[64:79], v[48:51], v[56:59], v[64:79]
  v_mfma_f32_32x32x16_bf16 v[80:95], v[48:51], v[60:63], v[80:95]
  v_mfma_f32_32x32x16_bf16 v[96:111], v[52:55], v[56:59], v[96:111]
  v_mfma_f32_32x32x16_bf16 v[112:127], v[52:55], v[60:63], v[112:127]
  s_waitcnt vmcnt(24)
  s_barrier
  ds_read_b64_tr_b16 v[32:33], v10 offset:0
  ds_read_b64_tr_b16 v[34:35], v10 offset:2048
  ds_read_b64_tr_b16 v[36:37], v11 offset:0
  ds_read_b64_tr_b16 v[38:39], v11 offset:2048
  ds_read_b128 v[40:43], v12 offset:0
  ds_read_b128 v[44:47], v12 offset:4096
  ds_read_b64_tr_b16 v[48:49], v10 offset:4096
  ds_read_b64_tr_b16 v[50:51], v10 offset:6144
  ds_read_b64_tr_b16 v[52:53], v11 offset:4096
  ds_read_b64_tr_b16 v[54:55], v11 offset:6144
  ds_read_b128 v[56:59], v12 offset:1024
  ds_read_b128 v[60:63], v12 offset:5120
  s_waitcnt lgkmcnt(6)
  v_mfma_f32_32x32x16_bf16 v[64:79], v[32:35], v[40:43], v[64:79]
  s_add_u32 m0, s27, 131072
  s_add_u32 s29, s25, 589824
  buffer_load_dwordx4 v16, s[8:11], s29 offen lds
  v_mfma_f32_32x32x16_bf16 v[80:95], v[32:35], v[44:47], v[80:95]
  s_add_u32 m0, s27, 135168
  s_add_u32 s29, s25, 606208
  buffer_load_dwordx4 v16, s[8:11], s29 offen lds
  v_mfma_f32_32x32x16_bf16 v[96:111], v[36:39], v[40:43], v[96:111]
  s_add_u32 m0, s27, 139264
  s_add_u32 s29, s25, 622592
  buffer_load_dwordx4 v16, s[8:11], s29 offen lds
  v_mfma_f32_32x32x16_bf16 v[112:127], v[36:39], v[44:47], v[112:127]
  s_add_u32 m0, s27, 143360
  s_add_u32 s29, s25, 638976
  buffer_load_dwordx4 v16, s[8:11], s29 offen lds
  ds_read_b64_tr_b16 v[32:33], v10 offset:8192
  ds_read_b64_tr_b16 v[34:35], v10 offset:10240
  ds_read_b64_tr_b16 v[36:37], v11 offset:8192
  ds_read_b64_tr_b16 v[38:39], v11 offset:10240
  ds_read_b128 v[40:43], v12 offset:2048
  ds_read_b128 v[44:47], v12 offset:6144
  s_waitcnt lgkmcnt(6)
  v_mfma_f32_32x32x16_bf16 v[64:79], v[48:51], v[56:59], v[64:79]
  v_mfma_f32_32x32x16_bf16 v[80:95], v[48:51], v[60:63], v[80:95]
  v_mfma_f32_32x32x16_bf16 v[96:111], v[52:55], v[56:59], v[96:111]
  v_mfma_f32_32x32x16_bf16 v[112:127], v[52:55], v[60:63], v[112:127]
  s_add_u32 m0, s28, 131072
  s_add_u32 s29, s26, 36864
  buffer_load_dwordx4 v17, s[12:15], s29 offen offset:0 lds
  buffer_load_dwordx4 v17, s[12:15], s29 offen offset:1024 lds
  buffer_load_dwordx4 v17, s[12:15], s29 offen offset:2048 lds
  buffer_load_dwordx4 v17, s[12:15], s29 offen offset:3072 lds
  ds_read_b64_tr_b16 v[48:49], v10 offset:12288
  ds_read_b64_tr_b16 v[50:51], v10 offset:14336
  ds_read_b64_tr_b16 v[52:53], v11 offset:12288
  ds_read_b64_tr_b16 v[54:55], v11 offset:14336
  ds_read_b128 v[56:59], v12 offset:3072
  ds_read_b128 v[60:63], v12 offset:7168
  s_waitcnt lgkmcnt(6)
  v_mfma_f32_32x32x16_bf16 v[64:79], v[32:35], v[40:43], v[64:79]
  v_mfma_f32_32x32x16_bf16 v[80:95], v[32:35], v[44:47], v[80:95]
  v_mfma_f32_32x32x16_bf16 v[96:111], v[36:39], v[40:43], v[96:111]
  v_mfma_f32_32x32x16_bf16 v[112:127], v[36:39], v[44:47], v[112:127]
  s_waitcnt lgkmcnt(0)
  v_mfma_f32_32x32x16_bf16 v[64:79], v[48:51], v[56:59], v[64:79]
  v_mfma_f32_32x32x16_bf16 v[80:95], v[48:51], v[60:63], v[80:95]
  v_mfma_f32_32x32x16_bf16 v[96:111], v[52:55], v[56:59], v[96:111]
  v_mfma_f32_32x32x16_bf16 v[112:127], v[52:55], v[60:63], v[112:127]
  s_waitcnt vmcnt(24)
  s_barrier
  ds_read_b64_tr_b16 v[32:33], v10 offset:32768
  ds_read_b64_tr_b16 v[34:35], v10 offset:34816
  ds_read_b64_tr_b16 v[36:37], v11 offset:32768
  ds_read_b64_tr_b16 v[38:39], v11 offset:34816
  ds_read_b128 v[40:43], v12 offset:32768
  ds_read_b128 v[44:47], v12 offset:36864
  ds_read_b64_tr_b16 v[48:49], v10 offset:36864
  ds_read_b64_tr_b16 v[50:51], v10 offset:38912
  ds_read_b64_tr_b16 v[52:53], v11 offset:36864
  ds_read_b64_tr_b16 v[54:55], v11 offset:38912
  ds_read_b128 v[56:59], v12 offset:33792
  ds_read_b128 v[60:63], v12 offset:37888
  s_waitcnt lgkmcnt(6)
  v_mfma_f32_32x32x16_bf16 v[64:79], v[32:35], v[40:43], v[64:79]
  s_add_u32 m0, s27, 0
  s_add_u32 s29, s25, 655360
  buffer_load_dwordx4 v16, s[8:11], s29 offen lds
  v_mfma_f32_32x32x16_bf16 v[80:95], v[32:35], v[44:47], v[80:95]
  s_add_u32 m0, s27, 4096
  s_add_u32 s29, s25, 671744
  buffer_load_dwordx4 v16, s[8:11], s29 offen lds
  v_mfma_f32_32x32x16_bf16 v[96:111], v[36:39], v[40:43], v[96:111]
  s_add_u32 m0, s27, 8192
  s_add_u32 s29, s25, 688128
  buffer_load_dwordx4 v16, s[8:11], s29 offen lds
  v_mfma_f32_32x32x16_bf16 v[112:127], v[36:39], v[44:47], v[112:127]
  s_add_u32 m0, s27, 12288
  s_add_u32 s29, s25, 704512
  buffer_load_dwordx4 v16, s[8:11], s29 offen lds
  ds_read_b64_tr_b16 v[32:33], v10 offset:40960
  ds_read_b64_tr_b16 v[34:35], v10 offset:43008
  ds_read_b64_tr_b16 v[36:37], v11 offset:40960
  ds_read_b64_tr_b16 v[38:39], v11 offset:43008
  ds_read_b128 v[40:43], v12 offset:34816
  ds_read_b128 v[44:47], v12 offset:38912
  s_waitcnt lgkmcnt(6)
  v_mfma_f32_32x32x16_bf16 v[64:79], v[48:51], v[56:59], v[64:79]
  v_mfma_f32_32x32x16_bf16 v[80:95], v[48:51], v[60:63], v[80:95]
  v_mfma_f32_32x32x16_bf16 v[96:111], v[52:55], v[56:59], v[96:111]
  v_mfma_f32_32x32x16_bf16 v[112:127], v[52:55], v[60:63], v[112:127]
  s_add_u32 m0, s28, 0
  s_add_u32 s29, s26, 40960
  buffer_load_dwordx4 v17, s[12:15], s29 offen offset:0 lds
  buffer_load_dwordx4 v17, s[12:15], s29 offen offset:1024 lds
  buffer_load_dwordx4 v17, s[12:15], s29 offen offset:2048 lds
  buffer_load_dwordx4 v17, s[12:15], s29 offen offset:3072 lds
  ds_read_b64_tr_b16 v[48:49], v10 offset:45056
  ds_read_b64_tr_b16 v[50:51], v10 offset:47104
  ds_read_b64_tr_b16 v[52:53], v11 offset:45056
  ds_read_b64_tr_b16 v[54:55], v11 offset:47104
  ds_read_b128 v[56:59], v12 offset:35840
  ds_read_b128 v[60:63], v12 offset:39936
  s_waitcnt lgkmcnt(6)
  v_mfma_f32_32x32x16_bf16 v[64:79], v[32:35], v[40:43], v[64:79]
  v_mfma_f32_32x32x16_bf16 v[80:95], v[32:35], v[44:47], v[80:95]
  v_mfma_f32_32x32x16_bf16 v[96:111], v[36:39], v[40:43], v[96:111]
  v_mfma_f32_32x32x16_bf16 v[112:127], v[36:39], v[44:47], v[112:127]
  s_waitcnt lgkmcnt(0)
  v_mfma_f32_32x32x16_bf16 v[64:79], v[48:51], v[56:59], v[64:79]
  v_mfma_f32_32x32x16_bf16 v[80:95], v[48:51], v[60:63], v[80:95]
  v_mfma_f32_32x32x16_bf16 v[96:111], v[52:55], v[56:59], v[96:111]
  v_mfma_f32_32x32x16_bf16 v[112:127], v[52:55], v[60:63], v[112:127]
  s_waitcnt vmcnt(24)
  s_barrier
  ds_read_b64_tr_b16 v[32:33], v13 offset:0
  ds_read_b64_tr_b16 v[34:35], v13 offset:2048
  ds_read_b64_tr_b16 v[36:37], v14 offset:0
  ds_read_b64_tr_b16 v[38:39], v14 offset:2048
  ds_read_b128 v[40:43], v15 offset:0
  ds_read_b128 v[44:47], v15 offset:4096
  ds_read_b64_tr_b16 v[48:49], v13 offset:4096
  ds_read_b64_tr_b16 v[50:51], v13 offset:6144
  ds_read_b64_tr_b16 v[52:53], v14 offset:4096
  ds_read_b64_tr_b16 v[54:55], v14 offset:6144
  ds_read_b128 v[56:59], v15 offset:1024
  ds_read_b128 v[60:63], v15 offset:5120
  s_waitcnt lgkmcnt(6)
  v_mfma_f32_32x32x16_bf16 v[64:79], v[32:35], v[40:43], v[64:79]
  s_add_u32 m0, s27, 32768
  s_add_u32 s29, s25, 720896
  buffer_load_dwordx4 v16, s[8:11], s29 offen lds
  v_mfma_f32_32x32x16_bf16 v[80:95], v[32:35], v[44:47], v[80:95]
  s_add_u32 m0, s27, 36864
  s_add_u32 s29, s25, 737280
  buffer_load_dwordx4 v16, s[8:11], s29 offen lds
  v_mfma_f32_32x32x16_bf16 v[96:111], v[36:39], v[40:43], v[96:111]
  s_add_u32 m0, s27, 40960
  s_add_u32 s29, s25, 753664
  buffer_load_dwordx4 v16, s[8:11], s29 offen lds
  v_mfma_f32_32x32x16_bf16 v[112:127], v[36:39], v[44:47], v[112:127]
  s_add_u32 m0, s27, 45056
  s_add_u32 s29, s25, 770048
  buffer_load_dwordx4 v16, s[8:11], s29 offen lds
  ds_read_b64_tr_b16 v[32:33], v13 offset:8192
  ds_read_b64_tr_b16 v[34:35], v13 offset:10240
  ds_read_b64_tr_b16 v[36:37], v14 offset:8192
  ds_read_b64_tr_b16 v[38:39], v14 offset:10240
  ds_read_b128 v[40:43], v15 offset:2048
  ds_read_b128 v[44:47], v15 offset:6144
  s_waitcnt lgkmcnt(6)
  v_mfma_f32_32x32x16_bf16 v[64:79], v[48:51], v[56:59], v[64:79]
  v_mfma_f32_32x32x16_bf16 v[80:95], v[48:51], v[60:63], v[80:95]
  v_mfma_f32_32x32x16_bf16 v[96:111], v[52:55], v[56:59], v[96:111]
  v_mfma_f32_32x32x16_bf16 v[112:127], v[52:55], v[60:63], v[112:127]
  s_add_u32 m0, s28, 32768
  s_add_u32 s29, s26, 45056
  buffer_load_dwordx4 v17, s[12:15], s29 offen offset:0 lds
  buffer_load_dwordx4 v17, s[12:15], s29 offen offset:1024 lds
  buffer_load_dwordx4 v17, s[12:15], s29 offen offset:2048 lds
  buffer_load_dwordx4 v17, s[12:15], s29 offen offset:3072 lds
  ds_read_b64_tr_b16 v[48:49], v13 offset:12288
  ds_read_b64_tr_b16 v[50:51], v13 offset:14336
  ds_read_b64_tr_b16 v[52:53], v14 offset:12288
  ds_read_b64_tr_b16 v[54:55], v14 offset:14336
  ds_read_b128 v[56:59], v15 offset:3072
  ds_read_b128 v[60:63], v15 offset:7168
  s_waitcnt lgkmcnt(6)
  v_mfma_f32_32x32x16_bf16 v[64:79], v[32:35], v[40:43], v[64:79]
  v_mfma_f32_32x32x16_bf16 v[80:95], v[32:35], v[44:47], v[80:95]
  v_mfma_f32_32x32x16_bf16 v[96:111], v[36:39], v[40:43], v[96:111]
  v_mfma_f32_32x32x16_bf16 v[112:127], v[36:39], v[44:47], v[112:127]
  s_waitcnt lgkmcnt(0)
  v_mfma_f32_32x32x16_bf16 v[64:79], v[48:51], v[56:59], v[64:79]
  v_mfma_f32_32x32x16_bf16 v[80:95], v[48:51], v[60:63], v[80:95]
  v_mfma_f32_32x32x16_bf16 v[96:111], v[52:55], v[56:59], v[96:111]
  v_mfma_f32_32x32x16_bf16 v[112:127], v[52:55], v[60:63], v[112:127]
  s_waitcnt vmcnt(24)
  s_barrier
  ds_read_b64_tr_b16 v[32:33], v13 offset:32768
  ds_read_b64_tr_b16 v[34:35], v13 offset:34816
  ds_read_b64_tr_b16 v[36:37], v14 offset:32768
  ds_read_b64_tr_b16 v[38:39], v14 offset:34816
  ds_read_b128 v[40:43], v15 offset:32768
  ds_read_b128 v[44:47], v15 offset:36864
  ds_read_b64_tr_b16 v[48:49], v13 offset:36864
  ds_read_b64_tr_b16 v[50:51], v13 offset:38912
  ds_read_b64_tr_b16 v[52:53], v14 offset:36864
  ds_read_b64_tr_b16 v[54:55], v14 offset:38912
  ds_read_b128 v[56:59], v15 offset:33792
  ds_read_b128 v[60:63], v15 offset:37888
  s_waitcnt lgkmcnt(6)
  v_mfma_f32_32x32x16_bf16 v[64:79], v[32:35], v[40:43], v[64:79]
  s_add_u32 m0, s27, 65536
  s_add_u32 s29, s25, 786432
  buffer_load_dwordx4 v16, s[8:11], s29 offen lds
  v_mfma_f32_32x32x16_bf16 v[80:95], v[32:35], v[44:47], v[80:95]
  s_add_u32 m0, s27, 69632
  s_add_u32 s29, s25, 802816
  buffer_load_dwordx4 v16, s[8:11], s29 offen lds
  v_mfma_f32_32x32x16_bf16 v[96:111], v[36:39], v[40:43], v[96:111]
  s_add_u32 m0, s27, 73728
  s_add_u32 s29, s25, 819200
  buffer_load_dwordx4 v16, s[8:11], s29 offen lds
  v_mfma_f32_32x32x16_bf16 v[112:127], v[36:39], v[44:47], v[112:127]
  s_add_u32 m0, s27, 77824
  s_add_u32 s29, s25, 835584
  buffer_load_dwordx4 v16, s[8:11], s29 offen lds
  ds_read_b64_tr_b16 v[32:33], v13 offset:40960
  ds_read_b64_tr_b16 v[34:35], v13 offset:43008
  ds_read_b64_tr_b16 v[36:37], v14 offset:40960
  ds_read_b64_tr_b16 v[38:39], v14 offset:43008
  ds_read_b128 v[40:43], v15 offset:34816
  ds_read_b128 v[44:47], v15 offset:38912
  s_waitcnt lgkmcnt(6)
  v_mfma_f32_32x32x16_bf16 v[64:79], v[48:51], v[56:59], v[64:79]
  v_mfma_f32_32x32x16_bf16 v[80:95], v[48:51], v[60:63], v[80:95]
  v_mfma_f32_32x32x16_bf16 v[96:111], v[52:55], v[56:59], v[96:111]
  v_mfma_f32_32x32x16_bf16 v[112:127], v[52:55], v[60:63], v[112:127]
  s_add_u32 m0, s28, 65536
  s_add_u32 s29, s26, 49152
  buffer_load_dwordx4 v17, s[12:15], s29 offen offset:0 lds
  buffer_load_dwordx4 v17, s[12:15], s29 offen offset:1024 lds
  buffer_load_dwordx4 v17, s[12:15], s29 offen offset:2048 lds
  buffer_load_dwordx4 v17, s[12:15], s29 offen offset:3072 lds
  ds_read_b64_tr_b16 v[48:49], v13 offset:45056
  ds_read_b64_tr_b16 v[50:51], v13 offset:47104
  ds_read_b64_tr_b16 v[52:53], v14 offset:45056
  ds_read_b64_tr_b16 v[54:55], v14 offset:47104
  ds_read_b128 v[56:59], v15 offset:35840
  ds_read_b128 v[60:63], v15 offset:39936
  s_waitcnt lgkmcnt(6)
  v_mfma_f32_32x32x16_bf16 v[64:79], v[32:35], v[40:43], v[64:79]
  v_mfma_f32_32x32x16_bf16 v[80:95], v[32:35], v[44:47], v[80:95]
  v_mfma_f32_32x32x16_bf16 v[96:111], v[36:39], v[40:43], v[96:111]
  v_mfma_f32_32x32x16_bf16 v[112:127], v[36:39], v[44:47], v[112:127]
  s_waitcnt lgkmcnt(0)
  v_mfma_f32_32x32x16_bf16 v[64:79], v[48:51], v[56:59], v[64:79]
  v_mfma_f32_32x32x16_bf16 v[80:95], v[48:51], v[60:63], v[80:95]
  v_mfma_f32_32x32x16_bf16 v[96:111], v[52:55], v[56:59], v[96:111]
  v_mfma_f32_32x32x16_bf16 v[112:127], v[52:55], v[60:63], v[112:127]
  s_waitcnt vmcnt(24)
  s_barrier
  ds_read_b64_tr_b16 v[32:33], v27 offset:0
  ds_read_b64_tr_b16 v[34:35], v27 offset:2048
  ds_read_b64_tr_b16 v[36:37], v28 offset:0
  ds_read_b64_tr_b16 v[38:39], v28 offset:2048
  ds_read_b128 v[40:43], v29 offset:0
  ds_read_b128 v[44:47], v29 offset:4096
  ds_read_b64_tr_b16 v[48:49], v27 offset:4096
  ds_read_b64_tr_b16 v[50:51], v27 offset:6144
  ds_read_b64_tr_b16 v[52:53], v28 offset:4096
  ds_read_b64_tr_b16 v[54:55], v28 offset:6144
  ds_read_b128 v[56:59], v29 offset:1024
  ds_read_b128 v[60:63], v29 offset:5120
  s_waitcnt lgkmcnt(6)
  v_mfma_f32_32x32x16_bf16 v[64:79], v[32:35], v[40:43], v[64:79]
  s_add_u32 m0, s27, 98304
  s_add_u32 s29, s25, 851968
  buffer_load_dwordx4 v16, s[8:11], s29 offen lds
  v_mfma_f32_32x32x16_bf16 v[80:95], v[32:35], v[44:47], v[80:95]
  s_add_u32 m0, s27, 102400
  s_add_u32 s29, s25, 868352
  buffer_load_dwordx4 v16, s[8:11], s29 offen lds
  v_mfma_f32_32x32x16_bf16 v[96:111], v[36:39], v[40:43], v[96:111]
  s_add_u32 m0, s27, 106496
  s_add_u32 s29, s25, 884736
  buffer_load_dwordx4 v16, s[8:11], s29 offen lds
  v_mfma_f32_32x32x16_bf16 v[112:127], v[36:39], v[44:47], v[112:127]
  s_add_u32 m0, s27, 110592
  s_add_u32 s29, s25, 901120
  buffer_load_dwordx4 v16, s[8:11], s29 offen lds
  ds_read_b64_tr_b16 v[32:33], v27 offset:8192
  ds_read_b64_tr_b16 v[34:35], v27 offset:10240
  ds_read_b64_tr_b16 v[36:37], v28 offset:8192
  ds_read_b64_tr_b16 v[38:39], v28 offset:10240
  ds_read_b128 v[40:43], v29 offset:2048
  ds_read_b128 v[44:47], v29 offset:6144
  s_waitcnt lgkmcnt(6)
  v_mfma_f32_32x32x16_bf16 v[64:79], v[48:51], v[56:59], v[64:79]
  v_mfma_f32_32x32x16_bf16 v[80:95], v[48:51], v[60:63], v[80:95]
  v_mfma_f32_32x32x16_bf16 v[96:111], v[52:55], v[56:59], v[96:111]
  v_mfma_f32_32x32x16_bf16 v[112:127], v[52:55], v[60:63], v[112:127]
  s_add_u32 m0, s28, 98304
  s_add_u32 s29, s26, 53248
  buffer_load_dwordx4 v17, s[12:15], s29 offen offset:0 lds
  buffer_load_dwordx4 v17, s[12:15], s29 offen offset:1024 lds
  buffer_load_dwordx4 v17, s[12:15], s29 offen offset:2048 lds
  buffer_load_dwordx4 v17, s[12:15], s29 offen offset:3072 lds
  ds_read_b64_tr_b16 v[48:49], v27 offset:12288
  ds_read_b64_tr_b16 v[50:51], v27 offset:14336
  ds_read_b64_tr_b16 v[52:53], v28 offset:12288
  ds_read_b64_tr_b16 v[54:55], v28 offset:14336
  ds_read_b128 v[56:59], v29 offset:3072
  ds_read_b128 v[60:63], v29 offset:7168
  s_waitcnt lgkmcnt(6)
  v_mfma_f32_32x32x16_bf16 v[64:79], v[32:35], v[40:43], v[64:79]
  v_mfma_f32_32x32x16_bf16 v[80:95], v[32:35], v[44:47], v[80:95]
  v_mfma_f32_32x32x16_bf16 v[96:111], v[36:39], v[40:43], v[96:111]
  v_mfma_f32_32x32x16_bf16 v[112:127], v[36:39], v[44:47], v[112:127]
  s_waitcnt lgkmcnt(0)
  v_mfma_f32_32x32x16_bf16 v[64:79], v[48:51], v[56:59], v[64:79]
  v_mfma_f32_32x32x16_bf16 v[80:95], v[48:51], v[60:63], v[80:95]
  v_mfma_f32_32x32x16_bf16 v[96:111], v[52:55], v[56:59], v[96:111]
  v_mfma_f32_32x32x16_bf16 v[112:127], v[52:55], v[60:63], v[112:127]
  s_waitcnt vmcnt(24)
  s_barrier
  ds_read_b64_tr_b16 v[32:33], v10 offset:0
  ds_read_b64_tr_b16 v[34:35], v10 offset:2048
  ds_read_b64_tr_b16 v[36:37], v11 offset:0
  ds_read_b64_tr_b16 v[38:39], v11 offset:2048
  ds_read_b128 v[40:43], v12 offset:0
  ds_read_b128 v[44:47], v12 offset:4096
  ds_read_b64_tr_b16 v[48:49], v10 offset:4096
  ds_read_b64_tr_b16 v[50:51], v10 offset:6144
  ds_read_b64_tr_b16 v[52:53], v11 offset:4096
  ds_read_b64_tr_b16 v[54:55], v11 offset:6144
  ds_read_b128 v[56:59], v12 offset:1024
  ds_read_b128 v[60:63], v12 offset:5120
  s_waitcnt lgkmcnt(6)
  v_mfma_f32_32x32x16_bf16 v[64:79], v[32:35], v[40:43], v[64:79]
  s_add_u32 m0, s27, 131072
  s_add_u32 s29, s25, 917504
  buffer_load_dwordx4 v16, s[8:11], s29 offen lds
  v_mfma_f32_32x32x16_bf16 v[80:95], v[32:35], v[44:47], v[80:95]
  s_add_u32 m0, s27, 135168
  s_add_u32 s29, s25, 933888
  buffer_load_dwordx4 v16, s[8:11], s29 offen lds
  v_mfma_f32_32x32x16_bf16 v[96:111], v[36:39], v[40:43], v[96:111]
  s_add_u32 m0, s27, 139264
  s_add_u32 s29, s25, 950272
  buffer_load_dwordx4 v16, s[8:11], s29 offen lds
  v_mfma_f32_32x32x16_bf16 v[112:127], v[36:39], v[44:47], v[112:127]
  s_add_u32 m0, s27, 143360
  s_add_u32 s29, s25, 966656
  buffer_load_dwordx4 v16, s[8:11], s29 offen lds
  ds_read_b64_tr_b16 v[32:33], v10 offset:8192
  ds_read_b64_tr_b16 v[34:35], v10 offset:10240
  ds_read_b64_tr_b16 v[36:37], v11 offset:8192
  ds_read_b64_tr_b16 v[38:39], v11 offset:10240
  ds_read_b128 v[40:43], v12 offset:2048
  ds_read_b128 v[44:47], v12 offset:6144
  s_waitcnt lgkmcnt(6)
  v_mfma_f32_32x32x16_bf16 v[64:79], v[48:51], v[56:59], v[64:79]
  v_mfma_f32_32x32x16_bf16 v[80:95], v[48:51], v[60:63], v[80:95]
  v_mfma_f32_32x32x16_bf16 v[96:111], v[52:55], v[56:59], v[96:111]
  v_mfma_f32_32x32x16_bf16 v[112:127], v[52:55], v[60:63], v[112:127]
  s_add_u32 m0, s28, 131072
  s_add_u32 s29, s26, 57344
  buffer_load_dwordx4 v17, s[12:15], s29 offen offset:0 lds
  buffer_load_dwordx4 v17, s[12:15], s29 offen offset:1024 lds
  buffer_load_dwordx4 v17, s[12:15], s29 offen offset:2048 lds
  buffer_load_dwordx4 v17, s[12:15], s29 offen offset:3072 lds
  ds_read_b64_tr_b16 v[48:49], v10 offset:12288
  ds_read_b64_tr_b16 v[50:51], v10 offset:14336
  ds_read_b64_tr_b16 v[52:53], v11 offset:12288
  ds_read_b64_tr_b16 v[54:55], v11 offset:14336
  ds_read_b128 v[56:59], v12 offset:3072
  ds_read_b128 v[60:63], v12 offset:7168
  s_waitcnt lgkmcnt(6)
  v_mfma_f32_32x32x16_bf16 v[64:79], v[32:35], v[40:43], v[64:79]
  v_mfma_f32_32x32x16_bf16 v[80:95], v[32:35], v[44:47], v[80:95]
  v_mfma_f32_32x32x16_bf16 v[96:111], v[36:39], v[40:43], v[96:111]
  v_mfma_f32_32x32x16_bf16 v[112:127], v[36:39], v[44:47], v[112:127]
  s_waitcnt lgkmcnt(0)
  v_mfma_f32_32x32x16_bf16 v[64:79], v[48:51], v[56:59], v[64:79]
  v_mfma_f32_32x32x16_bf16 v[80:95], v[48:51], v[60:63], v[80:95]
  v_mfma_f32_32x32x16_bf16 v[96:111], v[52:55], v[56:59], v[96:111]
  v_mfma_f32_32x32x16_bf16 v[112:127], v[52:55], v[60:63], v[112:127]
  s_waitcnt vmcnt(24)
  s_barrier
  ds_read_b64_tr_b16 v[32:33], v10 offset:32768
  ds_read_b64_tr_b16 v[34:35], v10 offset:34816
  ds_read_b64_tr_b16 v[36:37], v11 offset:32768
  ds_read_b64_tr_b16 v[38:39], v11 offset:34816
  ds_read_b128 v[40:43], v12 offset:32768
  ds_read_b128 v[44:47], v12 offset:36864
  ds_read_b64_tr_b16 v[48:49], v10 offset:36864
  ds_read_b64_tr_b16 v[50:51], v10 offset:38912
  ds_read_b64_tr_b16 v[52:53], v11 offset:36864
  ds_read_b64_tr_b16 v[54:55], v11 offset:38912
  ds_read_b128 v[56:59], v12 offset:33792
  ds_read_b128 v[60:63], v12 offset:37888
  s_waitcnt lgkmcnt(6)
  v_mfma_f32_32x32x16_bf16 v[64:79], v[32:35], v[40:43], v[64:79]
  s_add_u32 m0, s27, 0
  s_add_u32 s29, s25, 983040
  buffer_load_dwordx4 v16, s[8:11], s29 offen lds
  v_mfma_f32_32x32x16_bf16 v[80:95], v[32:35], v[44:47], v[80:95]
  s_add_u32 m0, s27, 4096
  s_add_u32 s29, s25, 999424
  buffer_load_dwordx4 v16, s[8:11], s29 offen lds
  v_mfma_f32_32x32x16_bf16 v[96:111], v[36:39], v[40:43], v[96:111]
  s_add_u32 m0, s27, 8192
  s_add_u32 s29, s25, 1015808
  buffer_load_dwordx4 v16, s[8:11], s29 offen lds
  v_mfma_f32_32x32x16_bf16 v[112:127], v[36:39], v[44:47], v[112:127]
  s_add_u32 m0, s27, 12288
  s_add_u32 s29, s25, 1032192
  buffer_load_dwordx4 v16, s[8:11], s29 offen lds
  ds_read_b64_tr_b16 v[32:33], v10 offset:40960
  ds_read_b64_tr_b16 v[34:35], v10 offset:43008
  ds_read_b64_tr_b16 v[36:37], v11 offset:40960
  ds_read_b64_tr_b16 v[38:39], v11 offset:43008
  ds_read_b128 v[40:43], v12 offset:34816
  ds_read_b128 v[44:47], v12 offset:38912
  s_waitcnt lgkmcnt(6)
  v_mfma_f32_32x32x16_bf16 v[64:79], v[48:51], v[56:59], v[64:79]
  v_mfma_f32_32x32x16_bf16 v[80:95], v[48:51], v[60:63], v[80:95]
  v_mfma_f32_32x32x16_bf16 v[96:111], v[52:55], v[56:59], v[96:111]
  v_mfma_f32_32x32x16_bf16 v[112:127], v[52:55], v[60:63], v[112:127]
  s_add_u32 m0, s28, 0
  s_add_u32 s29, s26, 61440
  buffer_load_dwordx4 v17, s[12:15], s29 offen offset:0 lds
  buffer_load_dwordx4 v17, s[12:15], s29 offen offset:1024 lds
  buffer_load_dwordx4 v17, s[12:15], s29 offen offset:2048 lds
  buffer_load_dwordx4 v17, s[12:15], s29 offen offset:3072 lds
  ds_read_b64_tr_b16 v[48:49], v10 offset:45056
  ds_read_b64_tr_b16 v[50:51], v10 offset:47104
  ds_read_b64_tr_b16 v[52:53], v11 offset:45056
  ds_read_b64_tr_b16 v[54:55], v11 offset:47104
  ds_read_b128 v[56:59], v12 offset:35840
  ds_read_b128 v[60:63], v12 offset:39936
  s_waitcnt lgkmcnt(6)
  v_mfma_f32_32x32x16_bf16 v[64:79], v[32:35], v[40:43], v[64:79]
  v_mfma_f32_32x32x16_bf16 v[80:95], v[32:35], v[44:47], v[80:95]
  v_mfma_f32_32x32x16_bf16 v[96:111], v[36:39], v[40:43], v[96:111]
  v_mfma_f32_32x32x16_bf16 v[112:127], v[36:39], v[44:47], v[112:127]
  s_waitcnt lgkmcnt(0)
  v_mfma_f32_32x32x16_bf16 v[64:79], v[48:51], v[56:59], v[64:79]
  v_mfma_f32_32x32x16_bf16 v[80:95], v[48:51], v[60:63], v[80:95]
  v_mfma_f32_32x32x16_bf16 v[96:111], v[52:55], v[56:59], v[96:111]
  v_mfma_f32_32x32x16_bf16 v[112:127], v[52:55], v[60:63], v[112:127]
  s_waitcnt vmcnt(24)
  s_barrier
  ds_read_b64_tr_b16 v[32:33], v13 offset:0
  ds_read_b64_tr_b16 v[34:35], v13 offset:2048
  ds_read_b64_tr_b16 v[36:37], v14 offset:0
  ds_read_b64_tr_b16 v[38:39], v14 offset:2048
  ds_read_b128 v[40:43], v15 offset:0
  ds_read_b128 v[44:47], v15 offset:4096
  ds_read_b64_tr_b16 v[48:49], v13 offset:4096
  ds_read_b64_tr_b16 v[50:51], v13 offset:6144
  ds_read_b64_tr_b16 v[52:53], v14 offset:4096
  ds_read_b64_tr_b16 v[54:55], v14 offset:6144
  ds_read_b128 v[56:59], v15 offset:1024
  ds_read_b128 v[60:63], v15 offset:5120
  s_waitcnt lgkmcnt(6)
  v_mfma_f32_32x32x16_bf16 v[64:79], v[32:35], v[40:43], v[64:79]
  v_mfma_f32_32x32x16_bf16 v[80:95], v[32:35], v[44:47], v[80:95]
  v_mfma_f32_32x32x16_bf16 v[96:111], v[36:39], v[40:43], v[96:111]
  v_mfma_f32_32x32x16_bf16 v[112:127], v[36:39], v[44:47], v[112:127]
  ds_read_b64_tr_b16 v[32:33], v13 offset:8192
  ds_read_b64_tr_b16 v[34:35], v13 offset:10240
  ds_read_b64_tr_b16 v[36:37], v14 offset:8192
  ds_read_b64_tr_b16 v[38:39], v14 offset:10240
  ds_read_b128 v[40:43], v15 offset:2048
  ds_read_b128 v[44:47], v15 offset:6144
  s_waitcnt lgkmcnt(6)
  v_mfma_f32_32x32x16_bf16 v[64:79], v[48:51], v[56:59], v[64:79]
  v_mfma_f32_32x32x16_bf16 v[80:95], v[48:51], v[60:63], v[80:95]
  v_mfma_f32_32x32x16_bf16 v[96:111], v[52:55], v[56:59], v[96:111]
  v_mfma_f32_32x32x16_bf16 v[112:127], v[52:55], v[60:63], v[112:127]
  ds_read_b64_tr_b16 v[48:49], v13 offset:12288
  ds_read_b64_tr_b16 v[50:51], v13 offset:14336
  ds_read_b64_tr_b16 v[52:53], v14 offset:12288
  ds_read_b64_tr_b16 v[54:55], v14 offset:14336
  ds_read_b128 v[56:59], v15 offset:3072
  ds_read_b128 v[60:63], v15 offset:7168
  s_waitcnt lgkmcnt(6)
  v_mfma_f32_32x32x16_bf16 v[64:79], v[32:35], v[40:43], v[64:79]
  v_mfma_f32_32x32x16_bf16 v[80:95], v[32:35], v[44:47], v[80:95]
  v_mfma_f32_32x32x16_bf16 v[96:111], v[36:39], v[40:43], v[96:111]
  v_mfma_f32_32x32x16_bf16 v[112:127], v[36:39], v[44:47], v[112:127]
  s_waitcnt lgkmcnt(0)
  v_mfma_f32_32x32x16_bf16 v[64:79], v[48:51], v[56:59], v[64:79]
  v_mfma_f32_32x32x16_bf16 v[80:95], v[48:51], v[60:63], v[80:95]
  v_mfma_f32_32x32x16_bf16 v[96:111], v[52:55], v[56:59], v[96:111]
  v_mfma_f32_32x32x16_bf16 v[112:127], v[52:55], v[60:63], v[112:127]
  s_waitcnt vmcnt(16)
  s_barrier
  ds_read_b64_tr_b16 v[32:33], v13 offset:32768
  ds_read_b64_tr_b16 v[34:35], v13 offset:34816
  ds_read_b64_tr_b16 v[36:37], v14 offset:32768
  ds_read_b64_tr_b16 v[38:39], v14 offset:34816
  ds_read_b128 v[40:43], v15 offset:32768
  ds_read_b128 v[44:47], v15 offset:36864
  ds_read_b64_tr_b16 v[48:49], v13 offset:36864
  ds_read_b64_tr_b16 v[50:51], v13 offset:38912
  ds_read_b64_tr_b16 v[52:53], v14 offset:36864
  ds_read_b64_tr_b16 v[54:55], v14 offset:38912
  ds_read_b128 v[56:59], v15 offset:33792
  ds_read_b128 v[60:63], v15 offset:37888
  s_waitcnt lgkmcnt(6)
  v_mfma_f32_32x32x16_bf16 v[64:79], v[32:35], v[40:43], v[64:79]
  v_mfma_f32_32x32x16_bf16 v[80:95], v[32:35], v[44:47], v[80:95]
  v_mfma_f32_32x32x16_bf16 v[96:111], v[36:39], v[40:43], v[96:111]
  v_mfma_f32_32x32x16_bf16 v[112:127], v[36:39], v[44:47], v[112:127]
  ds_read_b64_tr_b16 v[32:33], v13 offset:40960
  ds_read_b64_tr_b16 v[34:35], v13 offset:43008
  ds_read_b64_tr_b16 v[36:37], v14 offset:40960
  ds_read_b64_tr_b16 v[38:39], v14 offset:43008
  ds_read_b128 v[40:43], v15 offset:34816
  ds_read_b128 v[44:47], v15 offset:38912
  s_waitcnt lgkmcnt(6)
  v_mfma_f32_32x32x16_bf16 v[64:79], v[48:51], v[56:59], v[64:79]
  v_mfma_f32_32x32x16_bf16 v[80:95], v[48:51], v[60:63], v[80:95]
  v_mfma_f32_32x32x16_bf16 v[96:111], v[52:55], v[56:59], v[96:111]
  v_mfma_f32_32x32x16_bf16 v[112:127], v[52:55], v[60:63], v[112:127]
  ds_read_b64_tr_b16 v[48:49], v13 offset:45056
  ds_read_b64_tr_b16 v[50:51], v13 offset:47104
  ds_read_b64_tr_b16 v[52:53], v14 offset:45056
  ds_read_b64_tr_b16 v[54:55], v14 offset:47104
  ds_read_b128 v[56:59], v15 offset:35840
  ds_read_b128 v[60:63], v15 offset:39936
  s_waitcnt lgkmcnt(6)
  v_mfma_f32_32x32x16_bf16 v[64:79], v[32:35], v[40:43], v[64:79]
  v_mfma_f32_32x32x16_bf16 v[80:95], v[32:35], v[44:47], v[80:95]
  v_mfma_f32_32x32x16_bf16 v[96:111], v[36:39], v[40:43], v[96:111]
  v_mfma_f32_32x32x16_bf16 v[112:127], v[36:39], v[44:47], v[112:127]
  s_waitcnt lgkmcnt(0)
  v_mfma_f32_32x32x16_bf16 v[64:79], v[48:51], v[56:59], v[64:79]
  v_mfma_f32_32x32x16_bf16 v[80:95], v[48:51], v[60:63], v[80:95]
  v_mfma_f32_32x32x16_bf16 v[96:111], v[52:55], v[56:59], v[96:111]
  v_mfma_f32_32x32x16_bf16 v[112:127], v[52:55], v[60:63], v[112:127]
  s_waitcnt vmcnt(8)
  s_barrier
  ds_read_b64_tr_b16 v[32:33], v27 offset:0
  ds_read_b64_tr_b16 v[34:35], v27 offset:2048
  ds_read_b64_tr_b16 v[36:37], v28 offset:0
  ds_read_b64_tr_b16 v[38:39], v28 offset:2048
  ds_read_b128 v[40:43], v29 offset:0
  ds_read_b128 v[44:47], v29 offset:4096
  ds_read_b64_tr_b16 v[48:49], v27 offset:4096
  ds_read_b64_tr_b16 v[50:51], v27 offset:6144
  ds_read_b64_tr_b16 v[52:53], v28 offset:4096
  ds_read_b64_tr_b16 v[54:55], v28 offset:6144
  ds_read_b128 v[56:59], v29 offset:1024
  ds_read_b128 v[60:63], v29 offset:5120
  s_waitcnt lgkmcnt(6)
  v_mfma_f32_32x32x16_bf16 v[64:79], v[32:35], v[40:43], v[64:79]
  v_mfma_f32_32x32x16_bf16 v[80:95], v[32:35], v[44:47], v[80:95]
  v_mfma_f32_32x32x16_bf16 v[96:111], v[36:39], v[40:43], v[96:111]
  v_mfma_f32_32x32x16_bf16 v[112:127], v[36:39], v[44:47], v[112:127]
  ds_read_b64_tr_b16 v[32:33], v27 offset:8192
  ds_read_b64_tr_b16 v[34:35], v27 offset:10240
  ds_read_b64_tr_b16 v[36:37], v28 offset:8192
  ds_read_b64_tr_b16 v[38:39], v28 offset:10240
  ds_read_b128 v[40:43], v29 offset:2048
  ds_read_b128 v[44:47], v29 offset:6144
  s_waitcnt lgkmcnt(6)
  v_mfma_f32_32x32x16_bf16 v[64:79], v[48:51], v[56:59], v[64:79]
  v_mfma_f32_32x32x16_bf16 v[80:95], v[48:51], v[60:63], v[80:95]
  v_mfma_f32_32x32x16_bf16 v[96:111], v[52:55], v[56:59], v[96:111]
  v_mfma_f32_32x32x16_bf16 v[112:127], v[52:55], v[60:63], v[112:127]
  ds_read_b64_tr_b16 v[48:49], v27 offset:12288
  ds_read_b64_tr_b16 v[50:51], v27 offset:14336
  ds_read_b64_tr_b16 v[52:53], v28 offset:12288
  ds_read_b64_tr_b16 v[54:55], v28 offset:14336
  ds_read_b128 v[56:59], v29 offset:3072
  ds_read_b128 v[60:63], v29 offset:7168
  s_waitcnt lgkmcnt(6)
  v_mfma_f32_32x32x16_bf16 v[64:79], v[32:35], v[40:43], v[64:79]
  v_mfma_f32_32x32x16_bf16 v[80:95], v[32:35], v[44:47], v[80:95]
  v_mfma_f32_32x32x16_bf16 v[96:111], v[36:39], v[40:43], v[96:111]
  v_mfma_f32_32x32x16_bf16 v[112:127], v[36:39], v[44:47], v[112:127]
  s_waitcnt lgkmcnt(0)
  v_mfma_f32_32x32x16_bf16 v[64:79], v[48:51], v[56:59], v[64:79]
  v_mfma_f32_32x32x16_bf16 v[80:95], v[48:51], v[60:63], v[80:95]
  v_mfma_f32_32x32x16_bf16 v[96:111], v[52:55], v[56:59], v[96:111]
  v_mfma_f32_32x32x16_bf16 v[112:127], v[52:55], v[60:63], v[112:127]
  s_waitcnt vmcnt(0)
  s_barrier
  ds_read_b64_tr_b16 v[32:33], v10 offset:0
  ds_read_b64_tr_b16 v[34:35], v10 offset:2048
  ds_read_b64_tr_b16 v[36:37], v11 offset:0
  ds_read_b64_tr_b16 v[38:39], v11 offset:2048
  ds_read_b128 v[40:43], v12 offset:0
  ds_read_b128 v[44:47], v12 offset:4096
  ds_read_b64_tr_b16 v[48:49], v10 offset:4096
  ds_read_b64_tr_b16 v[50:51], v10 offset:6144
  ds_read_b64_tr_b16 v[52:53], v11 offset:4096
  ds_read_b64_tr_b16 v[54:55], v11 offset:6144
  ds_read_b128 v[56:59], v12 offset:1024
  ds_read_b128 v[60:63], v12 offset:5120
  s_waitcnt lgkmcnt(6)
  v_mfma_f32_32x32x16_bf16 v[64:79], v[32:35], v[40:43], v[64:79]
  v_mfma_f32_32x32x16_bf16 v[80:95], v[32:35], v[44:47], v[80:95]
  v_mfma_f32_32x32x16_bf16 v[96:111], v[36:39], v[40:43], v[96:111]
  v_mfma_f32_32x32x16_bf16 v[112:127], v[36:39], v[44:47], v[112:127]
  ds_read_b64_tr_b16 v[32:33], v10 offset:8192
  ds_read_b64_tr_b16 v[34:35], v10 offset:10240
  ds_read_b64_tr_b16 v[36:37], v11 offset:8192
  ds_read_b64_tr_b16 v[38:39], v11 offset:10240
  ds_read_b128 v[40:43], v12 offset:2048
  ds_read_b128 v[44:47], v12 offset:6144
  s_waitcnt lgkmcnt(6)
  v_mfma_f32_32x32x16_bf16 v[64:79], v[48:51], v[56:59], v[64:79]
  v_mfma_f32_32x32x16_bf16 v[80:95], v[48:51], v[60:63], v[80:95]
  v_mfma_f32_32x32x16_bf16 v[96:111], v[52:55], v[56:59], v[96:111]
  v_mfma_f32_32x32x16_bf16 v[112:127], v[52:55], v[60:63], v[112:127]
  ds_read_b64_tr_b16 v[48:49], v10 offset:12288
  ds_read_b64_tr_b16 v[50:51], v10 offset:14336
  ds_read_b64_tr_b16 v[52:53], v11 offset:12288
  ds_read_b64_tr_b16 v[54:55], v11 offset:14336
  ds_read_b128 v[56:59], v12 offset:3072
  ds_read_b128 v[60:63], v12 offset:7168
  s_waitcnt lgkmcnt(6)
  v_mfma_f32_32x32x16_bf16 v[64:79], v[32:35], v[40:43], v[64:79]
  v_mfma_f32_32x32x16_bf16 v[80:95], v[32:35], v[44:47], v[80:95]
  v_mfma_f32_32x32x16_bf16 v[96:111], v[36:39], v[40:43], v[96:111]
  v_mfma_f32_32x32x16_bf16 v[112:127], v[36:39], v[44:47], v[112:127]
  s_waitcnt lgkmcnt(0)
  v_mfma_f32_32x32x16_bf16 v[64:79], v[48:51], v[56:59], v[64:79]
  v_mfma_f32_32x32x16_bf16 v[80:95], v[48:51], v[60:63], v[80:95]
  v_mfma_f32_32x32x16_bf16 v[96:111], v[52:55], v[56:59], v[96:111]
  v_mfma_f32_32x32x16_bf16 v[112:127], v[52:55], v[60:63], v[112:127]
  s_lshl_b32 s29, s22, 21
  s_lshl_b32 s32, s23, 2
  s_lshl_b32 s33, s31, 1
  s_add_u32 s32, s32, s33
  s_lshl_b32 s32, s32, 15
  s_add_u32 s29, s29, s32
  s_lshl_b32 s32, s24, 2
  s_lshl_b32 s33, s30, 1
  s_add_u32 s32, s32, s33
  s_lshl_b32 s32, s32, 11
  s_add_u32 s29, s29, s32
  s_nop 7
  v_cvt_pk_bf16_f32 v64, v64, v65
  v_cvt_pk_bf16_f32 v65, v66, v67
  v_cvt_pk_bf16_f32 v66, v68, v69
  v_cvt_pk_bf16_f32 v67, v70, v71
  v_cvt_pk_bf16_f32 v68, v72, v73
  v_cvt_pk_bf16_f32 v69, v74, v75
  v_cvt_pk_bf16_f32 v70, v76, v77
  v_cvt_pk_bf16_f32 v71, v78, v79
  s_add_u32 s32, s29, 0
  buffer_store_dwordx4 v[64:67], v17, s[16:19], s32 offen offset:0 sc1
  buffer_store_dwordx4 v[68:71], v17, s[16:19], s32 offen offset:1024 sc1
  v_cvt_pk_bf16_f32 v80, v80, v81
  v_cvt_pk_bf16_f32 v81, v82, v83
  v_cvt_pk_bf16_f32 v82, v84, v85
  v_cvt_pk_bf16_f32 v83, v86, v87
  v_cvt_pk_bf16_f32 v84, v88, v89
  v_cvt_pk_bf16_f32 v85, v90, v91
  v_cvt_pk_bf16_f32 v86, v92, v93
  v_cvt_pk_bf16_f32 v87, v94, v95
  s_add_u32 s32, s29, 32768
  buffer_store_dwordx4 v[80:83], v17, s[16:19], s32 offen offset:0 sc1
  buffer_store_dwordx4 v[84:87], v17, s[16:19], s32 offen offset:1024 sc1
  v_cvt_pk_bf16_f32 v96, v96, v97
  v_cvt_pk_bf16_f32 v97, v98, v99
  v_cvt_pk_bf16_f32 v98, v100, v101
  v_cvt_pk_bf16_f32 v99, v102, v103
  v_cvt_pk_bf16_f32 v100, v104, v105
  v_cvt_pk_bf16_f32 v101, v106, v107
  v_cvt_pk_bf16_f32 v102, v108, v109
  v_cvt_pk_bf16_f32 v103, v110, v111
  s_add_u32 s32, s29, 2048
  buffer_store_dwordx4 v[96:99], v17, s[16:19], s32 offen offset:0 sc1
  buffer_store_dwordx4 v[100:103], v17, s[16:19], s32 offen offset:1024 sc1
  s_nop 7
  v_cvt_pk_bf16_f32 v112, v112, v113
  v_cvt_pk_bf16_f32 v113, v114, v115
  v_cvt_pk_bf16_f32 v114, v116, v117
  v_cvt_pk_bf16_f32 v115, v118, v119
  v_cvt_pk_bf16_f32 v116, v120, v121
  v_cvt_pk_bf16_f32 v117, v122, v123
  v_cvt_pk_bf16_f32 v118, v124, v125
  v_cvt_pk_bf16_f32 v119, v126, v127
  s_add_u32 s32, s29, 34816
  buffer_store_dwordx4 v[112:115], v17, s[16:19], s32 offen offset:0 sc1
  buffer_store_dwordx4 v[116:119], v17, s[16:19], s32 offen offset:1024 sc1
k3_kernel_end:
  s_endpgm
.globl k4_kernel
.p2align 8
.type k4_kernel,@function
k4_kernel:
  s_cmp_ge_u32 s2, 256
  s_cbranch_scc1 k4_kernel_end
  s_load_dwordx2 s[4:5], s[0:1], 0
  s_load_dwordx2 s[6:7], s[0:1], 104
  v_and_b32 v1, 63, v0
  v_lshrrev_b32 v2, 6, v0
  s_nop 0
  v_readfirstlane_b32 s3, v2
  s_waitcnt lgkmcnt(0)
  s_mov_b32 s8, s4
  s_and_b32 s9, s5, 0xffff
  s_mov_b32 s10, 2097152
  s_mov_b32 s11, 0x20000
  s_add_u32 s12, s6, 69206016
  s_addc_u32 s13, s7, 0
  s_and_b32 s13, s13, 0xffff
  s_mov_b32 s14, 16777216
  s_mov_b32 s15, 0x20000
  s_add_u32 s16, s6, 85983232
  s_addc_u32 s17, s7, 0
  s_and_b32 s17, s17, 0xffff
  s_mov_b32 s18, 2097152
  s_mov_b32 s19, 0x20000
  s_add_u32 s20, s6, 88080384
  s_addc_u32 s21, s7, 0
  s_and_b32 s21, s21, 0xffff
  s_mov_b32 s22, 2097152
  s_mov_b32 s23, 0x20000
  v_and_b32 v2, 7, v1
  v_lshrrev_b32 v3, 3, v1
  v_and_b32 v4, 3, v3
  v_lshrrev_b32 v5, 5, v1
  v_lshlrev_b32 v10, 9, v4
  v_lshl_add_u32 v10, v5, 11, v10
  v_lshl_add_u32 v10, v2, 4, v10
  s_and_b32 s24, s2, 3
  s_lshl_b32 s24, s24, 7
  v_add_u32 v10, s24, v10
  s_lshr_b32 s25, s2, 2
  s_lshl_b32 s25, s25, 15
  s_lshl_b32 s26, s3, 13
  s_add_u32 s25, s25, s26
  v_bfe_u32 v6, v1, 3, 1
  v_bfe_u32 v7, v1, 4, 1
  v_lshlrev_b32 v8, 3, v6
  v_lshl_add_u32 v8, v7, 5, v8
  v_lshl_add_u32 v8, v5, 6, v8
  v_lshl_add_u32 v11, v2, 10, v8
  s_lshl_b32 s27, s2, 13
  s_lshl_b32 s26, s3, 8
  s_add_u32 s27, s27, s26
  buffer_load_dwordx2 v[24:25], v11, s[8:11], s27 offen offset:0
  buffer_load_dwordx2 v[26:27], v11, s[8:11], s27 offen offset:16
  buffer_load_dwordx2 v[28:29], v11, s[8:11], s27 offen offset:128
  buffer_load_dwordx2 v[30:31], v11, s[8:11], s27 offen offset:144
  s_add_u32 s26, s25, 0
  buffer_load_dwordx4 v[96:99], v10, s[12:15], s26 offen
  s_add_u32 s28, s26, 4096
  buffer_load_dwordx4 v[100:103], v10, s[12:15], s28 offen
  s_add_u32 s26, s25, 2097152
  buffer_load_dwordx4 v[104:107], v10, s[12:15], s26 offen
  s_add_u32 s28, s26, 4096
  buffer_load_dwordx4 v[108:111], v10, s[12:15], s28 offen
  s_add_u32 s26, s25, 4194304
  buffer_load_dwordx4 v[112:115], v10, s[12:15], s26 offen
  s_add_u32 s28, s26, 4096
  buffer_load_dwordx4 v[116:119], v10, s[12:15], s28 offen
  s_add_u32 s26, s25, 6291456
  buffer_load_dwordx4 v[120:123], v10, s[12:15], s26 offen
  s_add_u32 s28, s26, 4096
  buffer_load_dwordx4 v[124:127], v10, s[12:15], s28 offen
  v_lshlrev_b32 v12, 2, v2
  s_lshl_b32 s26, s3, 5
  v_add_u32 v13, s26, v12
  s_waitcnt vmcnt(6)
  v_lshlrev_b32 v64, 16, v96
  v_and_b32 v65, 0xffff0000, v96
  v_lshlrev_b32 v66, 16, v97
  v_and_b32 v67, 0xffff0000, v97
  v_lshlrev_b32 v68, 16, v98
  v_and_b32 v69, 0xffff0000, v98
  v_lshlrev_b32 v70, 16, v99
  v_and_b32 v71, 0xffff0000, v99
  v_lshlrev_b32 v72, 16, v100
  v_and_b32 v73, 0xffff0000, v100
  v_lshlrev_b32 v74, 16, v101
  v_and_b32 v75, 0xffff0000, v101
  v_lshlrev_b32 v76, 16, v102
  v_and_b32 v77, 0xffff0000, v102
  v_lshlrev_b32 v78, 16, v103
  v_and_b32 v79, 0xffff0000, v103
  s_waitcnt vmcnt(4)
  v_lshlrev_b32 v80, 16, v104
  v_and_b32 v81, 0xffff0000, v104
  v_lshlrev_b32 v82, 16, v105
  v_and_b32 v83, 0xffff0000, v105
  v_lshlrev_b32 v84, 16, v106
  v_and_b32 v85, 0xffff0000, v106
  v_lshlrev_b32 v86, 16, v107
  v_and_b32 v87, 0xffff0000, v107
  v_lshlrev_b32 v88, 16, v108
  v_and_b32 v89, 0xffff0000, v108
  v_lshlrev_b32 v90, 16, v109
  v_and_b32 v91, 0xffff0000, v109
  v_lshlrev_b32 v92, 16, v110
  v_and_b32 v93, 0xffff0000, v110
  v_lshlrev_b32 v94, 16, v111
  v_and_b32 v95, 0xffff0000, v111
  v_add_f32 v64, v64, v80
  v_add_f32 v65, v65, v81
  v_add_f32 v66, v66, v82
  v_add_f32 v67, v67, v83
  v_add_f32 v68, v68, v84
  v_add_f32 v69, v69, v85
  v_add_f32 v70, v70, v86
  v_add_f32 v71, v71, v87
  v_add_f32 v72, v72, v88
  v_add_f32 v73, v73, v89
  v_add_f32 v74, v74, v90
  v_add_f32 v75, v75, v91
  v_add_f32 v76, v76, v92
  v_add_f32 v77, v77, v93
  v_add_f32 v78, v78, v94
  v_add_f32 v79, v79, v95
  s_waitcnt vmcnt(2)
  v_lshlrev_b32 v80, 16, v112
  v_and_b32 v81, 0xffff0000, v112
  v_lshlrev_b32 v82, 16, v113
  v_and_b32 v83, 0xffff0000, v113
  v_lshlrev_b32 v84, 16, v114
  v_and_b32 v85, 0xffff0000, v114
  v_lshlrev_b32 v86, 16, v115
  v_and_b32 v87, 0xffff0000, v115
  v_lshlrev_b32 v88, 16, v116
  v_and_b32 v89, 0xffff0000, v116
  v_lshlrev_b32 v90, 16, v117
  v_and_b32 v91, 0xffff0000, v117
  v_lshlrev_b32 v92, 16, v118
  v_and_b32 v93, 0xffff0000, v118
  v_lshlrev_b32 v94, 16, v119
  v_and_b32 v95, 0xffff0000, v119
  v_add_f32 v64, v64, v80
  v_add_f32 v65, v65, v81
  v_add_f32 v66, v66, v82
  v_add_f32 v67, v67, v83
  v_add_f32 v68, v68, v84
  v_add_f32 v69, v69, v85
  v_add_f32 v70, v70, v86
  v_add_f32 v71, v71, v87
  v_add_f32 v72, v72, v88
  v_add_f32 v73, v73, v89
  v_add_f32 v74, v74, v90
  v_add_f32 v75, v75, v91
  v_add_f32 v76, v76, v92
  v_add_f32 v77, v77, v93
  v_add_f32 v78, v78, v94
  v_add_f32 v79, v79, v95
  s_waitcnt vmcnt(0)
  v_lshlrev_b32 v80, 16, v120
  v_and_b32 v81, 0xffff0000, v120
  v_lshlrev_b32 v82, 16, v121
  v_and_b32 v83, 0xffff0000, v121
  v_lshlrev_b32 v84, 16, v122
  v_and_b32 v85, 0xffff0000, v122
  v_lshlrev_b32 v86, 16, v123
  v_and_b32 v87, 0xffff0000, v123
  v_lshlrev_b32 v88, 16, v124
  v_and_b32 v89, 0xffff0000, v124
  v_lshlrev_b32 v90, 16, v125
  v_and_b32 v91, 0xffff0000, v125
  v_lshlrev_b32 v92, 16, v126
  v_and_b32 v93, 0xffff0000, v126
  v_lshlrev_b32 v94, 16, v127
  v_and_b32 v95, 0xffff0000, v127
  v_add_f32 v64, v64, v80
  v_add_f32 v65, v65, v81
  v_add_f32 v66, v66, v82
  v_add_f32 v67, v67, v83
  v_add_f32 v68, v68, v84
  v_add_f32 v69, v69, v85
  v_add_f32 v70, v70, v86
  v_add_f32 v71, v71, v87
  v_add_f32 v72, v72, v88
  v_add_f32 v73, v73, v89
  v_add_f32 v74, v74, v90
  v_add_f32 v75, v75, v91
  v_add_f32 v76, v76, v92
  v_add_f32 v77, v77, v93
  v_add_f32 v78, v78, v94
  v_add_f32 v79, v79, v95
  v_cvt_pk_bf16_f32 v48, v64, v65
  v_cvt_pk_bf16_f32 v49, v66, v67
  v_cvt_pk_bf16_f32 v50, v68, v69
  v_cvt_pk_bf16_f32 v51, v70, v71
  v_cvt_pk_bf16_f32 v52, v72, v73
  v_cvt_pk_bf16_f32 v53, v74, v75
  v_cvt_pk_bf16_f32 v54, v76, v77
  v_cvt_pk_bf16_f32 v55, v78, v79
  v_lshlrev_b32 v64, 16, v48
  v_and_b32 v65, 0xffff0000, v48
  v_lshlrev_b32 v66, 16, v49
  v_and_b32 v67, 0xffff0000, v49
  v_lshlrev_b32 v68, 16, v50
  v_and_b32 v69, 0xffff0000, v50
  v_lshlrev_b32 v70, 16, v51
  v_and_b32 v71, 0xffff0000, v51
  v_lshlrev_b32 v72, 16, v52
  v_and_b32 v73, 0xffff0000, v52
  v_lshlrev_b32 v74, 16, v53
  v_and_b32 v75, 0xffff0000, v53
  v_lshlrev_b32 v76, 16, v54
  v_and_b32 v77, 0xffff0000, v54
  v_lshlrev_b32 v78, 16, v55
  v_and_b32 v79, 0xffff0000, v55
  v_lshlrev_b32 v80, 16, v24
  v_and_b32 v81, 0xffff0000, v24
  v_lshlrev_b32 v82, 16, v25
  v_and_b32 v83, 0xffff0000, v25
  v_lshlrev_b32 v84, 16, v26
  v_and_b32 v85, 0xffff0000, v26
  v_lshlrev_b32 v86, 16, v27
  v_and_b32 v87, 0xffff0000, v27
  v_lshlrev_b32 v88, 16, v28
  v_and_b32 v89, 0xffff0000, v28
  v_lshlrev_b32 v90, 16, v29
  v_and_b32 v91, 0xffff0000, v29
  v_lshlrev_b32 v92, 16, v30
  v_and_b32 v93, 0xffff0000, v30
  v_lshlrev_b32 v94, 16, v31
  v_and_b32 v95, 0xffff0000, v31
  v_add_f32 v64, v64, v80
  v_add_f32 v65, v65, v81
  v_add_f32 v66, v66, v82
  v_add_f32 v67, v67, v83
  v_add_f32 v68, v68, v84
  v_add_f32 v69, v69, v85
  v_add_f32 v70, v70, v86
  v_add_f32 v71, v71, v87
  v_add_f32 v72, v72, v88
  v_add_f32 v73, v73, v89
  v_add_f32 v74, v74, v90
  v_add_f32 v75, v75, v91
  v_add_f32 v76, v76, v92
  v_add_f32 v77, v77, v93
  v_add_f32 v78, v78, v94
  v_add_f32 v79, v79, v95
  v_cvt_pk_bf16_f32 v48, v64, v65
  v_cvt_pk_bf16_f32 v49, v66, v67
  v_cvt_pk_bf16_f32 v50, v68, v69
  v_cvt_pk_bf16_f32 v51, v70, v71
  v_cvt_pk_bf16_f32 v52, v72, v73
  v_cvt_pk_bf16_f32 v53, v74, v75
  v_cvt_pk_bf16_f32 v54, v76, v77
  v_cvt_pk_bf16_f32 v55, v78, v79
  buffer_store_dwordx2 v[48:49], v11, s[16:19], s27 offen offset:0 sc1
  buffer_store_dwordx2 v[50:51], v11, s[16:19], s27 offen offset:16 sc1
  buffer_store_dwordx2 v[52:53], v11, s[16:19], s27 offen offset:128 sc1
  buffer_store_dwordx2 v[54:55], v11, s[16:19], s27 offen offset:144 sc1
  v_lshlrev_b32 v32, 16, v48
  v_and_b32 v33, 0xffff0000, v48
  v_lshlrev_b32 v34, 16, v49
  v_and_b32 v35, 0xffff0000, v49
  v_lshlrev_b32 v36, 16, v50
  v_and_b32 v37, 0xffff0000, v50
  v_lshlrev_b32 v38, 16, v51
  v_and_b32 v39, 0xffff0000, v51
  v_lshlrev_b32 v40, 16, v52
  v_and_b32 v41, 0xffff0000, v52
  v_lshlrev_b32 v42, 16, v53
  v_and_b32 v43, 0xffff0000, v53
  v_lshlrev_b32 v44, 16, v54
  v_and_b32 v45, 0xffff0000, v54
  v_lshlrev_b32 v46, 16, v55
  v_and_b32 v47, 0xffff0000, v55
  v_mov_b32 v14, v32
  v_add_f32 v14, v14, v33
  v_add_f32 v14, v14, v34
  v_add_f32 v14, v14, v35
  v_add_f32 v14, v14, v36
  v_add_f32 v14, v14, v37
  v_add_f32 v14, v14, v38
  v_add_f32 v14, v14, v39
  v_add_f32 v14, v14, v40
  v_add_f32 v14, v14, v41
  v_add_f32 v14, v14, v42
  v_add_f32 v14, v14, v43
  v_add_f32 v14, v14, v44
  v_add_f32 v14, v14, v45
  v_add_f32 v14, v14, v46
  v_add_f32 v14, v14, v47
  s_nop 1
  v_add_f32_dpp v14, v14, v14 row_ror:8 row_mask:0xf bank_mask:0xf
  v_mov_b32 v15, v14
  s_nop 1
  v_permlane16_swap_b32 v15, v14
  v_add_f32 v14, v14, v15
  v_mov_b32 v15, v14
  s_nop 1
  v_permlane32_swap_b32 v15, v14
  v_add_f32 v14, v14, v15
  ds_write_b32 v13, v14 offset:8192
  s_waitcnt lgkmcnt(0)
  s_barrier
  ds_read_b32 v16, v12 offset:8192
  ds_read_b32 v17, v12 offset:8224
  ds_read_b32 v18, v12 offset:8256
  ds_read_b32 v19, v12 offset:8288
  s_waitcnt lgkmcnt(0)
  v_add_f32 v16, v16, v17
  v_add_f32 v18, v18, v19
  v_add_f32 v14, v16, v18
  v_mul_f32 v14, 0x3b000000, v14
  v_sub_f32 v32, v32, v14
  v_sub_f32 v33, v33, v14
  v_sub_f32 v34, v34, v14
  v_sub_f32 v35, v35, v14
  v_sub_f32 v36, v36, v14
  v_sub_f32 v37, v37, v14
  v_sub_f32 v38, v38, v14
  v_sub_f32 v39, v39, v14
  v_sub_f32 v40, v40, v14
  v_sub_f32 v41, v41, v14
  v_sub_f32 v42, v42, v14
  v_sub_f32 v43, v43, v14
  v_sub_f32 v44, v44, v14
  v_sub_f32 v45, v45, v14
  v_sub_f32 v46, v46, v14
  v_sub_f32 v47, v47, v14
  v_mul_f32 v14, v32, v32
  v_fmac_f32 v14, v33, v33
  v_fmac_f32 v14, v34, v34
  v_fmac_f32 v14, v35, v35
  v_fmac_f32 v14, v36, v36
  v_fmac_f32 v14, v37, v37
  v_fmac_f32 v14, v38, v38
  v_fmac_f32 v14, v39, v39
  v_fmac_f32 v14, v40, v40
  v_fmac_f32 v14, v41, v41
  v_fmac_f32 v14, v42, v42
  v_fmac_f32 v14, v43, v43
  v_fmac_f32 v14, v44, v44
  v_fmac_f32 v14, v45, v45
  v_fmac_f32 v14, v46, v46
  v_fmac_f32 v14, v47, v47
  s_nop 1
  v_add_f32_dpp v14, v14, v14 row_ror:8 row_mask:0xf bank_mask:0xf
  v_mov_b32 v15, v14
  s_nop 1
  v_permlane16_swap_b32 v15, v14
  v_add_f32 v14, v14, v15
  v_mov_b32 v15, v14
  s_nop 1
  v_permlane32_swap_b32 v15, v14
  v_add_f32 v14, v14, v15
  ds_write_b32 v13, v14 offset:8448
  s_waitcnt lgkmcnt(0)
  s_barrier
  ds_read_b32 v16, v12 offset:8448
  ds_read_b32 v17, v12 offset:8480
  ds_read_b32 v18, v12 offset:8512
  ds_read_b32 v19, v12 offset:8544
  s_waitcnt lgkmcnt(0)
  v_add_f32 v16, v16, v17
  v_add_f32 v18, v18, v19
  v_add_f32 v14, v16, v18
  v_mov_b32 v24, 0x3727c5ac
  v_fmac_f32 v24, 0x3b000000, v14
  v_rsq_f32 v24, v24
  s_nop 0
  v_mul_f32 v32, v32, v24
  v_mul_f32 v33, v33, v24
  v_mul_f32 v34, v34, v24
  v_mul_f32 v35, v35, v24
  v_mul_f32 v36, v36, v24
  v_mul_f32 v37, v37, v24
  v_mul_f32 v38, v38, v24
  v_mul_f32 v39, v39, v24
  v_mul_f32 v40, v40, v24
  v_mul_f32 v41, v41, v24
  v_mul_f32 v42, v42, v24
  v_mul_f32 v43, v43, v24
  v_mul_f32 v44, v44, v24
  v_mul_f32 v45, v45, v24
  v_mul_f32 v46, v46, v24
  v_mul_f32 v47, v47, v24
  v_cvt_pk_bf16_f32 v48, v32, v33
  v_cvt_pk_bf16_f32 v49, v34, v35
  v_cvt_pk_bf16_f32 v50, v36, v37
  v_cvt_pk_bf16_f32 v51, v38, v39
  v_cvt_pk_bf16_f32 v52, v40, v41
  v_cvt_pk_bf16_f32 v53, v42, v43
  v_cvt_pk_bf16_f32 v54, v44, v45
  v_cvt_pk_bf16_f32 v55, v46, v47
  v_lshlrev_b32 v32, 16, v48
  v_and_b32 v33, 0xffff0000, v48
  v_lshlrev_b32 v34, 16, v49
  v_and_b32 v35, 0xffff0000, v49
  v_lshlrev_b32 v36, 16, v50
  v_and_b32 v37, 0xffff0000, v50
  v_lshlrev_b32 v38, 16, v51
  v_and_b32 v39, 0xffff0000, v51
  v_lshlrev_b32 v40, 16, v52
  v_and_b32 v41, 0xffff0000, v52
  v_lshlrev_b32 v42, 16, v53
  v_and_b32 v43, 0xffff0000, v53
  v_lshlrev_b32 v44, 16, v54
  v_and_b32 v45, 0xffff0000, v54
  v_lshlrev_b32 v46, 16, v55
  v_and_b32 v47, 0xffff0000, v55
  v_mov_b32 v14, v32
  v_add_f32 v14, v14, v33
  v_add_f32 v14, v14, v34
  v_add_f32 v14, v14, v35
  v_add_f32 v14, v14, v36
  v_add_f32 v14, v14, v37
  v_add_f32 v14, v14, v38
  v_add_f32 v14, v14, v39
  v_add_f32 v14, v14, v40
  v_add_f32 v14, v14, v41
  v_add_f32 v14, v14, v42
  v_add_f32 v14, v14, v43
  v_add_f32 v14, v14, v44
  v_add_f32 v14, v14, v45
  v_add_f32 v14, v14, v46
  v_add_f32 v14, v14, v47
  s_nop 1
  v_add_f32_dpp v14, v14, v14 row_ror:8 row_mask:0xf bank_mask:0xf
  v_mov_b32 v15, v14
  s_nop 1
  v_permlane16_swap_b32 v15, v14
  v_add_f32 v14, v14, v15
  v_mov_b32 v15, v14
  s_nop 1
  v_permlane32_swap_b32 v15, v14
  v_add_f32 v14, v14, v15
  ds_write_b32 v13, v14 offset:8704
  s_waitcnt lgkmcnt(0)
  s_barrier
  ds_read_b32 v16, v12 offset:8704
  ds_read_b32 v17, v12 offset:8736
  ds_read_b32 v18, v12 offset:8768
  ds_read_b32 v19, v12 offset:8800
  s_waitcnt lgkmcnt(0)
  v_add_f32 v16, v16, v17
  v_add_f32 v18, v18, v19
  v_add_f32 v14, v16, v18
  v_mul_f32 v14, 0x3b000000, v14
  v_sub_f32 v32, v32, v14
  v_sub_f32 v33, v33, v14
  v_sub_f32 v34, v34, v14
  v_sub_f32 v35, v35, v14
  v_sub_f32 v36, v36, v14
  v_sub_f32 v37, v37, v14
  v_sub_f32 v38, v38, v14
  v_sub_f32 v39, v39, v14
  v_sub_f32 v40, v40, v14
  v_sub_f32 v41, v41, v14
  v_sub_f32 v42, v42, v14
  v_sub_f32 v43, v43, v14
  v_sub_f32 v44, v44, v14
  v_sub_f32 v45, v45, v14
  v_sub_f32 v46, v46, v14
  v_sub_f32 v47, v47, v14
  v_mul_f32 v14, v32, v32
  v_fmac_f32 v14, v33, v33
  v_fmac_f32 v14, v34, v34
  v_fmac_f32 v14, v35, v35
  v_fmac_f32 v14, v36, v36
  v_fmac_f32 v14, v37, v37
  v_fmac_f32 v14, v38, v38
  v_fmac_f32 v14, v39, v39
  v_fmac_f32 v14, v40, v40
  v_fmac_f32 v14, v41, v41
  v_fmac_f32 v14, v42, v42
  v_fmac_f32 v14, v43, v43
  v_fmac_f32 v14, v44, v44
  v_fmac_f32 v14, v45, v45
  v_fmac_f32 v14, v46, v46
  v_fmac_f32 v14, v47, v47
  s_nop 1
  v_add_f32_dpp v14, v14, v14 row_ror:8 row_mask:0xf bank_mask:0xf
  v_mov_b32 v15, v14
  s_nop 1
  v_permlane16_swap_b32 v15, v14
  v_add_f32 v14, v14, v15
  v_mov_b32 v15, v14
  s_nop 1
  v_permlane32_swap_b32 v15, v14
  v_add_f32 v14, v14, v15
  ds_write_b32 v13, v14 offset:8960
  s_waitcnt lgkmcnt(0)
  s_barrier
  ds_read_b32 v16, v12 offset:8960
  ds_read_b32 v17, v12 offset:8992
  ds_read_b32 v18, v12 offset:9024
  ds_read_b32 v19, v12 offset:9056
  s_waitcnt lgkmcnt(0)
  v_add_f32 v16, v16, v17
  v_add_f32 v18, v18, v19
  v_add_f32 v14, v16, v18
  v_mov_b32 v24, 0x3727c5ac
  v_fmac_f32 v24, 0x3b000000, v14
  v_rsq_f32 v24, v24
  s_nop 0
  v_mul_f32 v32, v32, v24
  v_mul_f32 v33, v33, v24
  v_mul_f32 v34, v34, v24
  v_mul_f32 v35, v35, v24
  v_mul_f32 v36, v36, v24
  v_mul_f32 v37, v37, v24
  v_mul_f32 v38, v38, v24
  v_mul_f32 v39, v39, v24
  v_mul_f32 v40, v40, v24
  v_mul_f32 v41, v41, v24
  v_mul_f32 v42, v42, v24
  v_mul_f32 v43, v43, v24
  v_mul_f32 v44, v44, v24
  v_mul_f32 v45, v45, v24
  v_mul_f32 v46, v46, v24
  v_mul_f32 v47, v47, v24
  v_cvt_pk_bf16_f32 v48, v32, v33
  v_cvt_pk_bf16_f32 v49, v34, v35
  v_cvt_pk_bf16_f32 v50, v36, v37
  v_cvt_pk_bf16_f32 v51, v38, v39
  v_cvt_pk_bf16_f32 v52, v40, v41
  v_cvt_pk_bf16_f32 v53, v42, v43
  v_cvt_pk_bf16_f32 v54, v44, v45
  v_cvt_pk_bf16_f32 v55, v46, v47
  v_lshlrev_b32 v14, 3, v8
  v_lshl_add_u32 v14, v2, 1, v14
  s_lshl_b32 s26, s3, 11
  v_add_u32 v14, s26, v14
  ds_write_b16 v14, v48 offset:0
  ds_write_b16_d16_hi v14, v48 offset:16
  ds_write_b16 v14, v49 offset:32
  ds_write_b16_d16_hi v14, v49 offset:48
  ds_write_b16 v14, v50 offset:128
  ds_write_b16_d16_hi v14, v50 offset:144
  ds_write_b16 v14, v51 offset:160
  ds_write_b16_d16_hi v14, v51 offset:176
  ds_write_b16 v14, v52 offset:1024
  ds_write_b16_d16_hi v14, v52 offset:1040
  ds_write_b16 v14, v53 offset:1056
  ds_write_b16_d16_hi v14, v53 offset:1072
  ds_write_b16 v14, v54 offset:1152
  ds_write_b16_d16_hi v14, v54 offset:1168
  ds_write_b16 v14, v55 offset:1184
  ds_write_b16_d16_hi v14, v55 offset:1200
  v_lshlrev_b32 v14, 4, v0
  v_lshrrev_b32 v15, 5, v0
  v_lshlrev_b32 v15, 17, v15
  v_and_b32 v16, 31, v0
  v_lshl_add_u32 v15, v16, 4, v15
  s_lshl_b32 s26, s2, 9
  s_add_u32 s28, s26, 0x100000
  s_waitcnt lgkmcnt(0)
  s_barrier
  ds_read_b128 v[56:59], v14
  ds_read_b128 v[60:63], v14 offset:4096
  s_waitcnt lgkmcnt(1)
  buffer_store_dwordx4 v[56:59], v15, s[20:23], s26 offen sc1
  s_waitcnt lgkmcnt(0)
  buffer_store_dwordx4 v[60:63], v15, s[20:23], s28 offen sc1
k4_kernel_end:
  s_endpgm
.globl k5_kernel
.p2align 8
.type k5_kernel,@function
k5_kernel:
  s_cmp_ge_u32 s2, 256
  s_cbranch_scc1 k5_kernel_end
  s_load_dwordx2 s[4:5], s[0:1], 56
  s_load_dwordx2 s[6:7], s[0:1], 104
  s_load_dwordx2 s[8:9], s[0:1], 64
  v_and_b32 v1, 63, v0
  v_lshrrev_b32 v2, 6, v0
  s_nop 0
  v_readfirstlane_b32 s3, v2
  s_waitcnt lgkmcnt(0)
  s_and_b32 s30, s2, 7
  s_lshr_b32 s31, s2, 3
  s_lshr_b32 s34, s31, 2
  s_cmp_ge_u32 s34, 7
  s_cbranch_scc1 k5_kernel_end
  s_lshr_b32 s32, s30, 1
  s_mul_i32 s32, s32, 7
  s_add_u32 s32, s32, s34
  s_and_b32 s33, s30, 1
  s_lshl_b32 s33, s33, 2
  s_and_b32 s31, s31, 3
  s_add_u32 s33, s33, s31
  s_mov_b32 s12, s4
  s_and_b32 s13, s5, 0xffff
  s_mov_b32 s14, 7340032
  s_mov_b32 s15, 0x20000
  s_add_u32 s16, s6, 88080384
  s_addc_u32 s17, s7, 0
  s_and_b32 s17, s17, 0xffff
  s_mov_b32 s18, 2097152
  s_mov_b32 s19, 0x20000
  s_add_u32 s20, s6, 90177536
  s_addc_u32 s21, s7, 0
  s_and_b32 s21, s21, 0xffff
  s_mov_b32 s22, 1835008
  s_mov_b32 s23, 0x20000
  s_mov_b32 s24, s8
  s_and_b32 s25, s9, 0xffff
  s_mov_b32 s26, 3584
  s_mov_b32 s27, 0x20000
  v_lshrrev_b32 v20, 3, v1
  s_movk_i32 s34, 3584
  v_mul_lo_u32 v20, v20, s34
  v_bfe_u32 v21, v1, 2, 1
  v_bfe_u32 v22, v1, 4, 1
  v_xor_b32 v21, v21, v22
  v_lshl_add_u32 v20, v21, 6, v20
  v_and_b32 v22, 3, v1
  v_lshl_add_u32 v16, v22, 4, v20
  v_lshlrev_b32 v17, 4, v1
  s_mul_i32 s40, s3, 917504
  s_lshl_b32 s34, s32, 7
  s_add_u32 s40, s40, s34
  s_lshl_b32 s41, s3, 14
  s_mul_i32 s42, s33, 262144
  s_mul_i32 s34, s3, 16384
  s_add_u32 s42, s42, s34
  s_add_u32 s43, s42, 131072
  s_lshr_b32 s44, s3, 2
  s_bfe_u32 s45, s3, 0x10001
  s_and_b32 s46, s3, 1
  v_lshrrev_b32 v18, 5, v1
  v_and_b32 v19, 31, v1
  s_lshl_b32 s34, s32, 7
  s_lshl_b32 s35, s44, 6
  s_add_u32 s34, s34, s35
  s_lshl_b32 s35, s46, 5
  s_add_u32 s34, s34, s35
  v_lshlrev_b32 v20, 3, v18
  buffer_load_dwordx2 v[24:25], v20, s[24:27], s34 offen
  buffer_load_dwordx2 v[26:27], v20, s[24:27], s34 offen offset:16
  s_add_u32 m0, s41, 0
  s_add_u32 s34, s40, 0
  buffer_load_dwordx4 v16, s[12:15], s34 offen lds
  s_add_u32 m0, s41, 1024
  s_add_u32 s34, s40, 28672
  buffer_load_dwordx4 v16, s[12:15], s34 offen lds
  s_add_u32 m0, s41, 2048
  s_add_u32 s34, s40, 57344
  buffer_load_dwordx4 v16, s[12:15], s34 offen lds
  s_add_u32 m0, s41, 3072
  s_add_u32 s34, s40, 86016
  buffer_load_dwordx4 v16, s[12:15], s34 offen lds
  s_add_u32 s34, s42, 0
  buffer_load_dwordx4 v[128:131], v17, s[16:19], s34 offen offset:0
  s_add_u32 s34, s43, 0
  buffer_load_dwordx4 v[132:135], v17, s[16:19], s34 offen offset:0
  s_add_u32 s34, s42, 0
  buffer_load_dwordx4 v[136:139], v17, s[16:19], s34 offen offset:1024
  s_add_u32 s34, s43, 0
  buffer_load_dwordx4 v[140:143], v17, s[16:19], s34 offen offset:1024
  s_add_u32 m0, s41, 4096
  s_add_u32 s34, s40, 114688
  buffer_load_dwordx4 v16, s[12:15], s34 offen lds
  s_add_u32 m0, s41, 5120
  s_add_u32 s34, s40, 143360
  buffer_load_dwordx4 v16, s[12:15], s34 offen lds
  s_add_u32 m0, s41, 6144
  s_add_u32 s34, s40, 172032
  buffer_load_dwordx4 v16, s[12:15], s34 offen lds
  s_add_u32 m0, s41, 7168
  s_add_u32 s34, s40, 200704
  buffer_load_dwordx4 v16, s[12:15], s34 offen lds
  s_add_u32 s34, s42, 0
  buffer_load_dwordx4 v[144:147], v17, s[16:19], s34 offen offset:2048
  s_add_u32 s34, s43, 0
  buffer_load_dwordx4 v[148:151], v17, s[16:19], s34 offen offset:2048
  s_add_u32 s34, s42, 0
  buffer_load_dwordx4 v[152:155], v17, s[16:19], s34 offen offset:3072
  s_add_u32 s34, s43, 0
  buffer_load_dwordx4 v[156:159], v17, s[16:19], s34 offen offset:3072
  s_add_u32 m0, s41, 8192
  s_add_u32 s34, s40, 229376
  buffer_load_dwordx4 v16, s[12:15], s34 offen lds
  s_add_u32 m0, s41, 9216
  s_add_u32 s34, s40, 258048
  buffer_load_dwordx4 v16, s[12:15], s34 offen lds
  s_add_u32 m0, s41, 10240
  s_add_u32 s34, s40, 286720
  buffer_load_dwordx4 v16, s[12:15], s34 offen lds
  s_add_u32 m0, s41, 11264
  s_add_u32 s34, s40, 315392
  buffer_load_dwordx4 v16, s[12:15], s34 offen lds
  s_add_u32 s34, s42, 4096
  buffer_load_dwordx4 v[160:163], v17, s[16:19], s34 offen offset:0
  s_add_u32 s34, s43, 4096
  buffer_load_dwordx4 v[164:167], v17, s[16:19], s34 offen offset:0
  s_add_u32 s34, s42, 4096
  buffer_load_dwordx4 v[168:171], v17, s[16:19], s34 offen offset:1024
  s_add_u32 s34, s43, 4096
  buffer_load_dwordx4 v[172:175], v17, s[16:19], s34 offen offset:1024
  s_add_u32 m0, s41, 12288
  s_add_u32 s34, s40, 344064
  buffer_load_dwordx4 v16, s[12:15], s34 offen lds
  s_add_u32 m0, s41, 13312
  s_add_u32 s34, s40, 372736
  buffer_load_dwordx4 v16, s[12:15], s34 offen lds
  s_add_u32 m0, s41, 14336
  s_add_u32 s34, s40, 401408
  buffer_load_dwordx4 v16, s[12:15], s34 offen lds
  s_add_u32 m0, s41, 15360
  s_add_u32 s34, s40, 430080
  buffer_load_dwordx4 v16, s[12:15], s34 offen lds
  s_add_u32 s34, s42, 4096
  buffer_load_dwordx4 v[176:179], v17, s[16:19], s34 offen offset:2048
  s_add_u32 s34, s43, 4096
  buffer_load_dwordx4 v[180:183], v17, s[16:19], s34 offen offset:2048
  s_add_u32 s34, s42, 4096
  buffer_load_dwordx4 v[184:187], v17, s[16:19], s34 offen offset:3072
  s_add_u32 s34, s43, 4096
  buffer_load_dwordx4 v[188:191], v17, s[16:19], s34 offen offset:3072
  s_add_u32 s34, s42, 8192
  buffer_load_dwordx4 v[192:195], v17, s[16:19], s34 offen offset:0
  s_add_u32 s34, s43, 8192
  buffer_load_dwordx4 v[196:199], v17, s[16:19], s34 offen offset:0
  s_add_u32 s34, s42, 8192
  buffer_load_dwordx4 v[200:203], v17, s[16:19], s34 offen offset:1024
  s_add_u32 s34, s43, 8192
  buffer_load_dwordx4 v[204:207], v17, s[16:19], s34 offen offset:1024
  s_add_u32 s34, s42, 8192
  buffer_load_dwordx4 v[208:211], v17, s[16:19], s34 offen offset:2048
  s_add_u32 s34, s43, 8192
  buffer_load_dwordx4 v[212:215], v17, s[16:19], s34 offen offset:2048
  s_add_u32 s34, s42, 8192
  buffer_load_dwordx4 v[216:219], v17, s[16:19], s34 offen offset:3072
  s_add_u32 s34, s43, 8192
  buffer_load_dwordx4 v[220:223], v17, s[16:19], s34 offen offset:3072
  s_add_u32 s34, s42, 12288
  buffer_load_dwordx4 v[224:227], v17, s[16:19], s34 offen offset:0
  s_add_u32 s34, s43, 12288
  buffer_load_dwordx4 v[228:231], v17, s[16:19], s34 offen offset:0
  s_add_u32 s34, s42, 12288
  buffer_load_dwordx4 v[232:235], v17, s[16:19], s34 offen offset:1024
  s_add_u32 s34, s43, 12288
  buffer_load_dwordx4 v[236:239], v17, s[16:19], s34 offen offset:1024
  s_add_u32 s34, s42, 12288
  buffer_load_dwordx4 v[240:243], v17, s[16:19], s34 offen offset:2048
  s_add_u32 s34, s43, 12288
  buffer_load_dwordx4 v[244:247], v17, s[16:19], s34 offen offset:2048
  s_add_u32 s34, s42, 12288
  buffer_load_dwordx4 v[248:251], v17, s[16:19], s34 offen offset:3072
  s_add_u32 s34, s43, 12288
  buffer_load_dwordx4 v[252:255], v17, s[16:19], s34 offen offset:3072
  v_bfe_u32 v20, v1, 2, 2
  v_lshl_add_u32 v21, v18, 3, v20
  v_lshlrev_b32 v21, 7, v21
  v_and_b32 v22, 16, v1
  v_lshl_add_u32 v21, v22, 1, v21
  v_and_b32 v22, 3, v1
  v_lshl_add_u32 v21, v22, 3, v21
  v_add_u32 v21, s41, v21
  v_lshrrev_b32 v20, 1, v20
  v_lshl_add_u32 v10, v20, 6, v21
  v_xor_b32 v20, 1, v20
  v_lshl_add_u32 v11, v20, 6, v21
  s_waitcnt vmcnt(40)
  ds_read_b64_tr_b16 v[32:33], v10 offset:0
  ds_read_b64_tr_b16 v[34:35], v10 offset:512
  ds_read_b64_tr_b16 v[36:37], v11 offset:0
  ds_read_b64_tr_b16 v[38:39], v11 offset:512
  ds_read_b64_tr_b16 v[40:41], v10 offset:2048
  ds_read_b64_tr_b16 v[42:43], v10 offset:2560
  ds_read_b64_tr_b16 v[44:45], v11 offset:2048
  ds_read_b64_tr_b16 v[46:47], v11 offset:2560
  s_waitcnt lgkmcnt(4)
  v_mfma_f32_32x32x16_bf16 v[64:79], v[32:35], v[128:131], 0
  v_mfma_f32_32x32x16_bf16 v[80:95], v[32:35], v[132:135], 0
  v_mfma_f32_32x32x16_bf16 v[96:111], v[36:39], v[128:131], 0
  v_mfma_f32_32x32x16_bf16 v[112:127], v[36:39], v[132:135], 0
  s_waitcnt lgkmcnt(0)
  s_add_u32 m0, s41, 0
  s_add_u32 s34, s40, 458752
  buffer_load_dwordx4 v16, s[12:15], s34 offen lds
  s_add_u32 m0, s41, 1024
  s_add_u32 s34, s40, 487424
  buffer_load_dwordx4 v16, s[12:15], s34 offen lds
  s_add_u32 m0, s41, 2048
  s_add_u32 s34, s40, 516096
  buffer_load_dwordx4 v16, s[12:15], s34 offen lds
  s_add_u32 m0, s41, 3072
  s_add_u32 s34, s40, 544768
  buffer_load_dwordx4 v16, s[12:15], s34 offen lds
  v_mfma_f32_32x32x16_bf16 v[64:79], v[40:43], v[136:139], v[64:79]
  v_mfma_f32_32x32x16_bf16 v[80:95], v[40:43], v[140:143], v[80:95]
  v_mfma_f32_32x32x16_bf16 v[96:111], v[44:47], v[136:139], v[96:111]
  v_mfma_f32_32x32x16_bf16 v[112:127], v[44:47], v[140:143], v[112:127]
  s_waitcnt vmcnt(36)
  ds_read_b64_tr_b16 v[48:49], v10 offset:4096
  ds_read_b64_tr_b16 v[50:51], v10 offset:4608
  ds_read_b64_tr_b16 v[52:53], v11 offset:4096
  ds_read_b64_tr_b16 v[54:55], v11 offset:4608
  ds_read_b64_tr_b16 v[56:57], v10 offset:6144
  ds_read_b64_tr_b16 v[58:59], v10 offset:6656
  ds_read_b64_tr_b16 v[60:61], v11 offset:6144
  ds_read_b64_tr_b16 v[62:63], v11 offset:6656
  s_waitcnt lgkmcnt(4)
  v_mfma_f32_32x32x16_bf16 v[64:79], v[48:51], v[144:147], v[64:79]
  v_mfma_f32_32x32x16_bf16 v[80:95], v[48:51], v[148:151], v[80:95]
  v_mfma_f32_32x32x16_bf16 v[96:111], v[52:55], v[144:147], v[96:111]
  v_mfma_f32_32x32x16_bf16 v[112:127], v[52:55], v[148:151], v[112:127]
  s_waitcnt lgkmcnt(0)
  s_add_u32 m0, s41, 4096
  s_add_u32 s34, s40, 573440
  buffer_load_dwordx4 v16, s[12:15], s34 offen lds
  s_add_u32 m0, s41, 5120
  s_add_u32 s34, s40, 602112
  buffer_load_dwordx4 v16, s[12:15], s34 offen lds
  s_add_u32 m0, s41, 6144
  s_add_u32 s34, s40, 630784
  buffer_load_dwordx4 v16, s[12:15], s34 offen lds
  s_add_u32 m0, s41, 7168
  s_add_u32 s34, s40, 659456
  buffer_load_dwordx4 v16, s[12:15], s34 offen lds
  v_mfma_f32_32x32x16_bf16 v[64:79], v[56:59], v[152:155], v[64:79]
  v_mfma_f32_32x32x16_bf16 v[80:95], v[56:59], v[156:159], v[80:95]
  v_mfma_f32_32x32x16_bf16 v[96:111], v[60:63], v[152:155], v[96:111]
  v_mfma_f32_32x32x16_bf16 v[112:127], v[60:63], v[156:159], v[112:127]
  s_waitcnt vmcnt(32)
  ds_read_b64_tr_b16 v[32:33], v10 offset:8192
  ds_read_b64_tr_b16 v[34:35], v10 offset:8704
  ds_read_b64_tr_b16 v[36:37], v11 offset:8192
  ds_read_b64_tr_b16 v[38:39], v11 offset:8704
  ds_read_b64_tr_b16 v[40:41], v10 offset:10240
  ds_read_b64_tr_b16 v[42:43], v10 offset:10752
  ds_read_b64_tr_b16 v[44:45], v11 offset:10240
  ds_read_b64_tr_b16 v[46:47], v11 offset:10752
  s_waitcnt lgkmcnt(4)
  v_mfma_f32_32x32x16_bf16 v[64:79], v[32:35], v[160:163], v[64:79]
  v_mfma_f32_32x32x16_bf16 v[80:95], v[32:35], v[164:167], v[80:95]
  v_mfma_f32_32x32x16_bf16 v[96:111], v[36:39], v[160:163], v[96:111]
  v_mfma_f32_32x32x16_bf16 v[112:127], v[36:39], v[164:167], v[112:127]
  s_waitcnt lgkmcnt(0)
  s_add_u32 m0, s41, 8192
  s_add_u32 s34, s40, 688128
  buffer_load_dwordx4 v16, s[12:15], s34 offen lds
  s_add_u32 m0, s41, 9216
  s_add_u32 s34, s40, 716800
  buffer_load_dwordx4 v16, s[12:15], s34 offen lds
  s_add_u32 m0, s41, 10240
  s_add_u32 s34, s40, 745472
  buffer_load_dwordx4 v16, s[12:15], s34 offen lds
  s_add_u32 m0, s41, 11264
  s_add_u32 s34, s40, 774144
  buffer_load_dwordx4 v16, s[12:15], s34 offen lds
  v_mfma_f32_32x32x16_bf16 v[64:79], v[40:43], v[168:171], v[64:79]
  v_mfma_f32_32x32x16_bf16 v[80:95], v[40:43], v[172:175], v[80:95]
  v_mfma_f32_32x32x16_bf16 v[96:111], v[44:47], v[168:171], v[96:111]
  v_mfma_f32_32x32x16_bf16 v[112:127], v[44:47], v[172:175], v[112:127]
  s_waitcnt vmcnt(28)
  ds_read_b64_tr_b16 v[48:49], v10 offset:12288
  ds_read_b64_tr_b16 v[50:51], v10 offset:12800
  ds_read_b64_tr_b16 v[52:53], v11 offset:12288
  ds_read_b64_tr_b16 v[54:55], v11 offset:12800
  ds_read_b64_tr_b16 v[56:57], v10 offset:14336
  ds_read_b64_tr_b16 v[58:59], v10 offset:14848
  ds_read_b64_tr_b16 v[60:61], v11 offset:14336
  ds_read_b64_tr_b16 v[62:63], v11 offset:14848
  s_waitcnt lgkmcnt(4)
  v_mfma_f32_32x32x16_bf16 v[64:79], v[48:51], v[176:179], v[64:79]
  v_mfma_f32_32x32x16_bf16 v[80:95], v[48:51], v[180:183], v[80:95]
  v_mfma_f32_32x32x16_bf16 v[96:111], v[52:55], v[176:179], v[96:111]
  v_mfma_f32_32x32x16_bf16 v[112:127], v[52:55], v[180:183], v[112:127]
  s_waitcnt lgkmcnt(0)
  s_add_u32 m0, s41, 12288
  s_add_u32 s34, s40, 802816
  buffer_load_dwordx4 v16, s[12:15], s34 offen lds
  s_add_u32 m0, s41, 13312
  s_add_u32 s34, s40, 831488
  buffer_load_dwordx4 v16, s[12:15], s34 offen lds
  s_add_u32 m0, s41, 14336
  s_add_u32 s34, s40, 860160
  buffer_load_dwordx4 v16, s[12:15], s34 offen lds
  s_add_u32 m0, s41, 15360
  s_add_u32 s34, s40, 888832
  buffer_load_dwordx4 v16, s[12:15], s34 offen lds
  v_mfma_f32_32x32x16_bf16 v[64:79], v[56:59], v[184:187], v[64:79]
  v_mfma_f32_32x32x16_bf16 v[80:95], v[56:59], v[188:191], v[80:95]
  v_mfma_f32_32x32x16_bf16 v[96:111], v[60:63], v[184:187], v[96:111]
  v_mfma_f32_32x32x16_bf16 v[112:127], v[60:63], v[188:191], v[112:127]
  s_waitcnt vmcnt(12)
  ds_read_b64_tr_b16 v[32:33], v10 offset:0
  ds_read_b64_tr_b16 v[34:35], v10 offset:512
  ds_read_b64_tr_b16 v[36:37], v11 offset:0
  ds_read_b64_tr_b16 v[38:39], v11 offset:512
  ds_read_b64_tr_b16 v[40:41], v10 offset:2048
  ds_read_b64_tr_b16 v[42:43], v10 offset:2560
  ds_read_b64_tr_b16 v[44:45], v11 offset:2048
  ds_read_b64_tr_b16 v[46:47], v11 offset:2560
  s_waitcnt lgkmcnt(4)
  v_mfma_f32_32x32x16_bf16 v[64:79], v[32:35], v[192:195], v[64:79]
  v_mfma_f32_32x32x16_bf16 v[80:95], v[32:35], v[196:199], v[80:95]
  v_mfma_f32_32x32x16_bf16 v[96:111], v[36:39], v[192:195], v[96:111]
  v_mfma_f32_32x32x16_bf16 v[112:127], v[36:39], v[196:199], v[112:127]
  s_waitcnt lgkmcnt(0)
  v_mfma_f32_32x32x16_bf16 v[64:79], v[40:43], v[200:203], v[64:79]
  v_mfma_f32_32x32x16_bf16 v[80:95], v[40:43], v[204:207], v[80:95]
  v_mfma_f32_32x32x16_bf16 v[96:111], v[44:47], v[200:203], v[96:111]
  v_mfma_f32_32x32x16_bf16 v[112:127], v[44:47], v[204:207], v[112:127]
  s_waitcnt vmcnt(8)
  ds_read_b64_tr_b16 v[48:49], v10 offset:4096
  ds_read_b64_tr_b16 v[50:51], v10 offset:4608
  ds_read_b64_tr_b16 v[52:53], v11 offset:4096
  ds_read_b64_tr_b16 v[54:55], v11 offset:4608
  ds_read_b64_tr_b16 v[56:57], v10 offset:6144
  ds_read_b64_tr_b16 v[58:59], v10 offset:6656
  ds_read_b64_tr_b16 v[60:61], v11 offset:6144
  ds_read_b64_tr_b16 v[62:63], v11 offset:6656
  s_waitcnt lgkmcnt(4)
  v_mfma_f32_32x32x16_bf16 v[64:79], v[48:51], v[208:211], v[64:79]
  v_mfma_f32_32x32x16_bf16 v[80:95], v[48:51], v[212:215], v[80:95]
  v_mfma_f32_32x32x16_bf16 v[96:111], v[52:55], v[208:211], v[96:111]
  v_mfma_f32_32x32x16_bf16 v[112:127], v[52:55], v[212:215], v[112:127]
  s_waitcnt lgkmcnt(0)
  v_mfma_f32_32x32x16_bf16 v[64:79], v[56:59], v[216:219], v[64:79]
  v_mfma_f32_32x32x16_bf16 v[80:95], v[56:59], v[220:223], v[80:95]
  v_mfma_f32_32x32x16_bf16 v[96:111], v[60:63], v[216:219], v[96:111]
  v_mfma_f32_32x32x16_bf16 v[112:127], v[60:63], v[220:223], v[112:127]
  s_waitcnt vmcnt(4)
  ds_read_b64_tr_b16 v[32:33], v10 offset:8192
  ds_read_b64_tr_b16 v[34:35], v10 offset:8704
  ds_read_b64_tr_b16 v[36:37], v11 offset:8192
  ds_read_b64_tr_b16 v[38:39], v11 offset:8704
  ds_read_b64_tr_b16 v[40:41], v10 offset:10240
  ds_read_b64_tr_b16 v[42:43], v10 offset:10752
  ds_read_b64_tr_b16 v[44:45], v11 offset:10240
  ds_read_b64_tr_b16 v[46:47], v11 offset:10752
  s_waitcnt lgkmcnt(4)
  v_mfma_f32_32x32x16_bf16 v[64:79], v[32:35], v[224:227], v[64:79]
  v_mfma_f32_32x32x16_bf16 v[80:95], v[32:35], v[228:231], v[80:95]
  v_mfma_f32_32x32x16_bf16 v[96:111], v[36:39], v[224:227], v[96:111]
  v_mfma_f32_32x32x16_bf16 v[112:127], v[36:39], v[228:231], v[112:127]
  s_waitcnt lgkmcnt(0)
  v_mfma_f32_32x32x16_bf16 v[64:79], v[40:43], v[232:235], v[64:79]
  v_mfma_f32_32x32x16_bf16 v[80:95], v[40:43], v[236:239], v[80:95]
  v_mfma_f32_32x32x16_bf16 v[96:111], v[44:47], v[232:235], v[96:111]
  v_mfma_f32_32x32x16_bf16 v[112:127], v[44:47], v[236:239], v[112:127]
  s_waitcnt vmcnt(0)
  ds_read_b64_tr_b16 v[48:49], v10 offset:12288
  ds_read_b64_tr_b16 v[50:51], v10 offset:12800
  ds_read_b64_tr_b16 v[52:53], v11 offset:12288
  ds_read_b64_tr_b16 v[54:55], v11 offset:12800
  ds_read_b64_tr_b16 v[56:57], v10 offset:14336
  ds_read_b64_tr_b16 v[58:59], v10 offset:14848
  ds_read_b64_tr_b16 v[60:61], v11 offset:14336
  ds_read_b64_tr_b16 v[62:63], v11 offset:14848
  s_waitcnt lgkmcnt(4)
  v_mfma_f32_32x32x16_bf16 v[64:79], v[48:51], v[240:243], v[64:79]
  v_mfma_f32_32x32x16_bf16 v[80:95], v[48:51], v[244:247], v[80:95]
  v_mfma_f32_32x32x16_bf16 v[96:111], v[52:55], v[240:243], v[96:111]
  v_mfma_f32_32x32x16_bf16 v[112:127], v[52:55], v[244:247], v[112:127]
  s_waitcnt lgkmcnt(0)
  v_mfma_f32_32x32x16_bf16 v[64:79], v[56:59], v[248:251], v[64:79]
  v_mfma_f32_32x32x16_bf16 v[80:95], v[56:59], v[252:255], v[80:95]
  v_mfma_f32_32x32x16_bf16 v[96:111], v[60:63], v[248:251], v[96:111]
  v_mfma_f32_32x32x16_bf16 v[112:127], v[60:63], v[252:255], v[112:127]
  v_add_u32 v12, s41, v17
  s_nop 7
  ds_write_b128 v12, v[64:67] offset:0
  ds_write_b128 v12, v[68:71] offset:1024
  ds_write_b128 v12, v[72:75] offset:2048
  ds_write_b128 v12, v[76:79] offset:3072
  ds_write_b128 v12, v[80:83] offset:4096
  ds_write_b128 v12, v[84:87] offset:5120
  ds_write_b128 v12, v[88:91] offset:6144
  ds_write_b128 v12, v[92:95] offset:7168
  ds_write_b128 v12, v[96:99] offset:8192
  ds_write_b128 v12, v[100:103] offset:9216
  ds_write_b128 v12, v[104:107] offset:10240
  ds_write_b128 v12, v[108:111] offset:11264
  ds_write_b128 v12, v[112:115] offset:12288
  ds_write_b128 v12, v[116:119] offset:13312
  ds_write_b128 v12, v[120:123] offset:14336
  ds_write_b128 v12, v[124:127] offset:15360
  s_lshl_b32 s34, s3, 11
  v_add_u32 v12, s34, v17
  v_add_u32 v13, 0x10000, v12
  s_waitcnt lgkmcnt(0)
  s_barrier
  ds_read_b128 v[64:67], v12 offset:0
  ds_read_b128 v[68:71], v12 offset:1024
  ds_read_b128 v[72:75], v12 offset:16384
  ds_read_b128 v[76:79], v12 offset:17408
  ds_read_b128 v[80:83], v12 offset:32768
  ds_read_b128 v[84:87], v12 offset:33792
  ds_read_b128 v[88:91], v12 offset:49152
  ds_read_b128 v[92:95], v12 offset:50176
  ds_read_b128 v[96:99], v13 offset:0
  ds_read_b128 v[100:103], v13 offset:1024
  ds_read_b128 v[104:107], v13 offset:16384
  ds_read_b128 v[108:111], v13 offset:17408
  ds_read_b128 v[112:115], v13 offset:32768
  ds_read_b128 v[116:119], v13 offset:33792
  ds_read_b128 v[120:123], v13 offset:49152
  ds_read_b128 v[124:127], v13 offset:50176
  s_waitcnt lgkmcnt(8)
  v_add_f32 v64, v64, v72
  v_add_f32 v65, v65, v73
  v_add_f32 v66, v66, v74
  v_add_f32 v67, v67, v75
  v_add_f32 v68, v68, v76
  v_add_f32 v69, v69, v77
  v_add_f32 v70, v70, v78
  v_add_f32 v71, v71, v79
  v_add_f32 v64, v64, v80
  v_add_f32 v65, v65, v81
  v_add_f32 v66, v66, v82
  v_add_f32 v67, v67, v83
  v_add_f32 v68, v68, v84
  v_add_f32 v69, v69, v85
  v_add_f32 v70, v70, v86
  v_add_f32 v71, v71, v87
  v_add_f32 v64, v64, v88
  v_add_f32 v65, v65, v89
  v_add_f32 v66, v66, v90
  v_add_f32 v67, v67, v91
  v_add_f32 v68, v68, v92
  v_add_f32 v69, v69, v93
  v_add_f32 v70, v70, v94
  v_add_f32 v71, v71, v95
  s_waitcnt lgkmcnt(0)
  v_add_f32 v64, v64, v96
  v_add_f32 v65, v65, v97
  v_add_f32 v66, v66, v98
  v_add_f32 v67, v67, v99
  v_add_f32 v68, v68, v100
  v_add_f32 v69, v69, v101
  v_add_f32 v70, v70, v102
  v_add_f32 v71, v71, v103
  v_add_f32 v64, v64, v104
  v_add_f32 v65, v65, v105
  v_add_f32 v66, v66, v106
  v_add_f32 v67, v67, v107
  v_add_f32 v68, v68, v108
  v_add_f32 v69, v69, v109
  v_add_f32 v70, v70, v110
  v_add_f32 v71, v71, v111
  v_add_f32 v64, v64, v112
  v_add_f32 v65, v65, v113
  v_add_f32 v66, v66, v114
  v_add_f32 v67, v67, v115
  v_add_f32 v68, v68, v116
  v_add_f32 v69, v69, v117
  v_add_f32 v70, v70, v118
  v_add_f32 v71, v71, v119
  v_add_f32 v64, v64, v120
  v_add_f32 v65, v65, v121
  v_add_f32 v66, v66, v122
  v_add_f32 v67, v67, v123
  v_add_f32 v68, v68, v124
  v_add_f32 v69, v69, v125
  v_add_f32 v70, v70, v126
  v_add_f32 v71, v71, v127
  s_waitcnt vmcnt(0)
  v_lshlrev_b32 v80, 16, v24
  v_and_b32 v81, 0xffff0000, v24
  v_lshlrev_b32 v82, 16, v25
  v_and_b32 v83, 0xffff0000, v25
  v_lshlrev_b32 v84, 16, v26
  v_and_b32 v85, 0xffff0000, v26
  v_lshlrev_b32 v86, 16, v27
  v_and_b32 v87, 0xffff0000, v27
  v_add_f32 v64, v64, v80
  v_add_f32 v65, v65, v81
  v_add_f32 v66, v66, v82
  v_add_f32 v67, v67, v83
  v_add_f32 v68, v68, v84
  v_add_f32 v69, v69, v85
  v_add_f32 v70, v70, v86
  v_add_f32 v71, v71, v87
  v_cvt_pk_bf16_f32 v40, v64, v65
  v_cvt_pk_bf16_f32 v41, v66, v67
  v_cvt_pk_bf16_f32 v42, v68, v69
  v_cvt_pk_bf16_f32 v43, v70, v71
  v_lshlrev_b32 v64, 16, v40
  v_and_b32 v65, 0xffff0000, v40
  v_lshlrev_b32 v66, 16, v41
  v_and_b32 v67, 0xffff0000, v41
  v_lshlrev_b32 v68, 16, v42
  v_and_b32 v69, 0xffff0000, v42
  v_lshlrev_b32 v70, 16, v43
  v_and_b32 v71, 0xffff0000, v43
  s_mov_b32 s34, 0xc0135761
  s_mov_b32 s35, 0xbdd2d3e8
  v_mov_b32 v32, s34
  v_mul_f32 v80, v64, v64
  v_mul_f32 v81, v65, v65
  v_mul_f32 v82, v66, v66
  v_mul_f32 v83, v67, v67
  v_mul_f32 v84, v68, v68
  v_mul_f32 v85, v69, v69
  v_mul_f32 v86, v70, v70
  v_mul_f32 v87, v71, v71
  v_fma_f32 v80, v80, s35, v32
  v_fma_f32 v81, v81, s35, v32
  v_fma_f32 v82, v82, s35, v32
  v_fma_f32 v83, v83, s35, v32
  v_fma_f32 v84, v84, s35, v32
  v_fma_f32 v85, v85, s35, v32
  v_fma_f32 v86, v86, s35, v32
  v_fma_f32 v87, v87, s35, v32
  v_mul_f32 v80, v80, v64
  v_mul_f32 v81, v81, v65
  v_mul_f32 v82, v82, v66
  v_mul_f32 v83, v83, v67
  v_mul_f32 v84, v84, v68
  v_mul_f32 v85, v85, v69
  v_mul_f32 v86, v86, v70
  v_mul_f32 v87, v87, v71
  v_exp_f32 v80, v80
  v_exp_f32 v81, v81
  v_exp_f32 v82, v82
  v_exp_f32 v83, v83
  v_exp_f32 v84, v84
  v_exp_f32 v85, v85
  v_exp_f32 v86, v86
  v_exp_f32 v87, v87
  v_add_f32 v80, 1.0, v80
  v_add_f32 v81, 1.0, v81
  v_add_f32 v82, 1.0, v82
  v_add_f32 v83, 1.0, v83
  v_add_f32 v84, 1.0, v84
  v_add_f32 v85, 1.0, v85
  v_add_f32 v86, 1.0, v86
  v_add_f32 v87, 1.0, v87
  v_rcp_f32 v80, v80
  v_rcp_f32 v81, v81
  v_rcp_f32 v82, v82
  v_rcp_f32 v83, v83
  v_rcp_f32 v84, v84
  v_rcp_f32 v85, v85
  v_rcp_f32 v86, v86
  v_rcp_f32 v87, v87
  v_mul_f32 v64, v64, v80
  v_mul_f32 v65, v65, v81
  v_mul_f32 v66, v66, v82
  v_mul_f32 v67, v67, v83
  v_mul_f32 v68, v68, v84
  v_mul_f32 v69, v69, v85
  v_mul_f32 v70, v70, v86
  v_mul_f32 v71, v71, v87
  v_cvt_pk_bf16_f32 v40, v64, v65
  v_cvt_pk_bf16_f32 v41, v66, v67
  v_cvt_pk_bf16_f32 v42, v68, v69
  v_cvt_pk_bf16_f32 v43, v70, v71
  s_lshl_b32 s34, s33, 1
  s_add_u32 s34, s34, s45
  s_mul_i32 s34, s34, 112
  s_lshl_b32 s35, s32, 2
  s_add_u32 s34, s34, s35
  s_lshl_b32 s35, s44, 1
  s_add_u32 s34, s34, s35
  s_add_u32 s34, s34, s46
  s_lshl_b32 s34, s34, 10
  buffer_store_dwordx4 v[40:43], v17, s[20:23], s34 offen sc1
k5_kernel_end:
  s_endpgm
.globl k6_kernel
.p2align 8
.type k6_kernel,@function
k6_kernel:
  s_cmp_ge_u32 s2, 256
  s_cbranch_scc1 k6_kernel_end
  s_load_dwordx2 s[4:5], s[0:1], 72
  s_load_dwordx2 s[6:7], s[0:1], 104
  s_load_dwordx2 s[8:9], s[0:1], 80
  s_load_dwordx2 s[10:11], s[0:1], 88
  v_and_b32 v1, 63, v0
  v_lshrrev_b32 v2, 6, v0
  s_nop 0
  v_readfirstlane_b32 s3, v2
  s_waitcnt lgkmcnt(0)
  s_and_b32 s30, s2, 7
  s_lshr_b32 s31, s2, 3
  s_lshr_b32 s32, s31, 3
  s_lshl_b32 s32, s32, 3
  s_add_u32 s32, s32, s30
  s_and_b32 s33, s31, 7
  s_cmp_ge_u32 s32, 32
  s_cbranch_scc1 k6_kernel_end
  s_mov_b32 s12, s4
  s_and_b32 s13, s5, 0xffff
  s_mov_b32 s14, 7340032
  s_mov_b32 s15, 0x20000
  s_add_u32 s16, s6, 90177536
  s_addc_u32 s17, s7, 0
  s_and_b32 s17, s17, 0xffff
  s_mov_b32 s18, 1835008
  s_mov_b32 s19, 0x20000
  s_add_u32 s20, s6, 85983232
  s_addc_u32 s21, s7, 0
  s_and_b32 s21, s21, 0xffff
  s_mov_b32 s22, 2097152
  s_mov_b32 s23, 0x20000
  s_mov_b32 s24, s8
  s_and_b32 s25, s9, 0xffff
  s_mov_b32 s26, 4096
  s_mov_b32 s27, 0x20000
  s_mov_b32 s36, s10
  s_and_b32 s37, s11, 0xffff
  s_mov_b32 s38, 2097152
  s_mov_b32 s39, 0x20000
  v_lshrrev_b32 v20, 3, v1
  s_movk_i32 s34, 4096
  v_mul_lo_u32 v20, v20, s34
  v_bfe_u32 v21, v1, 2, 1
  v_bfe_u32 v22, v1, 4, 1
  v_xor_b32 v21, v21, v22
  v_lshl_add_u32 v20, v21, 6, v20
  v_and_b32 v22, 3, v1
  v_lshl_add_u32 v16, v22, 4, v20
  v_lshlrev_b32 v17, 4, v1
  s_mul_i32 s40, s3, 917504
  s_lshl_b32 s34, s32, 7
  s_add_u32 s40, s40, s34
  s_lshl_b32 s41, s3, 14
  s_mul_i32 s42, s33, 229376
  s_mul_i32 s34, s3, 14336
  s_add_u32 s42, s42, s34
  s_add_u32 s43, s42, 114688
  s_lshr_b32 s44, s3, 2
  s_bfe_u32 s45, s3, 0x10001
  s_and_b32 s46, s3, 1
  v_lshrrev_b32 v18, 5, v1
  v_and_b32 v19, 31, v1
  s_lshl_b32 s34, s32, 6
  s_lshl_b32 s35, s45, 5
  s_add_u32 s34, s34, s35
  v_add_u32 v20, s34, v19
  v_lshlrev_b32 v21, 1, v20
  buffer_load_ushort v24, v21, s[24:27], 0 offen
  s_lshl_b32 s34, s33, 7
  s_lshl_b32 s35, s44, 6
  s_add_u32 s34, s34, s35
  s_lshl_b32 s35, s46, 5
  s_add_u32 s47, s34, s35
  v_lshlrev_b32 v20, 10, v20
  v_lshl_add_u32 v23, v18, 4, v20
  buffer_load_dwordx4 v[28:31], v23, s[20:23], s47 offen
  s_add_u32 m0, s41, 0
  s_add_u32 s34, s40, 0
  buffer_load_dwordx4 v16, s[12:15], s34 offen lds
  s_add_u32 m0, s41, 1024
  s_add_u32 s34, s40, 32768
  buffer_load_dwordx4 v16, s[12:15], s34 offen lds
  s_add_u32 m0, s41, 2048
  s_add_u32 s34, s40, 65536
  buffer_load_dwordx4 v16, s[12:15], s34 offen lds
  s_add_u32 m0, s41, 3072
  s_add_u32 s34, s40, 98304
  buffer_load_dwordx4 v16, s[12:15], s34 offen lds
  s_add_u32 s34, s42, 0
  buffer_load_dwordx4 v[128:131], v17, s[16:19], s34 offen offset:0
  s_add_u32 s34, s43, 0
  buffer_load_dwordx4 v[132:135], v17, s[16:19], s34 offen offset:0
  s_add_u32 s34, s42, 0
  buffer_load_dwordx4 v[136:139], v17, s[16:19], s34 offen offset:1024
  s_add_u32 s34, s43, 0
  buffer_load_dwordx4 v[140:143], v17, s[16:19], s34 offen offset:1024
  s_add_u32 m0, s41, 4096
  s_add_u32 s34, s40, 131072
  buffer_load_dwordx4 v16, s[12:15], s34 offen lds
  s_add_u32 m0, s41, 5120
  s_add_u32 s34, s40, 163840
  buffer_load_dwordx4 v16, s[12:15], s34 offen lds
  s_add_u32 m0, s41, 6144
  s_add_u32 s34, s40, 196608
  buffer_load_dwordx4 v16, s[12:15], s34 offen lds
  s_add_u32 m0, s41, 7168
  s_add_u32 s34, s40, 229376
  buffer_load_dwordx4 v16, s[12:15], s34 offen lds
  s_add_u32 s34, s42, 0
  buffer_load_dwordx4 v[144:147], v17, s[16:19], s34 offen offset:2048
  s_add_u32 s34, s43, 0
  buffer_load_dwordx4 v[148:151], v17, s[16:19], s34 offen offset:2048
  s_add_u32 s34, s42, 0
  buffer_load_dwordx4 v[152:155], v17, s[16:19], s34 offen offset:3072
  s_add_u32 s34, s43, 0
  buffer_load_dwordx4 v[156:159], v17, s[16:19], s34 offen offset:3072
  s_add_u32 m0, s41, 8192
  s_add_u32 s34, s40, 262144
  buffer_load_dwordx4 v16, s[12:15], s34 offen lds
  s_add_u32 m0, s41, 9216
  s_add_u32 s34, s40, 294912
  buffer_load_dwordx4 v16, s[12:15], s34 offen lds
  s_add_u32 m0, s41, 10240
  s_add_u32 s34, s40, 327680
  buffer_load_dwordx4 v16, s[12:15], s34 offen lds
  s_add_u32 m0, s41, 11264
  s_add_u32 s34, s40, 360448
  buffer_load_dwordx4 v16, s[12:15], s34 offen lds
  s_add_u32 s34, s42, 4096
  buffer_load_dwordx4 v[160:163], v17, s[16:19], s34 offen offset:0
  s_add_u32 s34, s43, 4096
  buffer_load_dwordx4 v[164:167], v17, s[16:19], s34 offen offset:0
  s_add_u32 s34, s42, 4096
  buffer_load_dwordx4 v[168:171], v17, s[16:19], s34 offen offset:1024
  s_add_u32 s34, s43, 4096
  buffer_load_dwordx4 v[172:175], v17, s[16:19], s34 offen offset:1024
  s_add_u32 m0, s41, 12288
  s_add_u32 s34, s40, 393216
  buffer_load_dwordx4 v16, s[12:15], s34 offen lds
  s_add_u32 m0, s41, 13312
  s_add_u32 s34, s40, 425984
  buffer_load_dwordx4 v16, s[12:15], s34 offen lds
  s_add_u32 m0, s41, 14336
  s_add_u32 s34, s40, 458752
  buffer_load_dwordx4 v16, s[12:15], s34 offen lds
  s_add_u32 m0, s41, 15360
  s_add_u32 s34, s40, 491520
  buffer_load_dwordx4 v16, s[12:15], s34 offen lds
  s_add_u32 s34, s42, 4096
  buffer_load_dwordx4 v[176:179], v17, s[16:19], s34 offen offset:2048
  s_add_u32 s34, s43, 4096
  buffer_load_dwordx4 v[180:183], v17, s[16:19], s34 offen offset:2048
  s_add_u32 s34, s42, 4096
  buffer_load_dwordx4 v[184:187], v17, s[16:19], s34 offen offset:3072
  s_add_u32 s34, s43, 4096
  buffer_load_dwordx4 v[188:191], v17, s[16:19], s34 offen offset:3072
  s_add_u32 s34, s42, 8192
  buffer_load_dwordx4 v[192:195], v17, s[16:19], s34 offen offset:0
  s_add_u32 s34, s43, 8192
  buffer_load_dwordx4 v[196:199], v17, s[16:19], s34 offen offset:0
  s_add_u32 s34, s42, 8192
  buffer_load_dwordx4 v[200:203], v17, s[16:19], s34 offen offset:1024
  s_add_u32 s34, s43, 8192
  buffer_load_dwordx4 v[204:207], v17, s[16:19], s34 offen offset:1024
  s_add_u32 s34, s42, 8192
  buffer_load_dwordx4 v[208:211], v17, s[16:19], s34 offen offset:2048
  s_add_u32 s34, s43, 8192
  buffer_load_dwordx4 v[212:215], v17, s[16:19], s34 offen offset:2048
  s_add_u32 s34, s42, 8192
  buffer_load_dwordx4 v[216:219], v17, s[16:19], s34 offen offset:3072
  s_add_u32 s34, s43, 8192
  buffer_load_dwordx4 v[220:223], v17, s[16:19], s34 offen offset:3072
  s_add_u32 s34, s42, 12288
  buffer_load_dwordx4 v[224:227], v17, s[16:19], s34 offen offset:0
  s_add_u32 s34, s43, 12288
  buffer_load_dwordx4 v[228:231], v17, s[16:19], s34 offen offset:0
  s_add_u32 s34, s42, 12288
  buffer_load_dwordx4 v[232:235], v17, s[16:19], s34 offen offset:1024
  s_add_u32 s34, s43, 12288
  buffer_load_dwordx4 v[236:239], v17, s[16:19], s34 offen offset:1024
  v_bfe_u32 v20, v1, 2, 2
  v_lshl_add_u32 v21, v18, 2, v20
  v_lshlrev_b32 v21, 7, v21
  v_and_b32 v22, 16, v1
  v_lshl_add_u32 v21, v22, 1, v21
  v_and_b32 v22, 3, v1
  v_lshl_add_u32 v21, v22, 3, v21
  v_add_u32 v21, s41, v21
  v_lshrrev_b32 v20, 1, v20
  v_lshl_add_u32 v10, v20, 6, v21
  v_xor_b32 v20, 1, v20
  v_lshl_add_u32 v11, v20, 6, v21
  s_waitcnt vmcnt(36)
  ds_read_b64_tr_b16 v[32:33], v10 offset:0
  ds_read_b64_tr_b16 v[34:35], v10 offset:1024
  ds_read_b64_tr_b16 v[36:37], v11 offset:0
  ds_read_b64_tr_b16 v[38:39], v11 offset:1024
  ds_read_b64_tr_b16 v[40:41], v10 offset:2048
  ds_read_b64_tr_b16 v[42:43], v10 offset:3072
  ds_read_b64_tr_b16 v[44:45], v11 offset:2048
  ds_read_b64_tr_b16 v[46:47], v11 offset:3072
  s_waitcnt lgkmcnt(4)
  v_mfma_f32_32x32x16_bf16 v[64:79], v[128:131], v[32:35], 0
  v_mfma_f32_32x32x16_bf16 v[80:95], v[128:131], v[36:39], 0
  v_mfma_f32_32x32x16_bf16 v[96:111], v[132:135], v[32:35], 0
  v_mfma_f32_32x32x16_bf16 v[112:127], v[132:135], v[36:39], 0
  s_waitcnt lgkmcnt(0)
  s_add_u32 m0, s41, 0
  s_add_u32 s34, s40, 524288
  buffer_load_dwordx4 v16, s[12:15], s34 offen lds
  s_add_u32 m0, s41, 1024
  s_add_u32 s34, s40, 557056
  buffer_load_dwordx4 v16, s[12:15], s34 offen lds
  s_add_u32 m0, s41, 2048
  s_add_u32 s34, s40, 589824
  buffer_load_dwordx4 v16, s[12:15], s34 offen lds
  s_add_u32 m0, s41, 3072
  s_add_u32 s34, s40, 622592
  buffer_load_dwordx4 v16, s[12:15], s34 offen lds
  v_mfma_f32_32x32x16_bf16 v[64:79], v[136:139], v[40:43], v[64:79]
  v_mfma_f32_32x32x16_bf16 v[80:95], v[136:139], v[44:47], v[80:95]
  v_mfma_f32_32x32x16_bf16 v[96:111], v[140:143], v[40:43], v[96:111]
  v_mfma_f32_32x32x16_bf16 v[112:127], v[140:143], v[44:47], v[112:127]
  s_waitcnt vmcnt(32)
  ds_read_b64_tr_b16 v[48:49], v10 offset:4096
  ds_read_b64_tr_b16 v[50:51], v10 offset:5120
  ds_read_b64_tr_b16 v[52:53], v11 offset:4096
  ds_read_b64_tr_b16 v[54:55], v11 offset:5120
  ds_read_b64_tr_b16 v[56:57], v10 offset:6144
  ds_read_b64_tr_b16 v[58:59], v10 offset:7168
  ds_read_b64_tr_b16 v[60:61], v11 offset:6144
  ds_read_b64_tr_b16 v[62:63], v11 offset:7168
  s_waitcnt lgkmcnt(4)
  v_mfma_f32_32x32x16_bf16 v[64:79], v[144:147], v[48:51], v[64:79]
  v_mfma_f32_32x32x16_bf16 v[80:95], v[144:147], v[52:55], v[80:95]
  v_mfma_f32_32x32x16_bf16 v[96:111], v[148:151], v[48:51], v[96:111]
  v_mfma_f32_32x32x16_bf16 v[112:127], v[148:151], v[52:55], v[112:127]
  s_waitcnt lgkmcnt(0)
  s_add_u32 m0, s41, 4096
  s_add_u32 s34, s40, 655360
  buffer_load_dwordx4 v16, s[12:15], s34 offen lds
  s_add_u32 m0, s41, 5120
  s_add_u32 s34, s40, 688128
  buffer_load_dwordx4 v16, s[12:15], s34 offen lds
  s_add_u32 m0, s41, 6144
  s_add_u32 s34, s40, 720896
  buffer_load_dwordx4 v16, s[12:15], s34 offen lds
  s_add_u32 m0, s41, 7168
  s_add_u32 s34, s40, 753664
  buffer_load_dwordx4 v16, s[12:15], s34 offen lds
  v_mfma_f32_32x32x16_bf16 v[64:79], v[152:155], v[56:59], v[64:79]
  v_mfma_f32_32x32x16_bf16 v[80:95], v[152:155], v[60:63], v[80:95]
  v_mfma_f32_32x32x16_bf16 v[96:111], v[156:159], v[56:59], v[96:111]
  v_mfma_f32_32x32x16_bf16 v[112:127], v[156:159], v[60:63], v[112:127]
  s_waitcnt vmcnt(28)
  ds_read_b64_tr_b16 v[32:33], v10 offset:8192
  ds_read_b64_tr_b16 v[34:35], v10 offset:9216
  ds_read_b64_tr_b16 v[36:37], v11 offset:8192
  ds_read_b64_tr_b16 v[38:39], v11 offset:9216
  ds_read_b64_tr_b16 v[40:41], v10 offset:10240
  ds_read_b64_tr_b16 v[42:43], v10 offset:11264
  ds_read_b64_tr_b16 v[44:45], v11 offset:10240
  ds_read_b64_tr_b16 v[46:47], v11 offset:11264
  s_waitcnt lgkmcnt(4)
  v_mfma_f32_32x32x16_bf16 v[64:79], v[160:163], v[32:35], v[64:79]
  v_mfma_f32_32x32x16_bf16 v[80:95], v[160:163], v[36:39], v[80:95]
  v_mfma_f32_32x32x16_bf16 v[96:111], v[164:167], v[32:35], v[96:111]
  v_mfma_f32_32x32x16_bf16 v[112:127], v[164:167], v[36:39], v[112:127]
  s_waitcnt lgkmcnt(0)
  s_add_u32 m0, s41, 8192
  s_add_u32 s34, s40, 786432
  buffer_load_dwordx4 v16, s[12:15], s34 offen lds
  s_add_u32 m0, s41, 9216
  s_add_u32 s34, s40, 819200
  buffer_load_dwordx4 v16, s[12:15], s34 offen lds
  s_add_u32 m0, s41, 10240
  s_add_u32 s34, s40, 851968
  buffer_load_dwordx4 v16, s[12:15], s34 offen lds
  s_add_u32 m0, s41, 11264
  s_add_u32 s34, s40, 884736
  buffer_load_dwordx4 v16, s[12:15], s34 offen lds
  v_mfma_f32_32x32x16_bf16 v[64:79], v[168:171], v[40:43], v[64:79]
  v_mfma_f32_32x32x16_bf16 v[80:95], v[168:171], v[44:47], v[80:95]
  v_mfma_f32_32x32x16_bf16 v[96:111], v[172:175], v[40:43], v[96:111]
  v_mfma_f32_32x32x16_bf16 v[112:127], v[172:175], v[44:47], v[112:127]
  s_waitcnt vmcnt(24)
  ds_read_b64_tr_b16 v[48:49], v10 offset:12288
  ds_read_b64_tr_b16 v[50:51], v10 offset:13312
  ds_read_b64_tr_b16 v[52:53], v11 offset:12288
  ds_read_b64_tr_b16 v[54:55], v11 offset:13312
  ds_read_b64_tr_b16 v[56:57], v10 offset:14336
  ds_read_b64_tr_b16 v[58:59], v10 offset:15360
  ds_read_b64_tr_b16 v[60:61], v11 offset:14336
  ds_read_b64_tr_b16 v[62:63], v11 offset:15360
  s_waitcnt lgkmcnt(4)
  v_mfma_f32_32x32x16_bf16 v[64:79], v[176:179], v[48:51], v[64:79]
  v_mfma_f32_32x32x16_bf16 v[80:95], v[176:179], v[52:55], v[80:95]
  v_mfma_f32_32x32x16_bf16 v[96:111], v[180:183], v[48:51], v[96:111]
  v_mfma_f32_32x32x16_bf16 v[112:127], v[180:183], v[52:55], v[112:127]
  s_waitcnt lgkmcnt(0)
  v_mfma_f32_32x32x16_bf16 v[64:79], v[184:187], v[56:59], v[64:79]
  v_mfma_f32_32x32x16_bf16 v[80:95], v[184:187], v[60:63], v[80:95]
  v_mfma_f32_32x32x16_bf16 v[96:111], v[188:191], v[56:59], v[96:111]
  v_mfma_f32_32x32x16_bf16 v[112:127], v[188:191], v[60:63], v[112:127]
  s_waitcnt vmcnt(8)
  ds_read_b64_tr_b16 v[32:33], v10 offset:0
  ds_read_b64_tr_b16 v[34:35], v10 offset:1024
  ds_read_b64_tr_b16 v[36:37], v11 offset:0
  ds_read_b64_tr_b16 v[38:39], v11 offset:1024
  ds_read_b64_tr_b16 v[40:41], v10 offset:2048
  ds_read_b64_tr_b16 v[42:43], v10 offset:3072
  ds_read_b64_tr_b16 v[44:45], v11 offset:2048
  ds_read_b64_tr_b16 v[46:47], v11 offset:3072
  s_waitcnt lgkmcnt(4)
  v_mfma_f32_32x32x16_bf16 v[64:79], v[192:195], v[32:35], v[64:79]
  v_mfma_f32_32x32x16_bf16 v[80:95], v[192:195], v[36:39], v[80:95]
  v_mfma_f32_32x32x16_bf16 v[96:111], v[196:199], v[32:35], v[96:111]
  v_mfma_f32_32x32x16_bf16 v[112:127], v[196:199], v[36:39], v[112:127]
  s_waitcnt lgkmcnt(0)
  v_mfma_f32_32x32x16_bf16 v[64:79], v[200:203], v[40:43], v[64:79]
  v_mfma_f32_32x32x16_bf16 v[80:95], v[200:203], v[44:47], v[80:95]
  v_mfma_f32_32x32x16_bf16 v[96:111], v[204:207], v[40:43], v[96:111]
  v_mfma_f32_32x32x16_bf16 v[112:127], v[204:207], v[44:47], v[112:127]
  s_waitcnt vmcnt(4)
  ds_read_b64_tr_b16 v[48:49], v10 offset:4096
  ds_read_b64_tr_b16 v[50:51], v10 offset:5120
  ds_read_b64_tr_b16 v[52:53], v11 offset:4096
  ds_read_b64_tr_b16 v[54:55], v11 offset:5120
  ds_read_b64_tr_b16 v[56:57], v10 offset:6144
  ds_read_b64_tr_b16 v[58:59], v10 offset:7168
  ds_read_b64_tr_b16 v[60:61], v11 offset:6144
  ds_read_b64_tr_b16 v[62:63], v11 offset:7168
  s_waitcnt lgkmcnt(4)
  v_mfma_f32_32x32x16_bf16 v[64:79], v[208:211], v[48:51], v[64:79]
  v_mfma_f32_32x32x16_bf16 v[80:95], v[208:211], v[52:55], v[80:95]
  v_mfma_f32_32x32x16_bf16 v[96:111], v[212:215], v[48:51], v[96:111]
  v_mfma_f32_32x32x16_bf16 v[112:127], v[212:215], v[52:55], v[112:127]
  s_waitcnt lgkmcnt(0)
  v_mfma_f32_32x32x16_bf16 v[64:79], v[216:219], v[56:59], v[64:79]
  v_mfma_f32_32x32x16_bf16 v[80:95], v[216:219], v[60:63], v[80:95]
  v_mfma_f32_32x32x16_bf16 v[96:111], v[220:223], v[56:59], v[96:111]
  v_mfma_f32_32x32x16_bf16 v[112:127], v[220:223], v[60:63], v[112:127]
  s_waitcnt vmcnt(0)
  ds_read_b64_tr_b16 v[32:33], v10 offset:8192
  ds_read_b64_tr_b16 v[34:35], v10 offset:9216
  ds_read_b64_tr_b16 v[36:37], v11 offset:8192
  ds_read_b64_tr_b16 v[38:39], v11 offset:9216
  ds_read_b64_tr_b16 v[40:41], v10 offset:10240
  ds_read_b64_tr_b16 v[42:43], v10 offset:11264
  ds_read_b64_tr_b16 v[44:45], v11 offset:10240
  ds_read_b64_tr_b16 v[46:47], v11 offset:11264
  s_waitcnt lgkmcnt(4)
  v_mfma_f32_32x32x16_bf16 v[64:79], v[224:227], v[32:35], v[64:79]
  v_mfma_f32_32x32x16_bf16 v[80:95], v[224:227], v[36:39], v[80:95]
  v_mfma_f32_32x32x16_bf16 v[96:111], v[228:231], v[32:35], v[96:111]
  v_mfma_f32_32x32x16_bf16 v[112:127], v[228:231], v[36:39], v[112:127]
  s_waitcnt lgkmcnt(0)
  v_mfma_f32_32x32x16_bf16 v[64:79], v[232:235], v[40:43], v[64:79]
  v_mfma_f32_32x32x16_bf16 v[80:95], v[232:235], v[44:47], v[80:95]
  v_mfma_f32_32x32x16_bf16 v[96:111], v[236:239], v[40:43], v[96:111]
  v_mfma_f32_32x32x16_bf16 v[112:127], v[236:239], v[44:47], v[112:127]
  v_add_u32 v12, s41, v17
  s_nop 7
  ds_write_b128 v12, v[64:67] offset:0
  ds_write_b128 v12, v[68:71] offset:1024
  ds_write_b128 v12, v[72:75] offset:2048
  ds_write_b128 v12, v[76:79] offset:3072
  ds_write_b128 v12, v[80:83] offset:4096
  ds_write_b128 v12, v[84:87] offset:5120
  ds_write_b128 v12, v[88:91] offset:6144
  ds_write_b128 v12, v[92:95] offset:7168
  ds_write_b128 v12, v[96:99] offset:8192
  ds_write_b128 v12, v[100:103] offset:9216
  ds_write_b128 v12, v[104:107] offset:10240
  ds_write_b128 v12, v[108:111] offset:11264
  ds_write_b128 v12, v[112:115] offset:12288
  ds_write_b128 v12, v[116:119] offset:13312
  ds_write_b128 v12, v[120:123] offset:14336
  ds_write_b128 v12, v[124:127] offset:15360
  s_lshl_b32 s34, s3, 11
  v_add_u32 v12, s34, v17
  v_add_u32 v13, 0x10000, v12
  s_waitcnt lgkmcnt(0)
  s_barrier
  ds_read_b128 v[64:67], v12 offset:0
  ds_read_b128 v[68:71], v12 offset:1024
  ds_read_b128 v[72:75], v12 offset:16384
  ds_read_b128 v[76:79], v12 offset:17408
  ds_read_b128 v[80:83], v12 offset:32768
  ds_read_b128 v[84:87], v12 offset:33792
  ds_read_b128 v[88:91], v12 offset:49152
  ds_read_b128 v[92:95], v12 offset:50176
  ds_read_b128 v[96:99], v13 offset:0
  ds_read_b128 v[100:103], v13 offset:1024
  ds_read_b128 v[104:107], v13 offset:16384
  ds_read_b128 v[108:111], v13 offset:17408
  ds_read_b128 v[112:115], v13 offset:32768
  ds_read_b128 v[116:119], v13 offset:33792
  ds_read_b128 v[120:123], v13 offset:49152
  ds_read_b128 v[124:127], v13 offset:50176
  s_waitcnt lgkmcnt(8)
  v_add_f32 v64, v64, v72
  v_add_f32 v65, v65, v73
  v_add_f32 v66, v66, v74
  v_add_f32 v67, v67, v75
  v_add_f32 v68, v68, v76
  v_add_f32 v69, v69, v77
  v_add_f32 v70, v70, v78
  v_add_f32 v71, v71, v79
  v_add_f32 v64, v64, v80
  v_add_f32 v65, v65, v81
  v_add_f32 v66, v66, v82
  v_add_f32 v67, v67, v83
  v_add_f32 v68, v68, v84
  v_add_f32 v69, v69, v85
  v_add_f32 v70, v70, v86
  v_add_f32 v71, v71, v87
  v_add_f32 v64, v64, v88
  v_add_f32 v65, v65, v89
  v_add_f32 v66, v66, v90
  v_add_f32 v67, v67, v91
  v_add_f32 v68, v68, v92
  v_add_f32 v69, v69, v93
  v_add_f32 v70, v70, v94
  v_add_f32 v71, v71, v95
  s_waitcnt lgkmcnt(0)
  v_add_f32 v64, v64, v96
  v_add_f32 v65, v65, v97
  v_add_f32 v66, v66, v98
  v_add_f32 v67, v67, v99
  v_add_f32 v68, v68, v100
  v_add_f32 v69, v69, v101
  v_add_f32 v70, v70, v102
  v_add_f32 v71, v71, v103
  v_add_f32 v64, v64, v104
  v_add_f32 v65, v65, v105
  v_add_f32 v66, v66, v106
  v_add_f32 v67, v67, v107
  v_add_f32 v68, v68, v108
  v_add_f32 v69, v69, v109
  v_add_f32 v70, v70, v110
  v_add_f32 v71, v71, v111
  v_add_f32 v64, v64, v112
  v_add_f32 v65, v65, v113
  v_add_f32 v66, v66, v114
  v_add_f32 v67, v67, v115
  v_add_f32 v68, v68, v116
  v_add_f32 v69, v69, v117
  v_add_f32 v70, v70, v118
  v_add_f32 v71, v71, v119
  v_add_f32 v64, v64, v120
  v_add_f32 v65, v65, v121
  v_add_f32 v66, v66, v122
  v_add_f32 v67, v67, v123
  v_add_f32 v68, v68, v124
  v_add_f32 v69, v69, v125
  v_add_f32 v70, v70, v126
  v_add_f32 v71, v71, v127
  s_waitcnt vmcnt(0)
  v_lshlrev_b32 v24, 16, v24
  v_add_f32 v64, v64, v24
  v_add_f32 v65, v65, v24
  v_add_f32 v66, v66, v24
  v_add_f32 v67, v67, v24
  v_add_f32 v68, v68, v24
  v_add_f32 v69, v69, v24
  v_add_f32 v70, v70, v24
  v_add_f32 v71, v71, v24
  v_cvt_pk_bf16_f32 v40, v64, v65
  v_cvt_pk_bf16_f32 v41, v66, v67
  v_cvt_pk_bf16_f32 v42, v68, v69
  v_cvt_pk_bf16_f32 v43, v70, v71
  v_lshlrev_b32 v64, 16, v40
  v_and_b32 v65, 0xffff0000, v40
  v_lshlrev_b32 v66, 16, v41
  v_and_b32 v67, 0xffff0000, v41
  v_lshlrev_b32 v68, 16, v42
  v_and_b32 v69, 0xffff0000, v42
  v_lshlrev_b32 v70, 16, v43
  v_and_b32 v71, 0xffff0000, v43
  v_permlane32_swap_b32 v64, v68
  v_permlane32_swap_b32 v65, v69
  v_permlane32_swap_b32 v66, v70
  v_permlane32_swap_b32 v67, v71
  v_lshlrev_b32 v80, 16, v28
  v_and_b32 v81, 0xffff0000, v28
  v_lshlrev_b32 v82, 16, v29
  v_and_b32 v83, 0xffff0000, v29
  v_lshlrev_b32 v84, 16, v30
  v_and_b32 v85, 0xffff0000, v30
  v_lshlrev_b32 v86, 16, v31
  v_and_b32 v87, 0xffff0000, v31
  v_add_f32 v64, v64, v80
  v_add_f32 v65, v65, v81
  v_add_f32 v66, v66, v82
  v_add_f32 v67, v67, v83
  v_add_f32 v68, v68, v84
  v_add_f32 v69, v69, v85
  v_add_f32 v70, v70, v86
  v_add_f32 v71, v71, v87
  v_cvt_pk_bf16_f32 v40, v64, v65
  v_cvt_pk_bf16_f32 v41, v66, v67
  v_cvt_pk_bf16_f32 v42, v68, v69
  v_cvt_pk_bf16_f32 v43, v70, v71
  buffer_store_dwordx4 v[40:43], v23, s[36:39], s47 offen
k6_kernel_end:
  s_endpgm
.section .rodata,"a"
.p2align 6
.amdhsa_kernel k1_kernel
  .amdhsa_next_free_vgpr 256
  .amdhsa_next_free_sgpr 64
  .amdhsa_accum_offset 256
  .amdhsa_group_segment_fixed_size 0
  .amdhsa_kernarg_size 112
  .amdhsa_user_sgpr_count 2
  .amdhsa_user_sgpr_kernarg_segment_ptr 1
  .amdhsa_system_sgpr_workgroup_id_x 1
.end_amdhsa_kernel
.p2align 6
.amdhsa_kernel k2_kernel
  .amdhsa_next_free_vgpr 256
  .amdhsa_next_free_sgpr 96
  .amdhsa_accum_offset 256
  .amdhsa_group_segment_fixed_size 0
  .amdhsa_kernarg_size 112
  .amdhsa_user_sgpr_count 2
  .amdhsa_user_sgpr_kernarg_segment_ptr 1
  .amdhsa_system_sgpr_workgroup_id_x 1
.end_amdhsa_kernel
.p2align 6
.amdhsa_kernel k3_kernel
  .amdhsa_next_free_vgpr 128
  .amdhsa_next_free_sgpr 48
  .amdhsa_accum_offset 128
  .amdhsa_group_segment_fixed_size 0
  .amdhsa_kernarg_size 112
  .amdhsa_user_sgpr_count 2
  .amdhsa_user_sgpr_kernarg_segment_ptr 1
  .amdhsa_system_sgpr_workgroup_id_x 1
.end_amdhsa_kernel
.p2align 6
.amdhsa_kernel k4_kernel
  .amdhsa_next_free_vgpr 128
  .amdhsa_next_free_sgpr 48
  .amdhsa_accum_offset 128
  .amdhsa_group_segment_fixed_size 0
  .amdhsa_kernarg_size 112
  .amdhsa_user_sgpr_count 2
  .amdhsa_user_sgpr_kernarg_segment_ptr 1
  .amdhsa_system_sgpr_workgroup_id_x 1
.end_amdhsa_kernel
.p2align 6
.amdhsa_kernel k5_kernel
  .amdhsa_next_free_vgpr 256
  .amdhsa_next_free_sgpr 56
  .amdhsa_accum_offset 256
  .amdhsa_group_segment_fixed_size 0
  .amdhsa_kernarg_size 112
  .amdhsa_user_sgpr_count 2
  .amdhsa_user_sgpr_kernarg_segment_ptr 1
  .amdhsa_system_sgpr_workgroup_id_x 1
.end_amdhsa_kernel
.p2align 6
.amdhsa_kernel k6_kernel
  .amdhsa_next_free_vgpr 256
  .amdhsa_next_free_sgpr 56
  .amdhsa_accum_offset 256
  .amdhsa_group_segment_fixed_size 0
  .amdhsa_kernarg_size 112
  .amdhsa_user_sgpr_count 2
  .amdhsa_user_sgpr_kernarg_segment_ptr 1
  .amdhsa_system_sgpr_workgroup_id_x 1
.end_amdhsa_kernel
```
